```python
import torch

def _softmax(x, axis=-1):
    return torch.softmax(x, dim=axis)
def _gelu(x):
    return torch.nn.functional.gelu(x, approximate="tanh")
def _silu(x):
    return torch.nn.functional.silu(x)
def _sigmoid(x):
    return torch.sigmoid(x)
def _layernorm(x, axis=-1, eps=1e-5):
    m = x.mean(dim=axis, keepdim=True)
    v = x.var(dim=axis, keepdim=True, unbiased=False)
    return (x - m) / torch.sqrt(v + eps)
def _scatter_add(tgt, idx, src, axis=0):
    return tgt.clone().index_add_(axis, idx, src)
def _segment_sum(src, seg, n):
    out = torch.zeros((n,) + src.shape[1:], dtype=src.dtype)
    return out.index_add_(0, seg, src)
def _pad(x, pw):
    flat = tuple(v for pair in reversed(pw) for v in pair)
    return torch.nn.functional.pad(x, flat)

kernel_name = 'gated_mix__linear_kernel_hedgehog__glu_gated_geglu__prompt'

def setup_inputs():

    _w = (lambda a: (lambda t: t.to(torch.bfloat16) if t.is_floating_point() else t)(torch.as_tensor(a)))
    def _A_setup():
        B, S, D, H = 1, 2048, 512, 32
        Dh = D // H
        return {
            "x": _w((lambda *s: torch.randn(*s, dtype=torch.bfloat16) * 0.05)(B, S, D)),
            "wqkv": _w((lambda *s: torch.randn(*s, dtype=torch.bfloat16) * 0.8)(D, 3 * D)),
            "w_phi": _w((lambda *s: torch.randn(*s, dtype=torch.bfloat16) * 0.8)(H, Dh, Dh) * (Dh ** -0.5)),
            "wo": _w((lambda *s: torch.randn(*s, dtype=torch.bfloat16) * 0.05)(D, D)),
        }
    _A_in = _A_setup()

    def _B_setup():
        B, S, Dm, Df = 1, 2048, 512, 1792
        return {
            "x": _w((lambda *s: torch.randn(*s, dtype=torch.bfloat16) * 0.05)(B, S, Dm)),
            "w_gate": _w((lambda *s: torch.randn(*s, dtype=torch.bfloat16) * 1.6)(Dm, Df) * (Dm ** -0.5)),
            "w_up": _w((lambda *s: torch.randn(*s, dtype=torch.bfloat16) * 1.6)(Dm, Df) * (Dm ** -0.5)),
            "w_down": _w((lambda *s: torch.randn(*s, dtype=torch.bfloat16) * 1.6)(Df, Dm) * (Df ** -0.5)),
        }
    _B_in = _B_setup()

    return {
        "A_x": _A_in["x"],
        "A_wqkv": _A_in["wqkv"],
        "A_w_phi": _A_in["w_phi"],
        "A_wo": _A_in["wo"],
        "B_x": _B_in["x"],
        "B_w_gate": _B_in["w_gate"],
        "B_w_up": _B_in["w_up"],
        "B_w_down": _B_in["w_down"],
        "gate_w": _w((lambda *s: torch.randn(*s, dtype=torch.bfloat16) * 0.05)(512) * 16.0),
    }

def reference(A_x, A_wqkv, A_w_phi, A_wo, B_x, B_w_gate, B_w_up, B_w_down, gate_w):
    def _A_ref(x, wqkv, w_phi, wo):
        B, S, D = x.shape
        H = 32; Dh = D // H
        qkv = (lambda x, *d: x.permute(*d))((x @ wqkv).reshape(B, S, 3, H, Dh), 2, 0, 3, 1, 4)
        q, k, v = qkv[0], qkv[1], qkv[2]
        pq = torch.einsum("bhsd,hdf->bhsf", q, w_phi)
        pk = torch.einsum("bhsd,hdf->bhsf", k, w_phi)
        phi_q = torch.concatenate([_softmax(pq, axis=-1), _softmax(-pq, axis=-1)], axis=-1)
        phi_k = torch.concatenate([_softmax(pk, axis=-1), _softmax(-pk, axis=-1)], axis=-1)
        kv = torch.einsum("bhsf,bhsd->bhfd", phi_k, v)
        z  = torch.einsum("bhsf->bhf", phi_k)
        num = torch.einsum("bhqf,bhfd->bhqd", phi_q, kv)
        den = torch.einsum("bhqf,bhf->bhq", phi_q, z)[..., None] + 1e-6
        o = num / den
        return (lambda x, *d: x.permute(*d))(o, 0, 2, 1, 3).reshape(B, S, D) @ wo

    def _B_ref(x, w_gate, w_up, w_down):
        g = torch.einsum("bsd,df->bsf", x, w_gate)
        u = torch.einsum("bsd,df->bsf", x, w_up)
        h = _gelu(g) * u
        return torch.einsum("bsf,fd->bsd", h, w_down)

    x = A_x
    g = _sigmoid((x * gate_w).sum(-1, keepdims=True))
    a = _A_ref(x, A_wqkv, A_w_phi, A_wo)
    b = _B_ref(x, B_w_gate, B_w_up, B_w_down)
    return g * a + (1 - g) * b
```

```asm
; @launch grid=(256,1,1) block=(256,1,1) lds=163840
.amdgcn_target "amdgcn-amd-amdhsa--gfx950"
.text
.globl gated_mix__linear_kernel_hedgehog__glu_gated_geglu__prompt_kernel
.p2align 12
.p2align 8
.type gated_mix__linear_kernel_hedgehog__glu_gated_geglu__prompt_kernel,@function
gated_mix__linear_kernel_hedgehog__glu_gated_geglu__prompt_kernel:
  s_cmp_ge_u32 s2, 256
  s_cbranch_scc1 L_end
  s_load_dwordx16 s[4:19], s[0:1], 0
  s_load_dwordx8 s[20:27], s[0:1], 64
  s_memrealtime s[56:57]
  v_lshrrev_b32 v1, 6, v0
  v_and_b32 v175, 63, v0
  v_readfirstlane_b32 s58, v1
  s_lshr_b32 s98, s2, 3
  s_getpc_b64 s[80:81]
L_pc:
  v_lshlrev_b32 v2, 3, v0
  v_lshl_add_u32 v2, s98, 11, v2
  v_min_u32 v2, L_end-L_pc, v2
  v_add_co_u32 v2, vcc, s80, v2
  v_mov_b32 v3, s81
  s_nop 0
  v_addc_co_u32 v3, vcc, 0, v3, vcc
  global_load_dword v64, v[2:3], off
  s_bfe_u32 s97, s2, 65538
  s_and_b32 s99, s98, 7
  s_lshl3_add_u32 s62, s97, s99
  s_lshr_b32 s98, s98, 3
  s_lshr_b32 s83, s98, 1
  s_and_b32 s61, s2, 3
  s_and_b32 s78, s98, 1
  s_lshl1_add_u32 s61, s61, s78
  s_add_u32 s63, s99, s2
  s_lshl1_add_u32 s63, s63, s97
  s_and_b32 s63, s63, 7
  s_lshr_b32 s59, s58, 1
  s_and_b32 s60, s58, 1
  s_lshl_b32 s76, s58, 12
  s_mov_b32 s64, s63
  s_lshl_b32 s97, s59, 10
  s_add_u32 s97, s97, 1024
  s_cmp_eq_u32 s83, 0
  s_cselect_b32 s97, s97, 1536
  s_movk_i32 s98, 3584
  s_cselect_b32 s98, 3072, s98
  s_lshl_b32 s78, s61, 7
  s_add_u32 s97, s97, s78
  s_lshl_b32 s86, s98, 6
  s_lshl_b32 s99, s98, 3
  s_sub_u32 s99, s99, 1024
  s_lshl_b32 s34, s98, 9
  s_sub_u32 s34, s34, s97
  v_lshrrev_b32 v2, 3, v175
  v_lshl_add_u32 v2, s58, 5, v2
  v_lshlrev_b32 v2, 10, v2
  v_lshrrev_b32 v3, 4, v175
  v_and_b32 v4, 7, v175
  v_xor_b32 v3, v3, v4
  v_lshl_add_u32 v164, v3, 4, v2
  v_xor_b32 v5, 64, v164
  v_add_u32 v165, 7168, v5
  v_add_u32 v166, 14336, v164
  v_add_u32 v167, 21504, v5
  v_lshlrev_b32 v183, 4, v175
  v_lshrrev_b32 v169, 3, v175
  v_and_b32 v170, 2, v169
  v_lshl_add_u32 v169, s60, 5, v169
  v_mul_u32_u24 v169, s98, v169
  v_and_b32 v171, 7, v175
  v_xor_b32 v170, v170, v171
  v_lshl_add_u32 v168, v170, 4, v169
  v_xor_b32 v169, 64, v168
  v_add_u32 v169, s99, v169
  v_lshl_add_u32 v170, s99, 1, v168
  v_lshl_add_u32 v171, s99, 1, v169
  s_lshl_b32 s78, s64, 7
  s_add_u32 m0, s76, 65536
  s_mul_i32 s79, s64, s86
  s_lshl_b32 s99, s62, 17
  s_mov_b32 s30, 0x20000
  s_mov_b32 s31, 0x20000
  s_mov_b32 s35, 0x20000
  s_waitcnt lgkmcnt(0)
  s_add_u32 s28, s4, s99
  s_addc_u32 s29, s5, 0
  buffer_load_dwordx4 v164, s[28:31], s78 offen offset:0 lds
  buffer_load_dwordx4 v165, s[28:31], s78 offen offset:1024 lds
  buffer_load_dwordx4 v166, s[28:31], s78 offen offset:2048 lds
  buffer_load_dwordx4 v167, s[28:31], s78 offen offset:3072 lds
  s_add_u32 m0, s76, 0
  s_cmp_eq_u32 s59, 0
  s_cselect_b64 s[84:85], s[14:15], s[16:17]
  s_cmp_eq_u32 s83, 0
  s_cselect_b64 s[32:33], s[6:7], s[84:85]
  s_add_u32 s32, s32, s97
  s_addc_u32 s33, s33, 0
  buffer_load_dwordx4 v168, s[32:35], s79 offen offset:0 lds
  buffer_load_dwordx4 v169, s[32:35], s79 offen offset:1024 lds
  buffer_load_dwordx4 v170, s[32:35], s79 offen offset:2048 lds
  buffer_load_dwordx4 v171, s[32:35], s79 offen offset:3072 lds
  v_lshl_add_u32 v1, s63, 7, v183
  v_and_b32 v1, 1023, v1
  s_lshl1_add_u32 s78, s61, s59
  v_lshl_add_u32 v2, s78, 10, v183
  s_lshl_b32 s79, s59, 10
  s_add_u32 s79, s79, 115712
  s_cmp_eq_u32 s59, s60
  s_cselect_b64 vcc, -1, 0
  s_cselect_b64 s[12:13], s[20:21], s[8:9]
  s_cselect_b32 s87, 114688, s79
  v_cndmask_b32 v70, v2, v1, vcc
  s_add_u32 s65, s63, 1
  s_and_b32 s65, s65, 7
  s_add_u32 s66, s63, 2
  s_and_b32 s66, s66, 7
  s_add_u32 s67, s63, 3
  s_and_b32 s67, s67, 7
  s_add_u32 s68, s63, 4
  s_and_b32 s68, s68, 7
  s_add_u32 s69, s63, 5
  s_and_b32 s69, s69, 7
  s_add_u32 s70, s63, 6
  s_and_b32 s70, s70, 7
  s_add_u32 s71, s63, 7
  s_and_b32 s71, s71, 7
  v_lshrrev_b32 v65, 4, v175
  v_bfe_u32 v66, v175, 2, 2
  v_and_b32 v67, 3, v175
  v_and_b32 v68, 15, v175
  v_mov_b32 v69, v0
  v_bfe_u32 v15, v175, 1, 3
  v_xor_b32 v15, v15, v65
  v_lshlrev_b32 v15, 4, v15
  v_lshl_add_u32 v15, v68, 7, v15
  s_add_u32 s78, s76, 65536
  v_add_u32 v160, s78, v15
  v_xor_b32 v161, 4096, v160
  v_xor_b32 v162, 64, v160
  v_xor_b32 v163, 4160, v160
  v_bfe_u32 v16, v175, 3, 2
  v_lshlrev_b32 v17, 1, s60
  v_xor_b32 v16, v16, v17
  v_lshlrev_b32 v16, 5, v16
  v_lshl_add_u32 v16, v67, 3, v16
  v_lshl_add_u32 v17, v65, 3, v66
  v_lshl_add_u32 v172, v17, 7, v16
  v_xor_b32 v173, 32, v172
  v_min_u32 v18, 1, v67
  v_mul_u32_u24 v18, 5184, v18
  v_lshl_add_u32 v18, v65, 4, v18
  v_add_u32 v174, 114688, v18
  v_mov_b32 v6, 0
  v_lshlrev_b32 v7, 2, v0
  v_add_u32 v7, 119872, v7
  ds_write_b32 v7, v6
  s_lshl2_add_u32 s78, s83, s58
  s_mov_b64 exec, 0
  s_cmp_eq_u32 s78, 0
  s_cbranch_scc1 L_pgK0
  s_cmp_eq_u32 s78, 1
  s_cbranch_scc1 L_pgK1
  s_cmp_eq_u32 s78, 2
  s_cbranch_scc1 L_pgK2
  s_cmp_eq_u32 s78, 3
  s_cbranch_scc1 L_pgK3
  s_cmp_eq_u32 s78, 4
  s_cbranch_scc1 L_pgQ0
  s_cmp_eq_u32 s78, 5
  s_cbranch_scc1 L_pgQ1
  s_cmp_eq_u32 s78, 6
  s_cbranch_scc1 L_pgQ2
  s_branch L_pgQ3
L_back:
  s_mov_b64 exec, -1
  s_cmp_eq_u32 s83, 1
  s_cbranch_scc1 L_typeQ
  s_branch L_typeK
.p2align 12
L_pgK0:
  s_cbranch_execz L_pgK4
L_typeK:
  s_mov_b32 m0, s87
  s_nop 0
  global_load_lds_dwordx4 v70, s[12:13]
  s_lshl_b32 s78, s65, 7
  s_add_u32 m0, s76, 81920
  s_nop 0
  buffer_load_dwordx4 v164, s[28:31], s78 offen offset:0 lds
  buffer_load_dwordx4 v165, s[28:31], s78 offen offset:1024 lds
  buffer_load_dwordx4 v166, s[28:31], s78 offen offset:2048 lds
  buffer_load_dwordx4 v167, s[28:31], s78 offen offset:3072 lds
  s_mul_i32 s79, s65, 196608
  s_add_u32 m0, s76, 16384
  s_nop 0
  buffer_load_dwordx4 v168, s[32:35], s79 offen offset:0 lds
  buffer_load_dwordx4 v169, s[32:35], s79 offen offset:1024 lds
  buffer_load_dwordx4 v170, s[32:35], s79 offen offset:2048 lds
  buffer_load_dwordx4 v171, s[32:35], s79 offen offset:3072 lds
  s_waitcnt vmcnt(9) lgkmcnt(0)
  s_barrier
  ds_read_b64_tr_b16 v[128:129], v172 offset:0
  ds_read_b64_tr_b16 v[130:131], v172 offset:512
  ds_read_b64_tr_b16 v[132:133], v172 offset:4096
  ds_read_b64_tr_b16 v[134:135], v172 offset:4608
  ds_read_b128 a[0:3], v160 offset:0
  ds_read_b128 a[16:19], v162 offset:0
  ds_read_b128 a[4:7], v160 offset:2048
  ds_read_b128 a[20:23], v162 offset:2048
  ds_read_b128 a[8:11], v161 offset:0
  ds_read_b128 a[24:27], v163 offset:0
  ds_read_b128 a[12:15], v161 offset:2048
  ds_read_b128 a[28:31], v163 offset:2048
  ds_read_b64_tr_b16 v[136:137], v173 offset:0
  ds_read_b64_tr_b16 v[138:139], v173 offset:512
  s_waitcnt lgkmcnt(9)
  v_mfma_f32_16x16x32_bf16 v[0:3], v[128:131], a[0:3], 0
  s_lshl_b32 s78, s66, 7
  ds_read_b64_tr_b16 v[140:141], v173 offset:4096
  s_mul_i32 s79, s66, 196608
  s_waitcnt lgkmcnt(9)
  v_mfma_f32_16x16x32_bf16 v[0:3], v[132:135], a[16:19], v[0:3]
  s_add_u32 m0, s76, 98304
  s_nop 0
  buffer_load_dwordx4 v164, s[28:31], s78 offen offset:0 lds
  s_waitcnt lgkmcnt(8)
  v_mfma_f32_16x16x32_bf16 v[8:11], v[128:131], a[4:7], 0
  ds_read_b64_tr_b16 v[142:143], v173 offset:4608
  s_waitcnt lgkmcnt(8)
  v_mfma_f32_16x16x32_bf16 v[8:11], v[132:135], a[20:23], v[8:11]
  s_waitcnt lgkmcnt(4)
  v_mfma_f32_16x16x32_bf16 v[16:19], v[128:131], a[8:11], 0
  ds_read_b64_tr_b16 v[112:113], v172 offset:8192
  buffer_load_dwordx4 v165, s[28:31], s78 offen offset:1024 lds
  v_mfma_f32_16x16x32_bf16 v[16:19], v[132:135], a[24:27], v[16:19]
  v_mfma_f32_16x16x32_bf16 v[24:27], v[128:131], a[12:15], 0
  ds_read_b64_tr_b16 v[114:115], v172 offset:8704
  buffer_load_dwordx4 v166, s[28:31], s78 offen offset:2048 lds
  v_mfma_f32_16x16x32_bf16 v[24:27], v[132:135], a[28:31], v[24:27]
  s_waitcnt lgkmcnt(2)
  s_mov_b64 s[52:53], s[24:25]
  s_movk_i32 s54, 256
  s_mov_b32 s55, 0x20000
  s_or_b32 s56, s56, 1
  s_lshl_b32 s77, s58, 13
  v_mov_b32 v72, s56
  v_lshl_add_u32 v73, s2, 8, v69
  v_lshlrev_b32 v73, 8, v73
  buffer_store_dword v72, v73, s[52:55], 0 offen sc1
  s_mov_b32 s24, 0xbdd2d3e8
  v_lshl_add_u32 v74, v65, 2, v66
  v_lshrrev_b32 v75, 1, v67
  v_lshl_add_u32 v75, s60, 1, v75
  v_mfma_f32_16x16x32_bf16 v[4:7], v[136:139], a[0:3], 0
  ds_read_b64_tr_b16 v[116:117], v172 offset:12288
  v_mfma_f32_16x16x32_bf16 v[4:7], v[140:143], a[16:19], v[4:7]
  buffer_load_dwordx4 v167, s[28:31], s78 offen offset:3072 lds
  v_mfma_f32_16x16x32_bf16 v[12:15], v[136:139], a[4:7], 0
  s_add_u32 m0, s76, 32768
  ds_read_b64_tr_b16 v[118:119], v172 offset:12800
  v_mfma_f32_16x16x32_bf16 v[12:15], v[140:143], a[20:23], v[12:15]
  buffer_load_dwordx4 v168, s[32:35], s79 offen offset:0 lds
  v_mfma_f32_16x16x32_bf16 v[20:23], v[136:139], a[8:11], 0
  ds_read_b64_tr_b16 v[128:129], v173 offset:8192
  v_mfma_f32_16x16x32_bf16 v[20:23], v[140:143], a[24:27], v[20:23]
  v_mfma_f32_16x16x32_bf16 v[28:31], v[136:139], a[12:15], 0
  ds_read_b64_tr_b16 v[130:131], v173 offset:8704
  buffer_load_dwordx4 v169, s[32:35], s79 offen offset:1024 lds
  v_mfma_f32_16x16x32_bf16 v[28:31], v[140:143], a[28:31], v[28:31]
  s_waitcnt lgkmcnt(2)
  v_lshlrev_b32 v75, 9, v75
  v_lshl_add_u32 v75, v74, 5, v75
  v_add_u32 v80, 115712, v75
  v_and_b32 v76, 1, v66
  v_mul_u32_u24 v76, 0x8000, v76
  v_lshl_or_b32 v76, v76, 16, v76
  v_bfe_i32 v77, v175, 3, 1
  v_bfe_u32 v78, v74, 1, 2
  v_lshlrev_b32 v78, 5, v78
  v_lshl_add_u32 v78, v67, 3, v78
  v_lshl_add_u32 v78, v74, 7, v78
  s_add_u32 s4, s77, 0x20000
  v_add_u32 v200, s4, v78
  v_mfma_f32_16x16x32_bf16 v[32:35], a[0:3], v[112:115], 0
  ds_read_b64_tr_b16 v[132:133], v173 offset:12288
  buffer_load_dwordx4 v170, s[32:35], s79 offen offset:2048 lds
  v_mfma_f32_16x16x32_bf16 v[32:35], a[16:19], v[116:119], v[32:35]
  v_mfma_f32_16x16x32_bf16 v[40:43], a[4:7], v[112:115], 0
  ds_read_b64_tr_b16 v[134:135], v173 offset:12800
  v_mfma_f32_16x16x32_bf16 v[40:43], a[20:23], v[116:119], v[40:43]
  buffer_load_dwordx4 v171, s[32:35], s79 offen offset:3072 lds
  v_mfma_f32_16x16x32_bf16 v[48:51], a[8:11], v[112:115], 0
  s_waitcnt vmcnt(9)
  s_barrier
  ds_read_b64_tr_b16 v[136:137], v172 offset:16384
  ds_read_b128 v[96:99], v174 offset:0
  ds_read_b128 v[100:103], v174 offset:64
  v_mfma_f32_16x16x32_bf16 v[48:51], a[24:27], v[116:119], v[48:51]
  s_lshl_b32 s78, s67, 7
  ds_read_b128 a[32:35], v160 offset:16384
  ds_read_b128 a[48:51], v162 offset:16384
  v_mfma_f32_16x16x32_bf16 v[56:59], a[12:15], v[112:115], 0
  s_mul_i32 s79, s67, 196608
  ds_read_b64_tr_b16 v[138:139], v172 offset:16896
  s_add_u32 m0, s76, 65536
  v_mfma_f32_16x16x32_bf16 v[56:59], a[28:31], v[116:119], v[56:59]
  s_waitcnt lgkmcnt(3)
  ds_read_b128 a[36:39], v160 offset:18432
  ds_read_b128 a[52:55], v162 offset:18432
  v_xor_b32 v201, 32, v200
  v_xor_b32 v202, 64, v200
  v_xor_b32 v203, 96, v200
  v_mov_b32 v206, 0xc0135761
  v_mov_b32 v207, 0x3fb8aa3b
  v_lshl_add_u32 v188, s60, 11, v183
  v_xor_b32 v189, 2048, v188
  v_lshl_add_u32 v190, s58, 10, v183
  v_xor_b32 v191, 1024, v190
  v_xor_b32 v204, 2048, v190
  v_xor_b32 v205, 3072, v190
  v_lshlrev_b32 v225, 3, v69
  v_add_u32 v225, 117760, v225
  s_lshl4_add_u32 s4, s62, s61
  v_mfma_f32_16x16x32_bf16 v[36:39], a[0:3], v[128:131], 0
  ds_read_b64_tr_b16 v[140:141], v172 offset:20480
  buffer_load_dwordx4 v164, s[28:31], s78 offen offset:0 lds
  v_mfma_f32_16x16x32_bf16 v[36:39], a[16:19], v[132:135], v[36:39]
  ds_read_b128 a[40:43], v161 offset:16384
  v_mfma_f32_16x16x32_bf16 v[44:47], a[4:7], v[128:131], 0
  ds_read_b64_tr_b16 v[142:143], v172 offset:20992
  v_mfma_f32_16x16x32_bf16 v[44:47], a[20:23], v[132:135], v[44:47]
  ds_read_b128 a[56:59], v163 offset:16384
  v_mfma_f32_16x16x32_bf16 v[52:55], a[8:11], v[128:131], 0
  ds_read_b64_tr_b16 v[112:113], v173 offset:16384
  v_mfma_f32_16x16x32_bf16 v[52:55], a[24:27], v[132:135], v[52:55]
  ds_read_b128 a[44:47], v161 offset:18432
  ds_read_b128 a[60:63], v163 offset:18432
  v_mfma_f32_16x16x32_bf16 v[60:63], a[12:15], v[128:131], 0
  ds_read_b64_tr_b16 v[114:115], v173 offset:16896
  buffer_load_dwordx4 v165, s[28:31], s78 offen offset:1024 lds
  v_mfma_f32_16x16x32_bf16 v[60:63], a[28:31], v[132:135], v[60:63]
  s_waitcnt lgkmcnt(5)
  s_lshl_b32 s4, s4, 7
  s_add_u32 s4, s4, 11075584
  v_lshlrev_b32 v79, 24, v69
  v_min_u32 v79, 2147483392, v79
  v_max_u32 v182, s4, v79
  v_lshl_add_u32 v78, v65, 3, v66
  v_and_b32 v75, 1, v65
  v_lshlrev_b32 v79, 5, v75
  v_lshl_add_u32 v79, v67, 3, v79
  v_lshl_add_u32 v196, v78, 6, v79
  v_xor_b32 v197, 32, v196
  v_lshl_add_u32 v78, s60, 13, v183
  v_add_u32 v78, 98304, v78
  v_mfma_f32_16x16x32_bf16 v[216:219], v[96:99], a[0:3], 0
  v_mfma_f32_16x16x32_bf16 v[216:219], v[100:103], a[16:19], v[216:219]
  v_mfma_f32_16x16x32_bf16 v[220:223], v[96:99], a[4:7], 0
  buffer_load_dwordx4 v166, s[28:31], s78 offen offset:2048 lds
  v_mfma_f32_16x16x32_bf16 v[220:223], v[100:103], a[20:23], v[220:223]
  v_mfma_f32_16x16x32_bf16 v[0:3], v[136:139], a[32:35], v[0:3]
  ds_read_b64_tr_b16 v[116:117], v173 offset:20480
  v_mfma_f32_16x16x32_bf16 v[0:3], v[140:143], a[48:51], v[0:3]
  ds_read_b128 v[104:107], v174 offset:128
  ds_read_b128 v[108:111], v174 offset:192
  v_mfma_f32_16x16x32_bf16 v[8:11], v[136:139], a[36:39], v[8:11]
  ds_read_b64_tr_b16 v[118:119], v173 offset:20992
  v_mfma_f32_16x16x32_bf16 v[8:11], v[140:143], a[52:55], v[8:11]
  s_waitcnt lgkmcnt(5)
  buffer_load_dwordx4 v167, s[28:31], s78 offen offset:3072 lds
  v_mfma_f32_16x16x32_bf16 v[16:19], v[136:139], a[40:43], v[16:19]
  s_add_u32 m0, s76, 49152
  ds_read_b64_tr_b16 v[128:129], v172 offset:24576
  v_mfma_f32_16x16x32_bf16 v[16:19], v[140:143], a[56:59], v[16:19]
  v_mfma_f32_16x16x32_bf16 v[24:27], v[136:139], a[44:47], v[24:27]
  ds_read_b64_tr_b16 v[130:131], v172 offset:25088
  v_mfma_f32_16x16x32_bf16 v[24:27], v[140:143], a[60:63], v[24:27]
  s_waitcnt lgkmcnt(2)
  buffer_load_dwordx4 v168, s[32:35], s79 offen offset:0 lds
  v_lshl_add_u32 v226, s59, 11, v78
  v_lshl_add_u32 v227, s59, 12, v78
  v_and_b32 v78, 2, v175
  v_and_or_b32 v78, v66, 1, v78
  v_lshlrev_b32 v79, 1, v75
  v_xor_b32 v78, v78, v79
  v_lshlrev_b32 v78, 4, v78
  v_lshl_add_u32 v78, v68, 6, v78
  v_lshrrev_b32 v79, 5, v175
  v_lshl_add_u32 v78, v79, 13, v78
  s_lshl2_add_u32 s4, s60, s59
  s_lshl_b32 s4, s4, 12
  s_add_u32 s4, s4, 65536
  v_add_u32 v228, s4, v78
  v_mfma_f32_16x16x32_bf16 v[4:7], v[112:115], a[32:35], v[4:7]
  ds_read_b64_tr_b16 v[132:133], v172 offset:28672
  v_mfma_f32_16x16x32_bf16 v[4:7], v[116:119], a[48:51], v[4:7]
  v_mfma_f32_16x16x32_bf16 v[12:15], v[112:115], a[36:39], v[12:15]
  ds_read_b64_tr_b16 v[134:135], v172 offset:29184
  v_mfma_f32_16x16x32_bf16 v[12:15], v[116:119], a[52:55], v[12:15]
  v_mfma_f32_16x16x32_bf16 v[20:23], v[112:115], a[40:43], v[20:23]
  ds_read_b64_tr_b16 v[136:137], v173 offset:24576
  buffer_load_dwordx4 v169, s[32:35], s79 offen offset:1024 lds
  v_mfma_f32_16x16x32_bf16 v[20:23], v[116:119], a[56:59], v[20:23]
  v_mfma_f32_16x16x32_bf16 v[28:31], v[112:115], a[44:47], v[28:31]
  ds_read_b64_tr_b16 v[138:139], v173 offset:25088
  v_mfma_f32_16x16x32_bf16 v[28:31], v[116:119], a[60:63], v[28:31]
  s_waitcnt lgkmcnt(2)
  v_xor_b32 v229, 16, v228
  v_and_or_b32 v78, v66, 2, v75
  v_lshlrev_b32 v79, 1, v67
  v_and_b32 v79, 2, v79
  v_xor_b32 v78, v78, v79
  v_lshlrev_b32 v78, 4, v78
  v_lshl_add_u32 v78, v74, 6, v78
  v_and_b32 v79, 2, v67
  v_lshl_add_u32 v78, v79, 2, v78
  s_lshl1_add_u32 s4, s60, s59
  s_lshl_b32 s4, s4, 13
  s_add_u32 s4, s4, 65536
  v_add_u32 v230, s4, v78
  v_mfma_f32_16x16x32_bf16 v[216:219], v[104:107], a[32:35], v[216:219]
  buffer_load_dwordx4 v170, s[32:35], s79 offen offset:2048 lds
  v_mfma_f32_16x16x32_bf16 v[216:219], v[108:111], a[48:51], v[216:219]
  v_mfma_f32_16x16x32_bf16 v[32:35], a[32:35], v[128:131], v[32:35]
  ds_read_b64_tr_b16 v[140:141], v173 offset:28672
  v_mfma_f32_16x16x32_bf16 v[32:35], a[48:51], v[132:135], v[32:35]
  v_mfma_f32_16x16x32_bf16 v[40:43], a[36:39], v[128:131], v[40:43]
  ds_read_b64_tr_b16 v[142:143], v173 offset:29184
  v_mfma_f32_16x16x32_bf16 v[40:43], a[52:55], v[132:135], v[40:43]
  buffer_load_dwordx4 v171, s[32:35], s79 offen offset:3072 lds
  v_mfma_f32_16x16x32_bf16 v[48:51], a[40:43], v[128:131], v[48:51]
  s_waitcnt vmcnt(8)
  s_barrier
  ds_read_b64_tr_b16 v[112:113], v172 offset:32768
  v_mfma_f32_16x16x32_bf16 v[48:51], a[56:59], v[132:135], v[48:51]
  s_lshl_b32 s78, s68, 7
  ds_read_b128 a[64:67], v160 offset:32768
  ds_read_b128 a[80:83], v162 offset:32768
  s_add_u32 m0, s76, 81920
  v_mfma_f32_16x16x32_bf16 v[56:59], a[44:47], v[128:131], v[56:59]
  s_mul_i32 s79, s68, 196608
  ds_read_b64_tr_b16 v[114:115], v172 offset:33280
  buffer_load_dwordx4 v164, s[28:31], s78 offen offset:0 lds
  v_mfma_f32_16x16x32_bf16 v[56:59], a[60:63], v[132:135], v[56:59]
  s_waitcnt lgkmcnt(4)
  ds_read_b128 a[68:71], v160 offset:34816
  ds_read_b128 a[84:87], v162 offset:34816
  v_xor_b32 v231, 16, v230
  v_lshlrev_b32 v78, 26, v68
  v_max_u32 v232, v78, v183
  v_mov_b32 v212, 0x3f803f80
  v_mov_b32 v213, 0x3f803f80
  v_mov_b32 v214, 0x3f803f80
  v_mov_b32 v215, 0x3f803f80
  ds_read_b64_tr_b16 v[236:237], v80 offset:0
  ds_read_b64_tr_b16 v[240:241], v80 offset:8
  ds_read_b64_tr_b16 v[244:245], v80 offset:16
  ds_read_b64_tr_b16 v[248:249], v80 offset:24
  s_mov_b64 s[36:37], s[26:27]
  s_mov_b32 s38, 12582912
  s_mov_b32 s39, 0x20000
  v_mfma_f32_16x16x32_bf16 v[36:39], a[32:35], v[136:139], v[36:39]
  ds_read_b64_tr_b16 v[116:117], v172 offset:36864
  v_mfma_f32_16x16x32_bf16 v[36:39], a[48:51], v[140:143], v[36:39]
  ds_read_b128 a[72:75], v161 offset:32768
  v_mfma_f32_16x16x32_bf16 v[44:47], a[36:39], v[136:139], v[44:47]
  ds_read_b64_tr_b16 v[118:119], v172 offset:37376
  buffer_load_dwordx4 v165, s[28:31], s78 offen offset:1024 lds
  v_mfma_f32_16x16x32_bf16 v[44:47], a[52:55], v[140:143], v[44:47]
  ds_read_b128 a[88:91], v163 offset:32768
  v_mfma_f32_16x16x32_bf16 v[52:55], a[40:43], v[136:139], v[52:55]
  ds_read_b64_tr_b16 v[128:129], v173 offset:32768
  v_mfma_f32_16x16x32_bf16 v[52:55], a[56:59], v[140:143], v[52:55]
  ds_read_b128 a[76:79], v161 offset:34816
  ds_read_b128 a[92:95], v163 offset:34816
  v_mfma_f32_16x16x32_bf16 v[60:63], a[44:47], v[136:139], v[60:63]
  ds_read_b64_tr_b16 v[130:131], v173 offset:33280
  buffer_load_dwordx4 v166, s[28:31], s78 offen offset:2048 lds
  v_mfma_f32_16x16x32_bf16 v[60:63], a[60:63], v[140:143], v[60:63]
  s_waitcnt lgkmcnt(5)
  s_lshl_b32 s97, s61, 7
  s_add_u32 s98, s97, 0
  s_add_u32 s80, s84, s98
  s_addc_u32 s81, s85, 0
  s_sub_u32 s82, 1835008, s98
  s_lshl_b32 s98, s61, 6
  s_add_u32 s98, s98, 1024
  s_add_u32 s84, s84, s98
  s_addc_u32 s85, s85, 0
  s_sub_u32 s86, 1835008, s98
  s_add_u32 s97, s63, s60
  s_add_u32 s72, s97, 0
  s_and_b32 s72, s72, 7
  v_mfma_f32_16x16x32_bf16 v[220:223], v[104:107], a[36:39], v[220:223]
  v_mfma_f32_16x16x32_bf16 v[220:223], v[108:111], a[52:55], v[220:223]
  v_mfma_f32_16x16x32_bf16 v[0:3], v[112:115], a[64:67], v[0:3]
  ds_read_b64_tr_b16 v[132:133], v173 offset:36864
  buffer_load_dwordx4 v167, s[28:31], s78 offen offset:3072 lds
  v_mfma_f32_16x16x32_bf16 v[0:3], v[116:119], a[80:83], v[0:3]
  s_add_u32 m0, s76, 0
  ds_read_b128 v[96:99], v174 offset:256
  ds_read_b128 v[100:103], v174 offset:320
  v_mfma_f32_16x16x32_bf16 v[8:11], v[112:115], a[68:71], v[8:11]
  s_cmp_eq_u32 s60, 0
  s_cselect_b64 s[12:13], s[6:7], s[14:15]
  s_cselect_b64 s[20:21], s[16:17], s[18:19]
  s_cmp_eq_u32 s59, 0
  s_cselect_b64 s[12:13], s[12:13], s[20:21]
  ds_read_b64_tr_b16 v[134:135], v173 offset:37376
  v_mfma_f32_16x16x32_bf16 v[8:11], v[116:119], a[84:87], v[8:11]
  s_waitcnt lgkmcnt(5)
  s_cmp_eq_u32 s58, 0
  s_movk_i32 s20, 1024
  s_cselect_b32 s20, 3072, s20
  s_cselect_b32 s21, 2, 3
  s_cselect_b32 s5, 0, 524288
  s_cmp_eq_u32 s59, s60
  s_cselect_b32 s20, s20, 3584
  s_cselect_b32 s21, s21, 2
  s_cselect_b32 s5, s5, 1024
  s_cselect_b32 s3, 3, 2
  v_mfma_f32_16x16x32_bf16 v[16:19], v[112:115], a[72:75], v[16:19]
  ds_read_b64_tr_b16 v[136:137], v172 offset:40960
  buffer_load_dwordx4 v168, s[32:35], s79 offen offset:0 lds
  v_mfma_f32_16x16x32_bf16 v[16:19], v[116:119], a[88:91], v[16:19]
  v_lshrrev_b32 v87, s3, v175
  v_lshlrev_b32 v86, s3, v87
  v_mfma_f32_16x16x32_bf16 v[24:27], v[112:115], a[76:79], v[24:27]
  ds_read_b64_tr_b16 v[138:139], v172 offset:41472
  v_sub_u32 v86, v175, v86
  v_lshl_add_u32 v86, v86, 7, s5
  v_mfma_f32_16x16x32_bf16 v[24:27], v[116:119], a[92:95], v[24:27]
  s_waitcnt lgkmcnt(2)
  s_add_u32 s73, s97, 2
  s_and_b32 s73, s73, 7
  s_add_u32 s74, s97, 4
  s_and_b32 s74, s74, 7
  s_add_u32 s75, s97, 6
  s_and_b32 s75, s75, 7
  s_lshl1_add_u32 s97, s62, s59
  s_mul_i32 s97, s97, 294912
  s_lshl1_add_u32 s98, s61, s60
  s_lshl_b32 s99, s98, 12
  s_add_u32 s88, s99, s97
  s_lshl_b32 s99, s61, 12
  s_add_u32 s99, s99, s97
  v_mfma_f32_16x16x32_bf16 v[4:7], v[128:131], a[64:67], v[4:7]
  s_mul_i32 s5, s21, s2
  ds_read_b64_tr_b16 v[140:141], v172 offset:45056
  buffer_load_dwordx4 v169, s[32:35], s79 offen offset:1024 lds
  v_mfma_f32_16x16x32_bf16 v[4:7], v[132:135], a[80:83], v[4:7]
  s_sub_u32 s21, s21, 1
  v_min_u32 v87, s21, v87
  v_add_u32 v87, s5, v87
  v_mad_u32_u24 v87, v87, s20, v86
  v_mfma_f32_16x16x32_bf16 v[12:15], v[128:131], a[68:71], v[12:15]
  ds_read_b64_tr_b16 v[142:143], v172 offset:45568
  v_mfma_f32_16x16x32_bf16 v[12:15], v[132:135], a[84:87], v[12:15]
  v_mfma_f32_16x16x32_bf16 v[20:23], v[128:131], a[72:75], v[20:23]
  ds_read_b64_tr_b16 v[112:113], v173 offset:40960
  buffer_load_dwordx4 v170, s[32:35], s79 offen offset:2048 lds
  v_mfma_f32_16x16x32_bf16 v[20:23], v[132:135], a[88:91], v[20:23]
  v_mfma_f32_16x16x32_bf16 v[28:31], v[128:131], a[76:79], v[28:31]
  ds_read_b64_tr_b16 v[114:115], v173 offset:41472
  v_mfma_f32_16x16x32_bf16 v[28:31], v[132:135], a[92:95], v[28:31]
  s_waitcnt lgkmcnt(2)
  s_add_u32 s89, s99, 65536
  s_bfe_u32 s99, s2, 196611
  s_xor_b32 s97, s99, s83
  s_and_b32 s97, s97, 1
  s_bfe_u32 s98, s2, 65542
  s_lshl1_add_u32 s97, s98, s97
  s_and_b32 s90, s2, 7
  s_lshl2_add_u32 s97, s90, s97
  s_lshr_b32 s90, s99, 1
  s_add_u32 s98, s98, s90
  s_lshl1_add_u32 s90, s58, s98
  s_add_u32 s91, s90, 1
  s_add_u32 s92, s58, s98
  s_and_b32 s92, s92, 3
  v_mfma_f32_16x16x32_bf16 v[216:219], v[96:99], a[64:67], v[216:219]
  buffer_load_dwordx4 v171, s[32:35], s79 offen offset:3072 lds
  v_mfma_f32_16x16x32_bf16 v[216:219], v[100:103], a[80:83], v[216:219]
  v_mfma_f32_16x16x32_bf16 v[32:35], a[64:67], v[136:139], v[32:35]
  ds_read_b64_tr_b16 v[116:117], v173 offset:45056
  v_mfma_f32_16x16x32_bf16 v[32:35], a[80:83], v[140:143], v[32:35]
  v_mfma_f32_16x16x32_bf16 v[40:43], a[68:71], v[136:139], v[40:43]
  ds_read_b64_tr_b16 v[118:119], v173 offset:45568
  global_load_dword v85, v87, s[12:13]
  v_mfma_f32_16x16x32_bf16 v[40:43], a[84:87], v[140:143], v[40:43]
  v_mfma_f32_16x16x32_bf16 v[48:51], a[72:75], v[136:139], v[48:51]
  s_waitcnt vmcnt(9)
  s_barrier
  ds_read_b64_tr_b16 v[128:129], v172 offset:49152
  v_mfma_f32_16x16x32_bf16 v[48:51], a[88:91], v[140:143], v[48:51]
  s_lshl_b32 s78, s69, 7
  ds_read_b128 a[96:99], v160 offset:0
  ds_read_b128 a[112:115], v162 offset:0
  s_add_u32 m0, s76, 98304
  v_mfma_f32_16x16x32_bf16 v[56:59], a[76:79], v[136:139], v[56:59]
  s_mul_i32 s79, s69, 196608
  ds_read_b64_tr_b16 v[130:131], v172 offset:49664
  buffer_load_dwordx4 v164, s[28:31], s78 offen offset:0 lds
  v_mfma_f32_16x16x32_bf16 v[56:59], a[92:95], v[140:143], v[56:59]
  s_waitcnt lgkmcnt(4)
  ds_read_b128 a[100:103], v160 offset:2048
  ds_read_b128 a[116:119], v162 offset:2048
  v_and_b32 v181, 1, v175
  v_add_u32 v180, s90, v181
  v_and_b32 v180, 7, v180
  v_lshlrev_b32 v180, 7, v180
  v_lshl_add_u32 v181, s92, 1, v181
  v_lshlrev_b32 v181, 7, v181
  s_and_b32 s90, s90, 7
  s_and_b32 s91, s91, 7
  s_mul_i32 s98, s97, 36
  s_add_u32 s93, s90, s98
  s_lshl_b32 s93, s93, 13
  s_lshl_b32 s90, s90, 16
  s_add_u32 s94, s91, s98
  v_mfma_f32_16x16x32_bf16 v[36:39], a[64:67], v[112:115], v[36:39]
  ds_read_b64_tr_b16 v[132:133], v172 offset:53248
  v_mfma_f32_16x16x32_bf16 v[36:39], a[80:83], v[116:119], v[36:39]
  ds_read_b128 a[104:107], v161 offset:0
  v_mfma_f32_16x16x32_bf16 v[44:47], a[68:71], v[112:115], v[44:47]
  ds_read_b64_tr_b16 v[134:135], v172 offset:53760
  v_mfma_f32_16x16x32_bf16 v[44:47], a[84:87], v[116:119], v[44:47]
  ds_read_b128 a[120:123], v163 offset:0
  buffer_load_dwordx4 v165, s[28:31], s78 offen offset:1024 lds
  v_mfma_f32_16x16x32_bf16 v[52:55], a[72:75], v[112:115], v[52:55]
  ds_read_b64_tr_b16 v[136:137], v173 offset:49152
  v_mfma_f32_16x16x32_bf16 v[52:55], a[88:91], v[116:119], v[52:55]
  ds_read_b128 a[108:111], v161 offset:2048
  ds_read_b128 a[124:127], v163 offset:2048
  v_mfma_f32_16x16x32_bf16 v[60:63], a[76:79], v[112:115], v[60:63]
  ds_read_b64_tr_b16 v[138:139], v173 offset:49664
  v_mfma_f32_16x16x32_bf16 v[60:63], a[92:95], v[116:119], v[60:63]
  s_waitcnt lgkmcnt(5)
  buffer_load_dwordx4 v166, s[28:31], s78 offen offset:2048 lds
  s_lshl_b32 s94, s94, 13
  s_lshl_b32 s91, s91, 16
  s_add_u32 s95, s92, s98
  s_lshl_b32 s95, s95, 13
  s_lshl_b32 s92, s92, 16
  s_lshr_b32 s96, s97, 1
  s_lshl_b32 s96, s96, 11
  s_add_u32 s96, s96, 11075584
  s_lshl_b32 s99, s99, 7
  s_add_u32 s40, s18, s99
  s_addc_u32 s41, s19, 0
  s_sub_u32 s42, 1835008, s99
  s_mov_b32 s43, 0x20000
  s_add_u32 s44, s10, s99
  s_addc_u32 s45, s11, 0
  v_mfma_f32_16x16x32_bf16 v[220:223], v[96:99], a[68:71], v[220:223]
  v_mfma_f32_16x16x32_bf16 v[220:223], v[100:103], a[84:87], v[220:223]
  v_mfma_f32_16x16x32_bf16 v[0:3], v[128:131], a[96:99], v[0:3]
  ds_read_b64_tr_b16 v[140:141], v173 offset:53248
  v_mfma_f32_16x16x32_bf16 v[0:3], v[132:135], a[112:115], v[0:3]
  ds_read_b128 v[104:107], v174 offset:384
  ds_read_b128 v[108:111], v174 offset:448
  v_mfma_f32_16x16x32_bf16 v[8:11], v[128:131], a[100:103], v[8:11]
  ds_read_b64_tr_b16 v[142:143], v173 offset:53760
  buffer_load_dwordx4 v167, s[28:31], s78 offen offset:3072 lds
  v_mfma_f32_16x16x32_bf16 v[8:11], v[132:135], a[116:119], v[8:11]
  s_waitcnt lgkmcnt(5)
  v_mfma_f32_16x16x32_bf16 v[16:19], v[128:131], a[104:107], v[16:19]
  s_add_u32 m0, s76, 16384
  ds_read_b64_tr_b16 v[112:113], v172 offset:57344
  v_mfma_f32_16x16x32_bf16 v[16:19], v[132:135], a[120:123], v[16:19]
  v_mfma_f32_16x16x32_bf16 v[24:27], v[128:131], a[108:111], v[24:27]
  ds_read_b64_tr_b16 v[114:115], v172 offset:57856
  buffer_load_dwordx4 v168, s[32:35], s79 offen offset:0 lds
  v_mfma_f32_16x16x32_bf16 v[24:27], v[132:135], a[124:127], v[24:27]
  s_waitcnt lgkmcnt(2)
  s_sub_u32 s46, 524288, s99
  s_mov_b32 s47, 0x20000
  s_lshl_b32 s97, s97, 16
  s_add_u32 s97, s97, s99
  s_add_u32 s48, s22, s97
  s_addc_u32 s49, s23, 0
  s_sub_u32 s50, 2097152, s97
  s_mov_b32 s51, 0x20000
  v_bitop3_b32 v238, v236, v76, v77 bitop3:0x28
  v_bitop3_b32 v236, v236, v76, v77 bitop3:0x14
  v_bitop3_b32 v239, v237, v76, v77 bitop3:0x28
  v_bitop3_b32 v237, v237, v76, v77 bitop3:0x14
  v_mfma_f32_16x16x32_bf16 v[4:7], v[136:139], a[96:99], v[4:7]
  ds_read_b64_tr_b16 v[116:117], v172 offset:61440
  v_mfma_f32_16x16x32_bf16 v[4:7], v[140:143], a[112:115], v[4:7]
  v_mfma_f32_16x16x32_bf16 v[12:15], v[136:139], a[100:103], v[12:15]
  ds_read_b64_tr_b16 v[118:119], v172 offset:61952
  v_mfma_f32_16x16x32_bf16 v[12:15], v[140:143], a[116:119], v[12:15]
  buffer_load_dwordx4 v169, s[32:35], s79 offen offset:1024 lds
  v_mfma_f32_16x16x32_bf16 v[20:23], v[136:139], a[104:107], v[20:23]
  ds_read_b64_tr_b16 v[128:129], v173 offset:57344
  v_mfma_f32_16x16x32_bf16 v[20:23], v[140:143], a[120:123], v[20:23]
  v_mfma_f32_16x16x32_bf16 v[28:31], v[136:139], a[108:111], v[28:31]
  ds_read_b64_tr_b16 v[130:131], v173 offset:57856
  v_mfma_f32_16x16x32_bf16 v[28:31], v[140:143], a[124:127], v[28:31]
  s_waitcnt lgkmcnt(2)
  buffer_load_dwordx4 v170, s[32:35], s79 offen offset:2048 lds
  v_bitop3_b32 v242, v240, v76, v77 bitop3:0x28
  v_bitop3_b32 v240, v240, v76, v77 bitop3:0x14
  v_bitop3_b32 v243, v241, v76, v77 bitop3:0x28
  v_bitop3_b32 v241, v241, v76, v77 bitop3:0x14
  v_bitop3_b32 v246, v244, v76, v77 bitop3:0x28
  v_bitop3_b32 v244, v244, v76, v77 bitop3:0x14
  v_bitop3_b32 v247, v245, v76, v77 bitop3:0x28
  v_bitop3_b32 v245, v245, v76, v77 bitop3:0x14
  v_bitop3_b32 v250, v248, v76, v77 bitop3:0x28
  v_bitop3_b32 v248, v248, v76, v77 bitop3:0x14
  v_bitop3_b32 v251, v249, v76, v77 bitop3:0x28
  v_bitop3_b32 v249, v249, v76, v77 bitop3:0x14
  s_lshl1_add_u32 s97, s61, s60
  s_lshl1_add_u32 s97, s97, s59
  v_mfma_f32_16x16x32_bf16 v[216:219], v[104:107], a[96:99], v[216:219]
  v_mfma_f32_16x16x32_bf16 v[216:219], v[108:111], a[112:115], v[216:219]
  v_mfma_f32_16x16x32_bf16 v[32:35], a[96:99], v[112:115], v[32:35]
  ds_read_b64_tr_b16 v[132:133], v173 offset:61440
  v_mfma_f32_16x16x32_bf16 v[32:35], a[112:115], v[116:119], v[32:35]
  v_mfma_f32_16x16x32_bf16 v[40:43], a[100:103], v[112:115], v[40:43]
  ds_read_b64_tr_b16 v[134:135], v173 offset:61952
  buffer_load_dwordx4 v171, s[32:35], s79 offen offset:3072 lds
  v_mfma_f32_16x16x32_bf16 v[40:43], a[116:119], v[116:119], v[40:43]
  v_mfma_f32_16x16x32_bf16 v[48:51], a[104:107], v[112:115], v[48:51]
  s_waitcnt vmcnt(9)
  s_barrier
  ds_read_b64_tr_b16 v[136:137], v172 offset:0
  v_mfma_f32_16x16x32_bf16 v[48:51], a[120:123], v[116:119], v[48:51]
  s_lshl_b32 s78, s70, 7
  ds_read_b128 a[128:131], v160 offset:16384
  ds_read_b128 a[144:147], v162 offset:16384
  s_add_u32 m0, s76, 65536
  v_mfma_f32_16x16x32_bf16 v[56:59], a[108:111], v[112:115], v[56:59]
  s_mul_i32 s79, s70, 196608
  ds_read_b64_tr_b16 v[138:139], v172 offset:512
  buffer_load_dwordx4 v164, s[28:31], s78 offen offset:0 lds
  v_mfma_f32_16x16x32_bf16 v[56:59], a[124:127], v[116:119], v[56:59]
  s_waitcnt lgkmcnt(4)
  ds_read_b128 a[132:135], v160 offset:18432
  ds_read_b128 a[148:151], v162 offset:18432
  s_mov_b32 s57, 0
  s_lshl4_add_u32 s98, s97, s62
  s_lshl_b32 s98, s98, 10
  s_add_u32 s25, s98, 10485760
  s_lshl_b32 s97, s97, 10
  s_lshl4_add_u32 s97, s62, s97
  s_add_u32 s26, s97, 11010048
  v_lshrrev_b32 v93, 2, v175
  v_mul_u32_u24 v93, 3584, v93
  v_and_b32 v94, 3, v175
  v_lshrrev_b32 v95, 4, v175
  v_and_b32 v95, 2, v95
  v_xor_b32 v94, v94, v95
  v_mfma_f32_16x16x32_bf16 v[36:39], a[96:99], v[128:131], v[36:39]
  ds_read_b64_tr_b16 v[140:141], v172 offset:4096
  v_mfma_f32_16x16x32_bf16 v[36:39], a[112:115], v[132:135], v[36:39]
  ds_read_b128 a[136:139], v161 offset:16384
  v_mfma_f32_16x16x32_bf16 v[44:47], a[100:103], v[128:131], v[44:47]
  ds_read_b64_tr_b16 v[142:143], v172 offset:4608
  v_mfma_f32_16x16x32_bf16 v[44:47], a[116:119], v[132:135], v[44:47]
  ds_read_b128 a[152:155], v163 offset:16384
  buffer_load_dwordx4 v165, s[28:31], s78 offen offset:1024 lds
  v_mfma_f32_16x16x32_bf16 v[52:55], a[104:107], v[128:131], v[52:55]
  ds_read_b64_tr_b16 v[112:113], v173 offset:0
  v_mfma_f32_16x16x32_bf16 v[52:55], a[120:123], v[132:135], v[52:55]
  ds_read_b128 a[140:143], v161 offset:18432
  ds_read_b128 a[156:159], v163 offset:18432
  v_mfma_f32_16x16x32_bf16 v[60:63], a[108:111], v[128:131], v[60:63]
  ds_read_b64_tr_b16 v[114:115], v173 offset:512
  v_mfma_f32_16x16x32_bf16 v[60:63], a[124:127], v[132:135], v[60:63]
  s_waitcnt lgkmcnt(5)
  buffer_load_dwordx4 v166, s[28:31], s78 offen offset:2048 lds
  v_lshl_add_u32 v92, v94, 4, v93
  v_add_u32 v93, 56320, v92
  v_add_u32 v94, 112640, v92
  v_add_u32 v95, 168960, v92
  s_bfe_u32 s3, s2, 196611
  s_mul_i32 s3, s3, 229376
  s_mul_i32 s97, s60, 2560
  s_add_u32 s3, s3, s97
  v_mul_u32_u24 v233, 3584, v175
  v_add_u32 v233, s3, v233
L_pgK1:
  s_cbranch_execz L_pgK5
  s_lshl2_add_u32 s3, s2, s58
  s_mul_i32 s3, s3, 14
  v_min_u32 v89, 13, v175
  v_add_lshl_u32 v89, v89, s3, 7
  v_mfma_f32_16x16x32_bf16 v[220:223], v[104:107], a[100:103], v[220:223]
  v_mfma_f32_16x16x32_bf16 v[220:223], v[108:111], a[116:119], v[220:223]
  v_mfma_f32_16x16x32_bf16 v[0:3], v[136:139], a[128:131], v[0:3]
  ds_read_b64_tr_b16 v[116:117], v173 offset:4096
  v_mfma_f32_16x16x32_bf16 v[0:3], v[140:143], a[144:147], v[0:3]
  ds_read_b128 v[96:99], v174 offset:512
  ds_read_b128 v[100:103], v174 offset:576
  v_mfma_f32_16x16x32_bf16 v[8:11], v[136:139], a[132:135], v[8:11]
  ds_read_b64_tr_b16 v[118:119], v173 offset:4608
  buffer_load_dwordx4 v167, s[28:31], s78 offen offset:3072 lds
  v_mfma_f32_16x16x32_bf16 v[8:11], v[140:143], a[148:151], v[8:11]
  s_waitcnt lgkmcnt(5)
  v_mfma_f32_16x16x32_bf16 v[16:19], v[136:139], a[136:139], v[16:19]
  s_add_u32 m0, s76, 32768
  ds_read_b64_tr_b16 v[128:129], v172 offset:8192
  v_mfma_f32_16x16x32_bf16 v[16:19], v[140:143], a[152:155], v[16:19]
  v_mfma_f32_16x16x32_bf16 v[24:27], v[136:139], a[140:143], v[24:27]
  ds_read_b64_tr_b16 v[130:131], v172 offset:8704
  buffer_load_dwordx4 v168, s[32:35], s79 offen offset:0 lds
  v_mfma_f32_16x16x32_bf16 v[24:27], v[140:143], a[156:159], v[24:27]
  s_waitcnt lgkmcnt(2)
  v_mfma_f32_16x16x32_bf16 v[4:7], v[112:115], a[128:131], v[4:7]
  ds_read_b64_tr_b16 v[132:133], v172 offset:12288
  v_mfma_f32_16x16x32_bf16 v[4:7], v[116:119], a[144:147], v[4:7]
  v_mfma_f32_16x16x32_bf16 v[12:15], v[112:115], a[132:135], v[12:15]
  ds_read_b64_tr_b16 v[134:135], v172 offset:12800
  v_mfma_f32_16x16x32_bf16 v[12:15], v[116:119], a[148:151], v[12:15]
  buffer_load_dwordx4 v169, s[32:35], s79 offen offset:1024 lds
  v_mfma_f32_16x16x32_bf16 v[20:23], v[112:115], a[136:139], v[20:23]
  ds_read_b64_tr_b16 v[136:137], v173 offset:8192
  v_mfma_f32_16x16x32_bf16 v[20:23], v[116:119], a[152:155], v[20:23]
  v_mfma_f32_16x16x32_bf16 v[28:31], v[112:115], a[140:143], v[28:31]
  ds_read_b64_tr_b16 v[138:139], v173 offset:8704
  v_mfma_f32_16x16x32_bf16 v[28:31], v[116:119], a[156:159], v[28:31]
  s_waitcnt lgkmcnt(2)
  buffer_load_dwordx4 v170, s[32:35], s79 offen offset:2048 lds
  v_mfma_f32_16x16x32_bf16 v[216:219], v[96:99], a[128:131], v[216:219]
  v_mfma_f32_16x16x32_bf16 v[216:219], v[100:103], a[144:147], v[216:219]
  v_mfma_f32_16x16x32_bf16 v[32:35], a[128:131], v[128:131], v[32:35]
  ds_read_b64_tr_b16 v[140:141], v173 offset:12288
  v_mfma_f32_16x16x32_bf16 v[32:35], a[144:147], v[132:135], v[32:35]
  v_mfma_f32_16x16x32_bf16 v[40:43], a[132:135], v[128:131], v[40:43]
  ds_read_b64_tr_b16 v[142:143], v173 offset:12800
  buffer_load_dwordx4 v171, s[32:35], s79 offen offset:3072 lds
  v_mfma_f32_16x16x32_bf16 v[40:43], a[148:151], v[132:135], v[40:43]
  v_mfma_f32_16x16x32_bf16 v[48:51], a[136:139], v[128:131], v[48:51]
  s_waitcnt vmcnt(8)
  s_barrier
  ds_read_b64_tr_b16 v[112:113], v172 offset:16384
  v_mfma_f32_16x16x32_bf16 v[48:51], a[152:155], v[132:135], v[48:51]
  s_lshl_b32 s78, s71, 7
  ds_read_b128 a[160:163], v160 offset:32768
  ds_read_b128 a[176:179], v162 offset:32768
  s_add_u32 m0, s76, 81920
  v_mfma_f32_16x16x32_bf16 v[56:59], a[140:143], v[128:131], v[56:59]
  s_mul_i32 s79, s71, 196608
  ds_read_b64_tr_b16 v[114:115], v172 offset:16896
  buffer_load_dwordx4 v164, s[28:31], s78 offen offset:0 lds
  v_mfma_f32_16x16x32_bf16 v[56:59], a[156:159], v[132:135], v[56:59]
  s_waitcnt lgkmcnt(4)
  ds_read_b128 a[164:167], v160 offset:34816
  ds_read_b128 a[180:183], v162 offset:34816
  v_mfma_f32_16x16x32_bf16 v[36:39], a[128:131], v[136:139], v[36:39]
  ds_read_b64_tr_b16 v[116:117], v172 offset:20480
  v_mfma_f32_16x16x32_bf16 v[36:39], a[144:147], v[140:143], v[36:39]
  ds_read_b128 a[168:171], v161 offset:32768
  v_mfma_f32_16x16x32_bf16 v[44:47], a[132:135], v[136:139], v[44:47]
  ds_read_b64_tr_b16 v[118:119], v172 offset:20992
  buffer_load_dwordx4 v165, s[28:31], s78 offen offset:1024 lds
  v_mfma_f32_16x16x32_bf16 v[44:47], a[148:151], v[140:143], v[44:47]
  ds_read_b128 a[184:187], v163 offset:32768
  v_mfma_f32_16x16x32_bf16 v[52:55], a[136:139], v[136:139], v[52:55]
  ds_read_b64_tr_b16 v[128:129], v173 offset:16384
  v_mfma_f32_16x16x32_bf16 v[52:55], a[152:155], v[140:143], v[52:55]
  ds_read_b128 a[172:175], v161 offset:34816
  ds_read_b128 a[188:191], v163 offset:34816
  v_mfma_f32_16x16x32_bf16 v[60:63], a[140:143], v[136:139], v[60:63]
  ds_read_b64_tr_b16 v[130:131], v173 offset:16896
  buffer_load_dwordx4 v166, s[28:31], s78 offen offset:2048 lds
  v_mfma_f32_16x16x32_bf16 v[60:63], a[156:159], v[140:143], v[60:63]
  s_waitcnt lgkmcnt(5)
  v_mfma_f32_16x16x32_bf16 v[220:223], v[96:99], a[132:135], v[220:223]
  v_mfma_f32_16x16x32_bf16 v[220:223], v[100:103], a[148:151], v[220:223]
  v_mfma_f32_16x16x32_bf16 v[0:3], v[112:115], a[160:163], v[0:3]
  ds_read_b64_tr_b16 v[132:133], v173 offset:20480
  v_mfma_f32_16x16x32_bf16 v[0:3], v[116:119], a[176:179], v[0:3]
  ds_read_b128 v[104:107], v174 offset:640
  ds_read_b128 v[108:111], v174 offset:704
  v_mfma_f32_16x16x32_bf16 v[8:11], v[112:115], a[164:167], v[8:11]
  ds_read_b64_tr_b16 v[134:135], v173 offset:20992
  buffer_load_dwordx4 v167, s[28:31], s78 offen offset:3072 lds
  v_mfma_f32_16x16x32_bf16 v[8:11], v[116:119], a[180:183], v[8:11]
  s_waitcnt lgkmcnt(5)
  v_mfma_f32_16x16x32_bf16 v[16:19], v[112:115], a[168:171], v[16:19]
  s_add_u32 m0, s76, 49152
  ds_read_b64_tr_b16 v[136:137], v172 offset:24576
  v_mfma_f32_16x16x32_bf16 v[16:19], v[116:119], a[184:187], v[16:19]
  v_mfma_f32_16x16x32_bf16 v[24:27], v[112:115], a[172:175], v[24:27]
  ds_read_b64_tr_b16 v[138:139], v172 offset:25088
  buffer_load_dwordx4 v168, s[32:35], s79 offen offset:0 lds
  v_mfma_f32_16x16x32_bf16 v[24:27], v[116:119], a[188:191], v[24:27]
  s_waitcnt lgkmcnt(2)
  v_mov_b32 v168, v92
  v_mfma_f32_16x16x32_bf16 v[4:7], v[128:131], a[160:163], v[4:7]
  ds_read_b64_tr_b16 v[140:141], v172 offset:28672
  v_mfma_f32_16x16x32_bf16 v[4:7], v[132:135], a[176:179], v[4:7]
  v_mfma_f32_16x16x32_bf16 v[12:15], v[128:131], a[164:167], v[12:15]
  ds_read_b64_tr_b16 v[142:143], v172 offset:29184
  buffer_load_dwordx4 v169, s[32:35], s79 offen offset:1024 lds
  v_mfma_f32_16x16x32_bf16 v[12:15], v[132:135], a[180:183], v[12:15]
  v_mov_b32 v169, v93
  v_mfma_f32_16x16x32_bf16 v[20:23], v[128:131], a[168:171], v[20:23]
  ds_read_b64_tr_b16 v[112:113], v173 offset:24576
  v_mfma_f32_16x16x32_bf16 v[20:23], v[132:135], a[184:187], v[20:23]
  v_mfma_f32_16x16x32_bf16 v[28:31], v[128:131], a[172:175], v[28:31]
  ds_read_b64_tr_b16 v[114:115], v173 offset:25088
  buffer_load_dwordx4 v170, s[32:35], s79 offen offset:2048 lds
  v_mfma_f32_16x16x32_bf16 v[28:31], v[132:135], a[188:191], v[28:31]
  s_waitcnt lgkmcnt(2)
  v_mov_b32 v170, v94
  v_mfma_f32_16x16x32_bf16 v[216:219], v[104:107], a[160:163], v[216:219]
  v_mfma_f32_16x16x32_bf16 v[216:219], v[108:111], a[176:179], v[216:219]
  v_mfma_f32_16x16x32_bf16 v[32:35], a[160:163], v[136:139], v[32:35]
  ds_read_b64_tr_b16 v[116:117], v173 offset:28672
  v_mfma_f32_16x16x32_bf16 v[32:35], a[176:179], v[140:143], v[32:35]
  buffer_load_dwordx4 v171, s[32:35], s79 offen offset:3072 lds
  v_mov_b32 v171, v95
  v_mfma_f32_16x16x32_bf16 v[40:43], a[164:167], v[136:139], v[40:43]
  s_mov_b64 s[32:33], s[84:85]
  ds_read_b64_tr_b16 v[118:119], v173 offset:29184
  s_mul_i32 s79, s72, 229376
  v_mfma_f32_16x16x32_bf16 v[40:43], a[180:183], v[140:143], v[40:43]
  s_mov_b32 s34, s86
  v_mfma_f32_16x16x32_bf16 v[48:51], a[168:171], v[136:139], v[48:51]
  s_waitcnt vmcnt(8)
  s_barrier
  ds_read_b64_tr_b16 v[128:129], v172 offset:32768
  v_mfma_f32_16x16x32_bf16 v[48:51], a[184:187], v[140:143], v[48:51]
  s_add_u32 m0, s76, 0
  ds_read_b128 a[192:195], v160 offset:0
  ds_read_b128 a[208:211], v162 offset:0
  v_mfma_f32_16x16x32_bf16 v[56:59], a[172:175], v[136:139], v[56:59]
  ds_read_b64_tr_b16 v[130:131], v172 offset:33280
  buffer_load_dwordx4 v168, s[32:35], s79 offen offset:0 lds
  v_mfma_f32_16x16x32_bf16 v[56:59], a[188:191], v[140:143], v[56:59]
  s_waitcnt lgkmcnt(4)
  ds_read_b128 a[196:199], v160 offset:2048
  ds_read_b128 a[212:215], v162 offset:2048
  v_mfma_f32_16x16x32_bf16 v[36:39], a[160:163], v[112:115], v[36:39]
  ds_read_b64_tr_b16 v[132:133], v172 offset:36864
  v_lshrrev_b32 v165, 3, v175
  v_mfma_f32_16x16x32_bf16 v[36:39], a[176:179], v[116:119], v[36:39]
  ds_read_b128 a[200:203], v161 offset:0
  v_and_b32 v166, 6, v165
  v_mfma_f32_16x16x32_bf16 v[44:47], a[164:167], v[112:115], v[44:47]
  ds_read_b64_tr_b16 v[134:135], v172 offset:37376
  v_lshlrev_b32 v165, 10, v165
  v_mfma_f32_16x16x32_bf16 v[44:47], a[180:183], v[116:119], v[44:47]
  ds_read_b128 a[216:219], v163 offset:0
  v_and_b32 v167, 7, v175
  v_mfma_f32_16x16x32_bf16 v[52:55], a[168:171], v[112:115], v[52:55]
  ds_read_b64_tr_b16 v[136:137], v173 offset:32768
  v_xor_b32_e64 v166, v166, v167
  v_mfma_f32_16x16x32_bf16 v[52:55], a[184:187], v[116:119], v[52:55]
  ds_read_b128 a[204:207], v161 offset:2048
  ds_read_b128 a[220:223], v163 offset:2048
  v_mfma_f32_16x16x32_bf16 v[60:63], a[172:175], v[112:115], v[60:63]
  ds_read_b64_tr_b16 v[138:139], v173 offset:33280
  buffer_load_dwordx4 v169, s[32:35], s79 offen offset:1024 lds
  v_mfma_f32_16x16x32_bf16 v[60:63], a[188:191], v[116:119], v[60:63]
  s_waitcnt lgkmcnt(5)
  v_lshl_add_u32 v164, v166, 4, v165
  v_add_u32 v165, 7168, v164
  v_mfma_f32_16x16x32_bf16 v[220:223], v[104:107], a[164:167], v[220:223]
  v_add_u32 v166, 14336, v164
  v_add_u32 v167, 21504, v164
  v_mfma_f32_16x16x32_bf16 v[220:223], v[108:111], a[180:183], v[220:223]
  v_mfma_f32_16x16x32_bf16 v[0:3], v[128:131], a[192:195], v[0:3]
  ds_read_b64_tr_b16 v[140:141], v173 offset:36864
  v_mfma_f32_16x16x32_bf16 v[0:3], v[132:135], a[208:211], v[0:3]
  ds_read_b128 v[96:99], v174 offset:768
  ds_read_b128 v[100:103], v174 offset:832
  v_mfma_f32_16x16x32_bf16 v[8:11], v[128:131], a[196:199], v[8:11]
  ds_read_b64_tr_b16 v[142:143], v173 offset:37376
  v_mfma_f32_16x16x32_bf16 v[8:11], v[132:135], a[212:215], v[8:11]
  s_waitcnt lgkmcnt(5)
  buffer_load_dwordx4 v170, s[32:35], s79 offen offset:2048 lds
  v_mfma_f32_16x16x32_bf16 v[16:19], v[128:131], a[200:203], v[16:19]
  ds_read_b64_tr_b16 v[112:113], v172 offset:40960
  v_mfma_f32_16x16x32_bf16 v[16:19], v[132:135], a[216:219], v[16:19]
  v_mfma_f32_16x16x32_bf16 v[24:27], v[128:131], a[204:207], v[24:27]
  ds_read_b64_tr_b16 v[114:115], v172 offset:41472
  v_mfma_f32_16x16x32_bf16 v[24:27], v[132:135], a[220:223], v[24:27]
  s_waitcnt lgkmcnt(2)
  v_mfma_f32_16x16x32_bf16 v[4:7], v[136:139], a[192:195], v[4:7]
  ds_read_b64_tr_b16 v[116:117], v172 offset:45056
  v_mfma_f32_16x16x32_bf16 v[4:7], v[140:143], a[208:211], v[4:7]
  buffer_load_dwordx4 v171, s[32:35], s79 offen offset:3072 lds
  v_mfma_f32_16x16x32_bf16 v[12:15], v[136:139], a[196:199], v[12:15]
  s_mul_i32 s79, s73, 229376
  ds_read_b64_tr_b16 v[118:119], v172 offset:45568
  v_mfma_f32_16x16x32_bf16 v[12:15], v[140:143], a[212:215], v[12:15]
  v_mfma_f32_16x16x32_bf16 v[20:23], v[136:139], a[200:203], v[20:23]
  ds_read_b64_tr_b16 v[128:129], v173 offset:40960
  v_mfma_f32_16x16x32_bf16 v[20:23], v[140:143], a[216:219], v[20:23]
  v_mfma_f32_16x16x32_bf16 v[28:31], v[136:139], a[204:207], v[28:31]
  ds_read_b64_tr_b16 v[130:131], v173 offset:41472
  v_mfma_f32_16x16x32_bf16 v[28:31], v[140:143], a[220:223], v[28:31]
  s_waitcnt lgkmcnt(2)
  buffer_load_dword v176, off, s[52:55], 0 sc1
  v_mfma_f32_16x16x32_bf16 v[216:219], v[96:99], a[192:195], v[216:219]
  v_mfma_f32_16x16x32_bf16 v[216:219], v[100:103], a[208:211], v[216:219]
  global_load_dword v199, v89, s[18:19]
  v_mfma_f32_16x16x32_bf16 v[32:35], a[192:195], v[112:115], v[32:35]
  ds_read_b64_tr_b16 v[132:133], v173 offset:45056
  v_mfma_f32_16x16x32_bf16 v[32:35], a[208:211], v[116:119], v[32:35]
  v_mfma_f32_16x16x32_bf16 v[40:43], a[196:199], v[112:115], v[40:43]
  ds_read_b64_tr_b16 v[134:135], v173 offset:45568
  v_mfma_f32_16x16x32_bf16 v[40:43], a[212:215], v[116:119], v[40:43]
  v_mfma_f32_16x16x32_bf16 v[48:51], a[200:203], v[112:115], v[48:51]
  s_waitcnt vmcnt(6)
  s_barrier
  ds_read_b64_tr_b16 v[136:137], v172 offset:49152
  v_mfma_f32_16x16x32_bf16 v[48:51], a[216:219], v[116:119], v[48:51]
  s_add_u32 m0, s76, 16384
  ds_read_b128 a[224:227], v160 offset:16384
  ds_read_b128 a[240:243], v162 offset:16384
  v_mfma_f32_16x16x32_bf16 v[56:59], a[204:207], v[112:115], v[56:59]
  ds_read_b64_tr_b16 v[138:139], v172 offset:49664
  buffer_load_dwordx4 v168, s[32:35], s79 offen offset:0 lds
  v_mfma_f32_16x16x32_bf16 v[56:59], a[220:223], v[116:119], v[56:59]
  s_waitcnt lgkmcnt(4)
  ds_read_b128 a[228:231], v160 offset:18432
  ds_read_b128 a[244:247], v162 offset:18432
  v_mfma_f32_16x16x32_bf16 v[36:39], a[192:195], v[128:131], v[36:39]
  ds_read_b64_tr_b16 v[140:141], v172 offset:53248
  v_mfma_f32_16x16x32_bf16 v[36:39], a[208:211], v[132:135], v[36:39]
  ds_read_b128 a[232:235], v161 offset:16384
  v_mfma_f32_16x16x32_bf16 v[44:47], a[196:199], v[128:131], v[44:47]
  ds_read_b64_tr_b16 v[142:143], v172 offset:53760
  v_mfma_f32_16x16x32_bf16 v[44:47], a[212:215], v[132:135], v[44:47]
  ds_read_b128 a[248:251], v163 offset:16384
  v_mfma_f32_16x16x32_bf16 v[52:55], a[200:203], v[128:131], v[52:55]
  ds_read_b64_tr_b16 v[112:113], v173 offset:49152
  v_mfma_f32_16x16x32_bf16 v[52:55], a[216:219], v[132:135], v[52:55]
  ds_read_b128 a[236:239], v161 offset:18432
  ds_read_b128 a[252:255], v163 offset:18432
  v_mfma_f32_16x16x32_bf16 v[60:63], a[204:207], v[128:131], v[60:63]
  ds_read_b64_tr_b16 v[114:115], v173 offset:49664
  buffer_load_dwordx4 v169, s[32:35], s79 offen offset:1024 lds
  v_mfma_f32_16x16x32_bf16 v[60:63], a[220:223], v[132:135], v[60:63]
  s_waitcnt lgkmcnt(5)
  v_mfma_f32_16x16x32_bf16 v[220:223], v[96:99], a[196:199], v[220:223]
  v_mfma_f32_16x16x32_bf16 v[220:223], v[100:103], a[212:215], v[220:223]
  v_mfma_f32_16x16x32_bf16 v[0:3], v[136:139], a[224:227], v[0:3]
  ds_read_b64_tr_b16 v[116:117], v173 offset:53248
  v_mfma_f32_16x16x32_bf16 v[0:3], v[140:143], a[240:243], v[0:3]
  ds_read_b128 v[104:107], v174 offset:896
  ds_read_b128 v[108:111], v174 offset:960
  v_mfma_f32_16x16x32_bf16 v[8:11], v[136:139], a[228:231], v[8:11]
  ds_read_b64_tr_b16 v[118:119], v173 offset:53760
  v_mfma_f32_16x16x32_bf16 v[8:11], v[140:143], a[244:247], v[8:11]
  s_waitcnt lgkmcnt(5)
  buffer_load_dwordx4 v170, s[32:35], s79 offen offset:2048 lds
  v_mfma_f32_16x16x32_bf16 v[16:19], v[136:139], a[232:235], v[16:19]
  ds_read_b64_tr_b16 v[128:129], v172 offset:57344
  v_add_u32 v160, 0xffff0000, v200
  v_mfma_f32_16x16x32_bf16 v[16:19], v[140:143], a[248:251], v[16:19]
  v_add_u32 v161, 0xffff0000, v201
  v_add_u32 v162, 0xffff0000, v202
  v_mfma_f32_16x16x32_bf16 v[24:27], v[136:139], a[236:239], v[24:27]
  ds_read_b64_tr_b16 v[130:131], v172 offset:57856
  v_add_u32 v163, 0xffff0000, v203
  v_mfma_f32_16x16x32_bf16 v[24:27], v[140:143], a[252:255], v[24:27]
  s_waitcnt lgkmcnt(2)
  v_mfma_f32_16x16x32_bf16 v[4:7], v[112:115], a[224:227], v[4:7]
  ds_read_b64_tr_b16 v[132:133], v172 offset:61440
  v_mfma_f32_16x16x32_bf16 v[4:7], v[116:119], a[240:243], v[4:7]
  buffer_load_dwordx4 v171, s[32:35], s79 offen offset:3072 lds
  v_mfma_f32_16x16x32_bf16 v[12:15], v[112:115], a[228:231], v[12:15]
  s_mul_i32 s79, s74, 229376
  ds_read_b64_tr_b16 v[134:135], v172 offset:61952
  v_mfma_f32_16x16x32_bf16 v[12:15], v[116:119], a[244:247], v[12:15]
  v_mfma_f32_16x16x32_bf16 v[20:23], v[112:115], a[232:235], v[20:23]
  ds_read_b64_tr_b16 v[136:137], v173 offset:57344
  v_mfma_f32_16x16x32_bf16 v[20:23], v[116:119], a[248:251], v[20:23]
  v_mfma_f32_16x16x32_bf16 v[28:31], v[112:115], a[236:239], v[28:31]
  ds_read_b64_tr_b16 v[138:139], v173 offset:57856
  v_mfma_f32_16x16x32_bf16 v[28:31], v[116:119], a[252:255], v[28:31]
  s_waitcnt lgkmcnt(2)
  v_mfma_f32_16x16x32_bf16 v[216:219], v[104:107], a[224:227], v[216:219]
  v_mfma_f32_16x16x32_bf16 v[216:219], v[108:111], a[240:243], v[216:219]
  v_mfma_f32_16x16x32_bf16 v[32:35], a[224:227], v[128:131], v[32:35]
  ds_read_b64_tr_b16 v[140:141], v173 offset:61440
  v_mfma_f32_16x16x32_bf16 v[32:35], a[240:243], v[132:135], v[32:35]
  v_mfma_f32_16x16x32_bf16 v[40:43], a[228:231], v[128:131], v[40:43]
  ds_read_b64_tr_b16 v[142:143], v173 offset:61952
  v_mfma_f32_16x16x32_bf16 v[40:43], a[244:247], v[132:135], v[40:43]
  v_mfma_f32_16x16x32_bf16 v[48:51], a[232:235], v[128:131], v[48:51]
  s_waitcnt vmcnt(6)
  s_barrier
  v_mfma_f32_16x16x32_bf16 v[48:51], a[248:251], v[132:135], v[48:51]
  v_mfma_f32_16x16x32_bf16 v[56:59], a[236:239], v[128:131], v[56:59]
  v_mfma_f32_16x16x32_bf16 v[56:59], a[252:255], v[132:135], v[56:59]
  s_waitcnt lgkmcnt(0)
  v_mfma_f32_16x16x32_bf16 v[36:39], a[224:227], v[136:139], v[36:39]
  s_waitcnt vmcnt(5)
  v_cmp_eq_u32 vcc, 0, v176
  s_cbranch_vccnz L_slow1
L_ret1:
  v_mfma_f32_16x16x32_bf16 v[36:39], a[240:243], v[140:143], v[36:39]
  v_mfma_f32_16x16x32_bf16 v[44:47], a[228:231], v[136:139], v[44:47]
  v_mfma_f32_16x16x32_bf16 v[44:47], a[244:247], v[140:143], v[44:47]
  v_mfma_f32_16x16x32_bf16 v[52:55], a[232:235], v[136:139], v[52:55]
  v_mfma_f32_16x16x32_bf16 v[52:55], a[248:251], v[140:143], v[52:55]
  v_mfma_f32_16x16x32_bf16 v[60:63], a[236:239], v[136:139], v[60:63]
  v_mfma_f32_16x16x32_bf16 v[60:63], a[252:255], v[140:143], v[60:63]
  v_mfma_f32_16x16x32_bf16 v[220:223], v[104:107], a[228:231], v[220:223]
  v_mfma_f32_16x16x32_bf16 v[220:223], v[108:111], a[244:247], v[220:223]
  v_cvt_pk_bf16_f32 v144, v0, v1
  v_cvt_pk_bf16_f32 v145, v2, v3
  v_cvt_pk_bf16_f32 v146, v4, v5
  v_cvt_pk_bf16_f32 v147, v6, v7
  v_cvt_pk_bf16_f32 v148, v8, v9
  v_cvt_pk_bf16_f32 v149, v10, v11
  v_cvt_pk_bf16_f32 v150, v12, v13
  v_cvt_pk_bf16_f32 v151, v14, v15
  v_cvt_pk_bf16_f32 v0, v32, v33
  v_cvt_pk_bf16_f32 v1, v34, v35
  v_cvt_pk_bf16_f32 v2, v40, v41
  v_cvt_pk_bf16_f32 v3, v42, v43
  v_cvt_pk_bf16_f32 v4, v36, v37
  v_cvt_pk_bf16_f32 v5, v38, v39
  v_mfma_f32_16x16x32_bf16 v[64:67], v[236:239], v[144:147], 0
  v_cvt_pk_bf16_f32 v152, v16, v17
  v_cvt_pk_bf16_f32 v153, v18, v19
  v_mfma_f32_16x16x32_bf16 v[68:71], v[240:243], v[144:147], 0
  ds_write_b128 v226, v[0:3] offset:0
  v_mfma_f32_16x16x32_bf16 v[72:75], v[244:247], v[144:147], 0
  v_cvt_pk_bf16_f32 v154, v20, v21
  v_cvt_pk_bf16_f32 v155, v22, v23
  v_mfma_f32_16x16x32_bf16 v[76:79], v[248:251], v[144:147], 0
  v_cvt_pk_bf16_f32 v6, v44, v45
  v_cvt_pk_bf16_f32 v7, v46, v47
  v_mfma_f32_16x16x32_bf16 v[80:83], v[236:239], v[148:151], 0
  v_cvt_pk_bf16_f32 v8, v48, v49
  v_cvt_pk_bf16_f32 v9, v50, v51
  v_mfma_f32_16x16x32_bf16 v[84:87], v[240:243], v[148:151], 0
  ds_write_b128 v226, v[4:7] offset:4096
  v_mfma_f32_16x16x32_bf16 v[88:91], v[244:247], v[148:151], 0
  v_cvt_pk_bf16_f32 v156, v24, v25
  v_cvt_pk_bf16_f32 v157, v26, v27
  v_mfma_f32_16x16x32_bf16 v[92:95], v[248:251], v[148:151], 0
  v_cvt_pk_bf16_f32 v158, v28, v29
  v_cvt_pk_bf16_f32 v159, v30, v31
  v_mfma_f32_16x16x32_bf16 v[96:99], v[236:239], v[152:155], 0
  v_cvt_pk_bf16_f32 v10, v56, v57
  v_cvt_pk_bf16_f32 v11, v58, v59
  v_mfma_f32_16x16x32_bf16 v[100:103], v[240:243], v[152:155], 0
  ds_write_b128 v226, v[8:11] offset:1024
  v_mfma_f32_16x16x32_bf16 v[104:107], v[244:247], v[152:155], 0
  v_cvt_pk_bf16_f32 v12, v52, v53
  v_cvt_pk_bf16_f32 v13, v54, v55
  v_mfma_f32_16x16x32_bf16 v[108:111], v[248:251], v[152:155], 0
  v_cvt_pk_bf16_f32 v14, v60, v61
  v_cvt_pk_bf16_f32 v15, v62, v63
  v_mfma_f32_16x16x32_bf16 v[112:115], v[236:239], v[156:159], 0
  v_mul_f32 v184, v207, v216
  v_mul_f32 v185, v207, v220
  v_mfma_f32_16x16x32_bf16 v[116:119], v[240:243], v[156:159], 0
  ds_write_b128 v226, v[12:15] offset:5120
  v_mfma_f32_16x16x32_bf16 v[120:123], v[244:247], v[156:159], 0
  v_exp_f32 v184, v184
  v_exp_f32 v185, v185
  v_mfma_f32_16x16x32_bf16 v[124:127], v[248:251], v[156:159], 0
  ds_write2_b32 v225, v216, v220 offset1:1
  v_add_f32 v184, 1.0, v184
  v_add_f32_e64 v185, 1.0, v185
  v_min_f32 v184, 0x71800000, v184
  v_min_f32 v185, 0x71800000, v185
  s_add_u32 m0, s76, 32768
  s_nop 0
  buffer_load_dwordx4 v168, s[32:35], s79 offen offset:0 lds
  v_max3_f32 v208, v64, v65, v66
  v_max3_f32 v208, v208, v67, v68
  v_max3_f32 v208, v208, v69, v70
  v_max3_f32 v208, v208, v71, v72
  v_max3_f32 v208, v208, v73, v74
  v_max3_f32 v208, v208, v75, v76
  v_max3_f32 v208, v208, v77, v78
  v_max_f32_e64 v208, v208, v79
  v_mul_f32 v208, 0xbfb8aa3b, v208
  v_pk_fma_f32 v[64:65], v[64:65], v[206:207], v[208:209] op_sel:[0,1,0] op_sel_hi:[1,1,0]
  buffer_load_dwordx4 v169, s[32:35], s79 offen offset:1024 lds
  v_pk_fma_f32 v[66:67], v[66:67], v[206:207], v[208:209] op_sel:[0,1,0] op_sel_hi:[1,1,0]
  v_pk_fma_f32 v[68:69], v[68:69], v[206:207], v[208:209] op_sel:[0,1,0] op_sel_hi:[1,1,0]
  v_pk_fma_f32 v[70:71], v[70:71], v[206:207], v[208:209] op_sel:[0,1,0] op_sel_hi:[1,1,0]
  v_pk_fma_f32 v[72:73], v[72:73], v[206:207], v[208:209] op_sel:[0,1,0] op_sel_hi:[1,1,0]
  v_pk_fma_f32 v[74:75], v[74:75], v[206:207], v[208:209] op_sel:[0,1,0] op_sel_hi:[1,1,0]
  v_pk_fma_f32 v[76:77], v[76:77], v[206:207], v[208:209] op_sel:[0,1,0] op_sel_hi:[1,1,0]
  v_pk_fma_f32 v[78:79], v[78:79], v[206:207], v[208:209] op_sel:[0,1,0] op_sel_hi:[1,1,0]
  v_exp_f32 v64, v64
  v_exp_f32 v65, v65
  v_exp_f32 v66, v66
  buffer_load_dwordx4 v170, s[32:35], s79 offen offset:2048 lds
  v_exp_f32 v67, v67
  v_exp_f32 v68, v68
  v_exp_f32 v69, v69
  v_exp_f32 v70, v70
  v_exp_f32 v71, v71
  v_exp_f32 v72, v72
  v_exp_f32 v73, v73
  v_exp_f32 v74, v74
  v_exp_f32 v75, v75
  buffer_load_dwordx4 v171, s[32:35], s79 offen offset:3072 lds
  v_exp_f32 v76, v76
  v_exp_f32 v77, v77
  v_exp_f32 v78, v78
  v_exp_f32 v79, v79
  v_pk_add_f32 v[210:211], v[64:65], v[66:67]
  v_pk_add_f32 v[210:211], v[210:211], v[68:69]
  v_pk_add_f32 v[210:211], v[210:211], v[70:71]
  v_pk_add_f32 v[210:211], v[210:211], v[72:73]
  v_pk_add_f32 v[210:211], v[210:211], v[74:75]
  v_pk_add_f32 v[210:211], v[210:211], v[76:77]
  s_add_u32 s78, s90, 786432
  s_add_u32 m0, s77, 131072
  s_nop 0
  buffer_load_dwordx4 v164, s[40:43], s78 offen offset:0 lds
  v_pk_add_f32 v[210:211], v[210:211], v[78:79]
  v_add_f32 v210, v210, v211
  v_rcp_f32 v210, v210
  s_nop 0
  v_pk_mul_f32 v[64:65], v[64:65], v[210:211] op_sel_hi:[1,0]
  v_pk_mul_f32 v[66:67], v[66:67], v[210:211] op_sel_hi:[1,0]
  v_pk_mul_f32 v[68:69], v[68:69], v[210:211] op_sel_hi:[1,0]
  v_pk_mul_f32 v[70:71], v[70:71], v[210:211] op_sel_hi:[1,0]
  v_pk_mul_f32 v[72:73], v[72:73], v[210:211] op_sel_hi:[1,0]
  v_pk_mul_f32 v[74:75], v[74:75], v[210:211] op_sel_hi:[1,0]
  buffer_load_dwordx4 v165, s[40:43], s78 offen offset:1024 lds
  v_pk_mul_f32 v[76:77], v[76:77], v[210:211] op_sel_hi:[1,0]
  v_pk_mul_f32 v[78:79], v[78:79], v[210:211] op_sel_hi:[1,0]
  v_cvt_pk_bf16_f32 v16, v64, v65
  v_cvt_pk_bf16_f32 v17, v66, v67
  v_cvt_pk_bf16_f32 v18, v68, v69
  v_cvt_pk_bf16_f32 v19, v70, v71
  v_cvt_pk_bf16_f32 v20, v72, v73
  v_cvt_pk_bf16_f32 v21, v74, v75
  v_cvt_pk_bf16_f32 v22, v76, v77
  v_cvt_pk_bf16_f32 v23, v78, v79
  buffer_load_dwordx4 v166, s[40:43], s78 offen offset:2048 lds
  ds_write_b128 v228, v[16:19] offset:0
  ds_write_b128 v229, v[20:23] offset:0
  v_max3_f32 v208, v80, v81, v82
  v_max3_f32 v208, v208, v83, v84
  v_max3_f32 v208, v208, v85, v86
  v_max3_f32 v208, v208, v87, v88
  v_max3_f32 v208, v208, v89, v90
  v_max3_f32 v208, v208, v91, v92
  v_max3_f32 v208, v208, v93, v94
  v_max_f32_e64 v208, v208, v95
  buffer_load_dwordx4 v167, s[40:43], s78 offen offset:3072 lds
  v_mul_f32 v208, 0xbfb8aa3b, v208
  v_pk_fma_f32 v[80:81], v[80:81], v[206:207], v[208:209] op_sel:[0,1,0] op_sel_hi:[1,1,0]
  v_pk_fma_f32 v[82:83], v[82:83], v[206:207], v[208:209] op_sel:[0,1,0] op_sel_hi:[1,1,0]
  v_pk_fma_f32 v[84:85], v[84:85], v[206:207], v[208:209] op_sel:[0,1,0] op_sel_hi:[1,1,0]
  v_pk_fma_f32 v[86:87], v[86:87], v[206:207], v[208:209] op_sel:[0,1,0] op_sel_hi:[1,1,0]
  v_pk_fma_f32 v[88:89], v[88:89], v[206:207], v[208:209] op_sel:[0,1,0] op_sel_hi:[1,1,0]
  v_pk_fma_f32 v[90:91], v[90:91], v[206:207], v[208:209] op_sel:[0,1,0] op_sel_hi:[1,1,0]
  v_pk_fma_f32 v[92:93], v[92:93], v[206:207], v[208:209] op_sel:[0,1,0] op_sel_hi:[1,1,0]
  v_pk_fma_f32 v[94:95], v[94:95], v[206:207], v[208:209] op_sel:[0,1,0] op_sel_hi:[1,1,0]
  s_add_u32 s78, s90, 819200
  s_add_u32 m0, s77, 135168
  s_nop 0
  buffer_load_dwordx4 v164, s[40:43], s78 offen offset:0 lds
  v_exp_f32 v80, v80
  v_exp_f32 v81, v81
  v_exp_f32 v82, v82
  v_exp_f32 v83, v83
  v_exp_f32 v84, v84
  v_exp_f32 v85, v85
  v_exp_f32 v86, v86
  v_exp_f32 v87, v87
  v_exp_f32 v88, v88
  v_exp_f32 v89, v89
  buffer_load_dwordx4 v165, s[40:43], s78 offen offset:1024 lds
  v_exp_f32 v90, v90
  v_exp_f32 v91, v91
  v_exp_f32 v92, v92
  v_exp_f32 v93, v93
  v_exp_f32 v94, v94
  v_exp_f32_e64 v95, v95
  v_pk_add_f32 v[210:211], v[80:81], v[82:83]
  v_pk_add_f32 v[210:211], v[210:211], v[84:85]
  v_pk_add_f32 v[210:211], v[210:211], v[86:87]
  buffer_load_dwordx4 v166, s[40:43], s78 offen offset:2048 lds
  v_pk_add_f32 v[210:211], v[210:211], v[88:89]
  v_pk_add_f32 v[210:211], v[210:211], v[90:91]
  v_pk_add_f32 v[210:211], v[210:211], v[92:93]
  v_pk_add_f32 v[210:211], v[210:211], v[94:95]
  v_add_f32 v210, v210, v211
  v_rcp_f32_e64 v210, v210
  s_nop 0
  v_pk_mul_f32 v[80:81], v[80:81], v[210:211] op_sel_hi:[1,0]
  v_pk_mul_f32 v[82:83], v[82:83], v[210:211] op_sel_hi:[1,0]
  v_pk_mul_f32 v[84:85], v[84:85], v[210:211] op_sel_hi:[1,0]
  v_pk_mul_f32 v[86:87], v[86:87], v[210:211] op_sel_hi:[1,0]
  buffer_load_dwordx4 v167, s[40:43], s78 offen offset:3072 lds
  v_pk_mul_f32 v[88:89], v[88:89], v[210:211] op_sel_hi:[1,0]
  v_pk_mul_f32 v[90:91], v[90:91], v[210:211] op_sel_hi:[1,0]
  v_pk_mul_f32 v[92:93], v[92:93], v[210:211] op_sel_hi:[1,0]
  v_pk_mul_f32 v[94:95], v[94:95], v[210:211] op_sel_hi:[1,0]
  v_cvt_pk_bf16_f32 v24, v80, v81
  v_cvt_pk_bf16_f32 v25, v82, v83
  v_cvt_pk_bf16_f32 v26, v84, v85
  v_cvt_pk_bf16_f32 v27, v86, v87
  v_cvt_pk_bf16_f32 v28, v88, v89
  v_cvt_pk_bf16_f32 v29, v90, v91
  global_load_dword v234, v233, s[80:81]
  v_cvt_pk_bf16_f32 v30, v92, v93
  v_cvt_pk_bf16_f32 v31, v94, v95
  ds_write_b128 v228, v[24:27] offset:1024
  ds_write_b128 v229, v[28:31] offset:1024
  v_max3_f32 v208, v96, v97, v98
  v_max3_f32 v208, v208, v99, v100
  v_max3_f32 v208, v208, v101, v102
  v_max3_f32 v208, v208, v103, v104
  v_max3_f32 v208, v208, v105, v106
  v_max3_f32 v208, v208, v107, v108
  v_max3_f32 v208, v208, v109, v110
  v_max_f32_e64 v208, v208, v111
  v_mul_f32 v208, 0xbfb8aa3b, v208
  v_pk_fma_f32 v[96:97], v[96:97], v[206:207], v[208:209] op_sel:[0,1,0] op_sel_hi:[1,1,0]
  v_pk_fma_f32 v[98:99], v[98:99], v[206:207], v[208:209] op_sel:[0,1,0] op_sel_hi:[1,1,0]
  v_pk_fma_f32 v[100:101], v[100:101], v[206:207], v[208:209] op_sel:[0,1,0] op_sel_hi:[1,1,0]
  v_pk_fma_f32 v[102:103], v[102:103], v[206:207], v[208:209] op_sel:[0,1,0] op_sel_hi:[1,1,0]
  v_pk_fma_f32 v[104:105], v[104:105], v[206:207], v[208:209] op_sel:[0,1,0] op_sel_hi:[1,1,0]
  v_pk_fma_f32 v[106:107], v[106:107], v[206:207], v[208:209] op_sel:[0,1,0] op_sel_hi:[1,1,0]
  v_pk_fma_f32 v[108:109], v[108:109], v[206:207], v[208:209] op_sel:[0,1,0] op_sel_hi:[1,1,0]
  v_pk_fma_f32 v[110:111], v[110:111], v[206:207], v[208:209] op_sel:[0,1,0] op_sel_hi:[1,1,0]
  v_exp_f32 v96, v96
  v_exp_f32 v97, v97
  v_exp_f32 v98, v98
  v_exp_f32 v99, v99
  v_exp_f32 v100, v100
  v_exp_f32 v101, v101
  v_exp_f32 v102, v102
  v_exp_f32 v103, v103
  v_exp_f32 v104, v104
  v_exp_f32 v105, v105
  v_exp_f32 v106, v106
  v_exp_f32 v107, v107
  v_exp_f32 v108, v108
  v_exp_f32 v109, v109
  v_exp_f32 v110, v110
  v_exp_f32 v111, v111
  v_pk_add_f32 v[210:211], v[96:97], v[98:99]
  v_pk_add_f32 v[210:211], v[210:211], v[100:101]
  v_pk_add_f32 v[210:211], v[210:211], v[102:103]
  v_pk_add_f32 v[210:211], v[210:211], v[104:105]
  v_pk_add_f32 v[210:211], v[210:211], v[106:107]
L_pgK2:
  s_cbranch_execz L_back
  v_pk_add_f32 v[210:211], v[210:211], v[108:109]
  v_pk_add_f32 v[210:211], v[210:211], v[110:111]
  v_add_f32 v210, v210, v211
  v_rcp_f32 v210, v210
  s_nop 0
  v_pk_mul_f32 v[96:97], v[96:97], v[210:211] op_sel_hi:[1,0]
  v_pk_mul_f32 v[98:99], v[98:99], v[210:211] op_sel_hi:[1,0]
  v_pk_mul_f32 v[100:101], v[100:101], v[210:211] op_sel_hi:[1,0]
  v_pk_mul_f32 v[102:103], v[102:103], v[210:211] op_sel_hi:[1,0]
  v_pk_mul_f32 v[104:105], v[104:105], v[210:211] op_sel_hi:[1,0]
  v_pk_mul_f32 v[106:107], v[106:107], v[210:211] op_sel_hi:[1,0]
  v_pk_mul_f32 v[108:109], v[108:109], v[210:211] op_sel_hi:[1,0]
  v_pk_mul_f32 v[110:111], v[110:111], v[210:211] op_sel_hi:[1,0]
  v_cvt_pk_bf16_f32 v16, v96, v97
  v_cvt_pk_bf16_f32 v17, v98, v99
  v_cvt_pk_bf16_f32 v18, v100, v101
  v_cvt_pk_bf16_f32 v19, v102, v103
  v_cvt_pk_bf16_f32 v20, v104, v105
  v_cvt_pk_bf16_f32 v21, v106, v107
  v_cvt_pk_bf16_f32 v22, v108, v109
  v_cvt_pk_bf16_f32 v23, v110, v111
  ds_write_b128 v228, v[16:19] offset:2048
  ds_write_b128 v229, v[20:23] offset:2048
  v_max3_f32 v208, v112, v113, v114
  v_max3_f32 v208, v208, v115, v116
  v_max3_f32 v208, v208, v117, v118
  v_max3_f32 v208, v208, v119, v120
  v_max3_f32 v208, v208, v121, v122
  v_max3_f32 v208, v208, v123, v124
  v_max3_f32 v208, v208, v125, v126
  v_max_f32_e64 v208, v208, v127
  v_mul_f32 v208, 0xbfb8aa3b, v208
  v_pk_fma_f32 v[112:113], v[112:113], v[206:207], v[208:209] op_sel:[0,1,0] op_sel_hi:[1,1,0]
  v_pk_fma_f32 v[114:115], v[114:115], v[206:207], v[208:209] op_sel:[0,1,0] op_sel_hi:[1,1,0]
  v_pk_fma_f32 v[116:117], v[116:117], v[206:207], v[208:209] op_sel:[0,1,0] op_sel_hi:[1,1,0]
  v_pk_fma_f32 v[118:119], v[118:119], v[206:207], v[208:209] op_sel:[0,1,0] op_sel_hi:[1,1,0]
  v_pk_fma_f32 v[120:121], v[120:121], v[206:207], v[208:209] op_sel:[0,1,0] op_sel_hi:[1,1,0]
  v_pk_fma_f32 v[122:123], v[122:123], v[206:207], v[208:209] op_sel:[0,1,0] op_sel_hi:[1,1,0]
  v_pk_fma_f32 v[124:125], v[124:125], v[206:207], v[208:209] op_sel:[0,1,0] op_sel_hi:[1,1,0]
  v_pk_fma_f32 v[126:127], v[126:127], v[206:207], v[208:209] op_sel:[0,1,0] op_sel_hi:[1,1,0]
  v_exp_f32 v112, v112
  v_exp_f32 v113, v113
  v_exp_f32 v114, v114
  v_exp_f32 v115, v115
  v_exp_f32 v116, v116
  v_exp_f32 v117, v117
  v_exp_f32 v118, v118
  v_exp_f32 v119, v119
  v_exp_f32 v120, v120
  v_exp_f32 v121, v121
  v_exp_f32 v122, v122
  v_exp_f32 v123, v123
  v_exp_f32 v124, v124
  v_exp_f32 v125, v125
  v_exp_f32 v126, v126
  v_exp_f32 v127, v127
  v_pk_add_f32 v[210:211], v[112:113], v[114:115]
  v_pk_add_f32 v[210:211], v[210:211], v[116:117]
  v_pk_add_f32 v[210:211], v[210:211], v[118:119]
  v_pk_add_f32 v[210:211], v[210:211], v[120:121]
  v_pk_add_f32 v[210:211], v[210:211], v[122:123]
  v_pk_add_f32 v[210:211], v[210:211], v[124:125]
  v_pk_add_f32 v[210:211], v[210:211], v[126:127]
  v_add_f32 v210, v210, v211
  v_rcp_f32_e64 v210, v210
  s_nop 0
  v_pk_mul_f32 v[112:113], v[112:113], v[210:211] op_sel_hi:[1,0]
  v_pk_mul_f32 v[114:115], v[114:115], v[210:211] op_sel_hi:[1,0]
  v_pk_mul_f32 v[116:117], v[116:117], v[210:211] op_sel_hi:[1,0]
  v_pk_mul_f32 v[118:119], v[118:119], v[210:211] op_sel_hi:[1,0]
  v_pk_mul_f32 v[120:121], v[120:121], v[210:211] op_sel_hi:[1,0]
  v_pk_mul_f32 v[122:123], v[122:123], v[210:211] op_sel_hi:[1,0]
  v_pk_mul_f32 v[124:125], v[124:125], v[210:211] op_sel_hi:[1,0]
  v_pk_mul_f32 v[126:127], v[126:127], v[210:211] op_sel_hi:[1,0]
  v_cvt_pk_bf16_f32 v24, v112, v113
  v_cvt_pk_bf16_f32 v25, v114, v115
  v_cvt_pk_bf16_f32 v26, v116, v117
  v_cvt_pk_bf16_f32 v27, v118, v119
  v_cvt_pk_bf16_f32 v28, v120, v121
  v_cvt_pk_bf16_f32 v29, v122, v123
  v_cvt_pk_bf16_f32 v30, v124, v125
  v_cvt_pk_bf16_f32 v31, v126, v127
  ds_write_b128 v228, v[24:27] offset:3072
  ds_write_b128 v229, v[28:31] offset:3072
  v_xor_b32 v225, 512, v225
  s_waitcnt lgkmcnt(0)
  s_barrier
  ds_read_b64_tr_b16 v[0:1], v230 offset:0
  ds_read_b64_tr_b16 v[2:3], v230 offset:1024
  ds_read_b64_tr_b16 v[4:5], v231 offset:0
  ds_read_b64_tr_b16 v[6:7], v231 offset:1024
  ds_read_b128 v[8:11], v227 offset:0
  ds_read_b64_tr_b16 v[12:13], v230 offset:2048
  ds_read_b64_tr_b16 v[14:15], v230 offset:3072
  ds_read_b64_tr_b16 v[16:17], v231 offset:2048
  ds_read_b64_tr_b16 v[18:19], v231 offset:3072
  ds_read_b128 v[20:23], v227 offset:1024
  s_waitcnt lgkmcnt(8)
  v_mfma_f32_16x16x32_bf16 v[152:155], v[0:3], v[212:215], 0
  ds_read_b64_tr_b16 v[24:25], v230 offset:4096
  ds_read_b64_tr_b16 v[26:27], v230 offset:5120
  s_waitcnt lgkmcnt(8)
  v_mfma_f32_16x16x32_bf16 v[156:159], v[4:7], v[212:215], 0
  ds_read_b64_tr_b16 v[28:29], v231 offset:4096
  ds_read_b64_tr_b16 v[30:31], v231 offset:5120
  s_waitcnt lgkmcnt(9)
  v_mfma_f32_16x16x32_bf16 v[144:147], v[0:3], v[8:11], 0
  ds_read_b128 v[32:35], v227 offset:2048
  ds_read_b64_tr_b16 v[36:37], v230 offset:6144
  v_mfma_f32_16x16x32_bf16 v[148:151], v[4:7], v[8:11], 0
  ds_read_b64_tr_b16 v[38:39], v230 offset:7168
  ds_read_b64_tr_b16 v[40:41], v231 offset:6144
  s_waitcnt lgkmcnt(11)
  v_mfma_f32_16x16x32_bf16 v[152:155], v[12:15], v[212:215], v[152:155]
  ds_read_b64_tr_b16 v[42:43], v231 offset:7168
  ds_read_b128 v[44:47], v227 offset:3072
  s_waitcnt lgkmcnt(11)
  v_mfma_f32_16x16x32_bf16 v[156:159], v[16:19], v[212:215], v[156:159]
  ds_read_b64 v[254:255], v225
  ds_read_b64_tr_b16 v[96:97], v196 offset:0
  s_waitcnt lgkmcnt(12)
  v_mfma_f32_16x16x32_bf16 v[144:147], v[12:15], v[20:23], v[144:147]
  ds_read_b64_tr_b16 v[98:99], v196 offset:256
  ds_read_b64_tr_b16 v[100:101], v196 offset:2048
  v_mfma_f32_16x16x32_bf16 v[148:151], v[16:19], v[20:23], v[148:151]
  ds_read_b64_tr_b16 v[102:103], v196 offset:2304
  ds_read_b64_tr_b16 v[104:105], v197 offset:0
  s_waitcnt lgkmcnt(14)
  v_mfma_f32_16x16x32_bf16 v[152:155], v[24:27], v[212:215], v[152:155]
  ds_read_b64_tr_b16 v[106:107], v197 offset:256
  ds_read_b64_tr_b16 v[108:109], v197 offset:2048
  s_waitcnt lgkmcnt(14)
  v_mfma_f32_16x16x32_bf16 v[156:159], v[28:31], v[212:215], v[156:159]
  ds_read_b64_tr_b16 v[110:111], v197 offset:2304
  ds_read_b64_tr_b16 v[112:113], v196 offset:8192
  s_waitcnt lgkmcnt(15)
  v_mfma_f32_16x16x32_bf16 v[144:147], v[24:27], v[32:35], v[144:147]
  ds_read_b64_tr_b16 v[114:115], v196 offset:8448
  ds_read_b64_tr_b16 v[116:117], v196 offset:10240
  v_mfma_f32_16x16x32_bf16 v[148:151], v[28:31], v[32:35], v[148:151]
  ds_read_b64_tr_b16 v[118:119], v196 offset:10496
  s_waitcnt lgkmcnt(15)
  v_mfma_f32_16x16x32_bf16 v[152:155], v[36:39], v[212:215], v[152:155]
  s_waitcnt lgkmcnt(14)
  v_mfma_f32_16x16x32_bf16 v[156:159], v[40:43], v[212:215], v[156:159]
  s_waitcnt lgkmcnt(13)
  v_mfma_f32_16x16x32_bf16 v[144:147], v[36:39], v[44:47], v[144:147]
  v_mfma_f32_16x16x32_bf16 v[148:151], v[40:43], v[44:47], v[148:151]
  s_waitcnt lgkmcnt(8)
  v_mfma_f32_16x16x32_bf16 v[64:67], v[96:99], a[0:3], 0
  s_mul_i32 s79, s75, 229376
  ds_read_b64_tr_b16 v[120:121], v197 offset:8192
  v_mfma_f32_16x16x32_bf16 v[64:67], v[100:103], a[16:19], v[64:67]
  ds_read_b64_tr_b16 v[122:123], v197 offset:8448
  v_mfma_f32_16x16x32_bf16 v[72:75], v[96:99], a[4:7], 0
  ds_read_b64_tr_b16 v[124:125], v197 offset:10240
  v_mfma_f32_16x16x32_bf16 v[72:75], v[100:103], a[20:23], v[72:75]
  s_waitcnt lgkmcnt(7)
  ds_read_b64_tr_b16 v[126:127], v197 offset:10496
  v_cvt_pk_bf16_f32 v240, v152, v153
  v_mfma_f32_16x16x32_bf16 v[68:71], v[104:107], a[0:3], 0
  ds_read_b64_tr_b16 v[96:97], v196 offset:4096
  v_cvt_pk_bf16_f32 v241, v154, v155
  v_cvt_pk_bf16_f32 v242, v156, v157
  v_mfma_f32_16x16x32_bf16 v[68:71], v[108:111], a[16:19], v[68:71]
  ds_read_b64_tr_b16 v[98:99], v196 offset:4352
  v_cvt_pk_bf16_f32 v243, v158, v159
  v_mfma_f32_16x16x32_bf16 v[76:79], v[104:107], a[4:7], 0
  ds_read_b64_tr_b16 v[100:101], v196 offset:6144
  v_cvt_pk_bf16_f32 v236, v144, v145
  v_cvt_pk_bf16_f32 v237, v146, v147
  v_mfma_f32_16x16x32_bf16 v[76:79], v[108:111], a[20:23], v[76:79]
  s_waitcnt lgkmcnt(7)
  ds_read_b64_tr_b16 v[102:103], v196 offset:6400
  v_cvt_pk_bf16_f32 v238, v148, v149
  v_mfma_f32_16x16x32_bf16 v[80:83], v[112:115], a[0:3], 0
  ds_read_b64_tr_b16 v[104:105], v197 offset:4096
  v_cvt_pk_bf16_f32 v239, v150, v151
  v_mul_f32 v186, v207, v254
  v_mfma_f32_16x16x32_bf16 v[80:83], v[116:119], a[16:19], v[80:83]
  ds_read_b64_tr_b16 v[106:107], v197 offset:4352
  buffer_store_dwordx4 v[236:239], v183, s[36:39], s25 offen sc1
  v_mfma_f32_16x16x32_bf16 v[88:91], v[112:115], a[4:7], 0
  ds_read_b64_tr_b16 v[108:109], v197 offset:6144
  buffer_store_dwordx4 v[240:243], v232, s[36:39], s26 offen sc1
  v_mfma_f32_16x16x32_bf16 v[88:91], v[116:119], a[20:23], v[88:91]
  s_waitcnt lgkmcnt(7)
  ds_read_b64_tr_b16 v[110:111], v197 offset:6400
  v_mfma_f32_16x16x32_bf16 v[84:87], v[120:123], a[0:3], 0
  ds_read_b64_tr_b16 v[112:113], v196 offset:12288
  v_mfma_f32_16x16x32_bf16 v[84:87], v[124:127], a[16:19], v[84:87]
  ds_read_b64_tr_b16 v[114:115], v196 offset:12544
  v_mfma_f32_16x16x32_bf16 v[92:95], v[120:123], a[4:7], 0
  ds_read_b64_tr_b16 v[116:117], v196 offset:14336
  v_mul_f32 v187, v207, v255
  v_mfma_f32_16x16x32_bf16 v[92:95], v[124:127], a[20:23], v[92:95]
  s_waitcnt lgkmcnt(7)
  ds_read_b64_tr_b16 v[118:119], v196 offset:14592
  v_mfma_f32_16x16x32_bf16 v[64:67], v[96:99], a[32:35], v[64:67]
  ds_read_b64_tr_b16 v[120:121], v197 offset:12288
  v_exp_f32 v186, v186
  v_mfma_f32_16x16x32_bf16 v[64:67], v[100:103], a[48:51], v[64:67]
  ds_read_b64_tr_b16 v[122:123], v197 offset:12544
  v_add_f32 v186, 1.0, v186
  v_mfma_f32_16x16x32_bf16 v[72:75], v[96:99], a[36:39], v[72:75]
  ds_read_b64_tr_b16 v[124:125], v197 offset:14336
  v_exp_f32 v187, v187
  v_mfma_f32_16x16x32_bf16 v[72:75], v[100:103], a[52:55], v[72:75]
  s_waitcnt lgkmcnt(7)
  ds_read_b64_tr_b16 v[126:127], v197 offset:14592
  v_add_f32 v187, 1.0, v187
  v_mfma_f32_16x16x32_bf16 v[68:71], v[104:107], a[32:35], v[68:71]
  s_waitcnt vmcnt(15)
  s_barrier
  ds_read_b64_tr_b16 v[96:97], v196 offset:16384
  v_mfma_f32_16x16x32_bf16 v[68:71], v[108:111], a[48:51], v[68:71]
  s_add_u32 m0, s76, 49152
  ds_read_b64_tr_b16 v[98:99], v196 offset:16640
  v_mfma_f32_16x16x32_bf16 v[76:79], v[104:107], a[36:39], v[76:79]
  ds_read_b64_tr_b16 v[100:101], v196 offset:18432
  buffer_load_dwordx4 v168, s[32:35], s79 offen offset:0 lds
  v_mfma_f32_16x16x32_bf16 v[76:79], v[108:111], a[52:55], v[76:79]
  s_waitcnt lgkmcnt(7)
  ds_read_b64_tr_b16 v[102:103], v196 offset:18688
  v_mfma_f32_16x16x32_bf16 v[80:83], v[112:115], a[32:35], v[80:83]
  ds_read_b64_tr_b16 v[104:105], v197 offset:16384
  v_min_f32 v186, 0x71800000, v186
  v_mfma_f32_16x16x32_bf16 v[80:83], v[116:119], a[48:51], v[80:83]
  ds_read_b64_tr_b16 v[106:107], v197 offset:16640
  v_min_f32 v187, 0x71800000, v187
  v_mfma_f32_16x16x32_bf16 v[88:91], v[112:115], a[36:39], v[88:91]
  ds_read_b64_tr_b16 v[108:109], v197 offset:18432
  v_mfma_f32_16x16x32_bf16 v[88:91], v[116:119], a[52:55], v[88:91]
  s_waitcnt lgkmcnt(7)
  ds_read_b64_tr_b16 v[110:111], v197 offset:18688
  v_mfma_f32_16x16x32_bf16 v[84:87], v[120:123], a[32:35], v[84:87]
  ds_read_b64_tr_b16 v[112:113], v196 offset:24576
  v_mfma_f32_16x16x32_bf16 v[84:87], v[124:127], a[48:51], v[84:87]
  ds_read_b64_tr_b16 v[114:115], v196 offset:24832
  buffer_load_dwordx4 v169, s[32:35], s79 offen offset:1024 lds
  v_mfma_f32_16x16x32_bf16 v[92:95], v[120:123], a[36:39], v[92:95]
  ds_read_b64_tr_b16 v[116:117], v196 offset:26624
  v_lshrrev_b32 v169, 3, v175
  v_mfma_f32_16x16x32_bf16 v[92:95], v[124:127], a[52:55], v[92:95]
  s_waitcnt lgkmcnt(7)
  ds_read_b64_tr_b16 v[118:119], v196 offset:26880
  v_mfma_f32_16x16x32_bf16 v[64:67], v[96:99], a[64:67], v[64:67]
  ds_read_b64_tr_b16 v[120:121], v197 offset:24576
  v_mfma_f32_16x16x32_bf16 v[64:67], v[100:103], a[80:83], v[64:67]
  ds_read_b64_tr_b16 v[122:123], v197 offset:24832
  v_mfma_f32_16x16x32_bf16 v[72:75], v[96:99], a[68:71], v[72:75]
  ds_read_b64_tr_b16 v[124:125], v197 offset:26624
  v_mfma_f32_16x16x32_bf16 v[72:75], v[100:103], a[84:87], v[72:75]
  s_waitcnt lgkmcnt(7)
  ds_read_b64_tr_b16 v[126:127], v197 offset:26880
  v_mfma_f32_16x16x32_bf16 v[68:71], v[104:107], a[64:67], v[68:71]
  ds_read_b64_tr_b16 v[96:97], v196 offset:20480
  buffer_load_dwordx4 v170, s[32:35], s79 offen offset:2048 lds
  v_mfma_f32_16x16x32_bf16 v[68:71], v[108:111], a[80:83], v[68:71]
  ds_read_b64_tr_b16 v[98:99], v196 offset:20736
  v_and_b32 v170, 2, v169
  v_mfma_f32_16x16x32_bf16 v[76:79], v[104:107], a[68:71], v[76:79]
  ds_read_b64_tr_b16 v[100:101], v196 offset:22528
  v_lshl_add_u32 v169, s60, 5, v169
  v_mfma_f32_16x16x32_bf16 v[76:79], v[108:111], a[84:87], v[76:79]
  s_waitcnt lgkmcnt(7)
  ds_read_b64_tr_b16 v[102:103], v196 offset:22784
  v_mul_u32_u24 v169, 3584, v169
  v_mfma_f32_16x16x32_bf16 v[80:83], v[112:115], a[64:67], v[80:83]
  ds_read_b64_tr_b16 v[104:105], v197 offset:20480
  v_mfma_f32_16x16x32_bf16 v[80:83], v[116:119], a[80:83], v[80:83]
  ds_read_b64_tr_b16 v[106:107], v197 offset:20736
  v_mfma_f32_16x16x32_bf16 v[88:91], v[112:115], a[68:71], v[88:91]
  ds_read_b64_tr_b16 v[108:109], v197 offset:22528
  v_mfma_f32_16x16x32_bf16 v[88:91], v[116:119], a[84:87], v[88:91]
  s_waitcnt lgkmcnt(7)
  ds_read_b64_tr_b16 v[110:111], v197 offset:22784
  buffer_load_dwordx4 v171, s[32:35], s79 offen offset:3072 lds
  v_mfma_f32_16x16x32_bf16 v[84:87], v[120:123], a[64:67], v[84:87]
  s_mov_b64 s[32:33], s[80:81]
  ds_read_b64_tr_b16 v[112:113], v196 offset:28672
  v_and_b32 v171, 7, v175
  v_mfma_f32_16x16x32_bf16 v[84:87], v[124:127], a[80:83], v[84:87]
  s_mov_b32 s34, s82
  ds_read_b64_tr_b16 v[114:115], v196 offset:28928
  v_xor_b32 v170, v170, v171
  v_mfma_f32_16x16x32_bf16 v[92:95], v[120:123], a[68:71], v[92:95]
  ds_read_b64_tr_b16 v[116:117], v196 offset:30720
  v_lshl_add_u32 v168, v170, 4, v169
  v_mfma_f32_16x16x32_bf16 v[92:95], v[124:127], a[84:87], v[92:95]
  s_waitcnt lgkmcnt(7)
  ds_read_b64_tr_b16 v[118:119], v196 offset:30976
  v_xor_b32 v169, 64, v168
  v_mfma_f32_16x16x32_bf16 v[64:67], v[96:99], a[96:99], v[64:67]
  ds_read_b64_tr_b16 v[120:121], v197 offset:28672
  v_add_u32 v169, 27648, v169
  v_mfma_f32_16x16x32_bf16 v[64:67], v[100:103], a[112:115], v[64:67]
  ds_read_b64_tr_b16 v[122:123], v197 offset:28928
  v_add_u32 v170, 55296, v168
  v_mfma_f32_16x16x32_bf16 v[72:75], v[96:99], a[100:103], v[72:75]
  s_mul_i32 s79, s64, 229376
  ds_read_b64_tr_b16 v[124:125], v197 offset:30720
  v_add_u32 v171, 55296, v169
  v_mfma_f32_16x16x32_bf16 v[72:75], v[100:103], a[116:119], v[72:75]
  s_waitcnt lgkmcnt(7)
  ds_read_b64_tr_b16 v[126:127], v197 offset:30976
  v_mfma_f32_16x16x32_bf16 v[68:71], v[104:107], a[96:99], v[68:71]
  s_waitcnt vmcnt(15)
  s_barrier
  ds_read_b64_tr_b16 v[96:97], v196 offset:32768
  v_mfma_f32_16x16x32_bf16 v[68:71], v[108:111], a[112:115], v[68:71]
  s_add_u32 m0, s76, 0
  ds_read_b64_tr_b16 v[98:99], v196 offset:33024
  buffer_load_dwordx4 v168, s[32:35], s79 offen offset:0 lds
  v_mfma_f32_16x16x32_bf16 v[76:79], v[104:107], a[100:103], v[76:79]
  ds_read_b64_tr_b16 v[100:101], v196 offset:34816
  s_add_u32 s78, s91, 786432
  v_mfma_f32_16x16x32_bf16 v[76:79], v[108:111], a[116:119], v[76:79]
  s_waitcnt lgkmcnt(7)
  ds_read_b64_tr_b16 v[102:103], v196 offset:35072
  v_mfma_f32_16x16x32_bf16 v[80:83], v[112:115], a[96:99], v[80:83]
  ds_read_b64_tr_b16 v[104:105], v197 offset:32768
  v_mfma_f32_16x16x32_bf16 v[80:83], v[116:119], a[112:115], v[80:83]
  ds_read_b64_tr_b16 v[106:107], v197 offset:33024
  buffer_load_dwordx4 v169, s[32:35], s79 offen offset:1024 lds
  v_mfma_f32_16x16x32_bf16 v[88:91], v[112:115], a[100:103], v[88:91]
  ds_read_b64_tr_b16 v[108:109], v197 offset:34816
  v_mfma_f32_16x16x32_bf16 v[88:91], v[116:119], a[116:119], v[88:91]
  s_waitcnt lgkmcnt(7)
  ds_read_b64_tr_b16 v[110:111], v197 offset:35072
  v_mfma_f32_16x16x32_bf16 v[84:87], v[120:123], a[96:99], v[84:87]
  ds_read_b64_tr_b16 v[112:113], v196 offset:40960
  v_mfma_f32_16x16x32_bf16 v[84:87], v[124:127], a[112:115], v[84:87]
  ds_read_b64_tr_b16 v[114:115], v196 offset:41216
  buffer_load_dwordx4 v170, s[32:35], s79 offen offset:2048 lds
  v_mfma_f32_16x16x32_bf16 v[92:95], v[120:123], a[100:103], v[92:95]
  ds_read_b64_tr_b16 v[116:117], v196 offset:43008
  v_mfma_f32_16x16x32_bf16 v[92:95], v[124:127], a[116:119], v[92:95]
  s_waitcnt lgkmcnt(7)
  ds_read_b64_tr_b16 v[118:119], v196 offset:43264
  v_mfma_f32_16x16x32_bf16 v[64:67], v[96:99], a[128:131], v[64:67]
  ds_read_b64_tr_b16 v[120:121], v197 offset:40960
  v_mfma_f32_16x16x32_bf16 v[64:67], v[100:103], a[144:147], v[64:67]
  ds_read_b64_tr_b16 v[122:123], v197 offset:41216
  buffer_load_dwordx4 v171, s[32:35], s79 offen offset:3072 lds
  v_mfma_f32_16x16x32_bf16 v[72:75], v[96:99], a[132:135], v[72:75]
  s_mul_i32 s79, s65, 229376
  ds_read_b64_tr_b16 v[124:125], v197 offset:43008
  s_add_u32 m0, s77, 65536
  v_mfma_f32_16x16x32_bf16 v[72:75], v[100:103], a[148:151], v[72:75]
  s_waitcnt lgkmcnt(7)
  ds_read_b64_tr_b16 v[126:127], v197 offset:43264
  v_mfma_f32_16x16x32_bf16 v[68:71], v[104:107], a[128:131], v[68:71]
  ds_read_b64_tr_b16 v[96:97], v196 offset:36864
  v_mfma_f32_16x16x32_bf16 v[68:71], v[108:111], a[144:147], v[68:71]
  ds_read_b64_tr_b16 v[98:99], v196 offset:37120
  buffer_load_dwordx4 v164, s[40:43], s78 offen offset:0 lds
  v_mfma_f32_16x16x32_bf16 v[76:79], v[104:107], a[132:135], v[76:79]
  ds_read_b64_tr_b16 v[100:101], v196 offset:38912
  v_mfma_f32_16x16x32_bf16 v[76:79], v[108:111], a[148:151], v[76:79]
  s_waitcnt lgkmcnt(7)
  ds_read_b64_tr_b16 v[102:103], v196 offset:39168
  v_mfma_f32_16x16x32_bf16 v[80:83], v[112:115], a[128:131], v[80:83]
  ds_read_b64_tr_b16 v[104:105], v197 offset:36864
  v_mfma_f32_16x16x32_bf16 v[80:83], v[116:119], a[144:147], v[80:83]
  ds_read_b64_tr_b16 v[106:107], v197 offset:37120
  buffer_load_dwordx4 v165, s[40:43], s78 offen offset:1024 lds
  v_mfma_f32_16x16x32_bf16 v[88:91], v[112:115], a[132:135], v[88:91]
  ds_read_b64_tr_b16 v[108:109], v197 offset:38912
  v_mfma_f32_16x16x32_bf16 v[88:91], v[116:119], a[148:151], v[88:91]
  s_waitcnt lgkmcnt(7)
  ds_read_b64_tr_b16 v[110:111], v197 offset:39168
  v_mfma_f32_16x16x32_bf16 v[84:87], v[120:123], a[128:131], v[84:87]
  ds_read_b64_tr_b16 v[112:113], v196 offset:45056
  v_mfma_f32_16x16x32_bf16 v[84:87], v[124:127], a[144:147], v[84:87]
  ds_read_b64_tr_b16 v[114:115], v196 offset:45312
  buffer_load_dwordx4 v166, s[40:43], s78 offen offset:2048 lds
  v_mfma_f32_16x16x32_bf16 v[92:95], v[120:123], a[132:135], v[92:95]
  ds_read_b64_tr_b16 v[116:117], v196 offset:47104
  v_mfma_f32_16x16x32_bf16 v[92:95], v[124:127], a[148:151], v[92:95]
  s_waitcnt lgkmcnt(7)
  ds_read_b64_tr_b16 v[118:119], v196 offset:47360
  v_mfma_f32_16x16x32_bf16 v[64:67], v[96:99], a[160:163], v[64:67]
  ds_read_b64_tr_b16 v[120:121], v197 offset:45056
  v_mfma_f32_16x16x32_bf16 v[64:67], v[100:103], a[176:179], v[64:67]
  ds_read_b64_tr_b16 v[122:123], v197 offset:45312
  buffer_load_dwordx4 v167, s[40:43], s78 offen offset:3072 lds
  v_mfma_f32_16x16x32_bf16 v[72:75], v[96:99], a[164:167], v[72:75]
  ds_read_b64_tr_b16 v[124:125], v197 offset:47104
  v_mfma_f32_16x16x32_bf16 v[72:75], v[100:103], a[180:183], v[72:75]
  s_waitcnt lgkmcnt(7)
  ds_read_b64_tr_b16 v[126:127], v197 offset:47360
  v_mfma_f32_16x16x32_bf16 v[68:71], v[104:107], a[160:163], v[68:71]
  s_waitcnt vmcnt(8)
  s_barrier
  buffer_store_dword v176, v182, s[36:39], 0 offen offset:0 sc1
  ds_read_b64_tr_b16 v[96:97], v196 offset:49152
  v_mfma_f32_16x16x32_bf16 v[68:71], v[108:111], a[176:179], v[68:71]
  s_add_u32 m0, s76, 16384
  ds_read_b64_tr_b16 v[98:99], v196 offset:49408
  buffer_load_dwordx4 v168, s[32:35], s79 offen offset:0 lds
  v_mfma_f32_16x16x32_bf16 v[76:79], v[104:107], a[164:167], v[76:79]
  ds_read_b64_tr_b16 v[100:101], v196 offset:51200
  v_mfma_f32_16x16x32_bf16 v[76:79], v[108:111], a[180:183], v[76:79]
  s_waitcnt lgkmcnt(7)
  ds_read_b64_tr_b16 v[102:103], v196 offset:51456
  s_add_u32 s78, s91, 819200
  v_mfma_f32_16x16x32_bf16 v[80:83], v[112:115], a[160:163], v[80:83]
  ds_read_b64_tr_b16 v[104:105], v197 offset:49152
  v_mfma_f32_16x16x32_bf16 v[80:83], v[116:119], a[176:179], v[80:83]
  ds_read_b64_tr_b16 v[106:107], v197 offset:49408
  buffer_load_dwordx4 v169, s[32:35], s79 offen offset:1024 lds
  v_mfma_f32_16x16x32_bf16 v[88:91], v[112:115], a[164:167], v[88:91]
  ds_read_b64_tr_b16 v[108:109], v197 offset:51200
  v_mfma_f32_16x16x32_bf16 v[88:91], v[116:119], a[180:183], v[88:91]
  s_waitcnt lgkmcnt(7)
  ds_read_b64_tr_b16 v[110:111], v197 offset:51456
  v_mfma_f32_16x16x32_bf16 v[84:87], v[120:123], a[160:163], v[84:87]
  ds_read_b64_tr_b16 v[112:113], v196 offset:57344
  v_mfma_f32_16x16x32_bf16 v[84:87], v[124:127], a[176:179], v[84:87]
  ds_read_b64_tr_b16 v[114:115], v196 offset:57600
  buffer_load_dwordx4 v170, s[32:35], s79 offen offset:2048 lds
  v_mfma_f32_16x16x32_bf16 v[92:95], v[120:123], a[164:167], v[92:95]
  ds_read_b64_tr_b16 v[116:117], v196 offset:59392
  v_mfma_f32_16x16x32_bf16 v[92:95], v[124:127], a[180:183], v[92:95]
  s_waitcnt lgkmcnt(7)
  ds_read_b64_tr_b16 v[118:119], v196 offset:59648
  v_mfma_f32_16x16x32_bf16 v[64:67], v[96:99], a[192:195], v[64:67]
  ds_read_b64_tr_b16 v[120:121], v197 offset:57344
  v_mfma_f32_16x16x32_bf16 v[64:67], v[100:103], a[208:211], v[64:67]
  ds_read_b64_tr_b16 v[122:123], v197 offset:57600
  buffer_load_dwordx4 v171, s[32:35], s79 offen offset:3072 lds
  v_mfma_f32_16x16x32_bf16 v[72:75], v[96:99], a[196:199], v[72:75]
  s_mul_i32 s79, s66, 229376
  ds_read_b64_tr_b16 v[124:125], v197 offset:59392
  s_add_u32 m0, s77, 69632
  v_mfma_f32_16x16x32_bf16 v[72:75], v[100:103], a[212:215], v[72:75]
  s_waitcnt lgkmcnt(7)
  ds_read_b64_tr_b16 v[126:127], v197 offset:59648
  v_mfma_f32_16x16x32_bf16 v[68:71], v[104:107], a[192:195], v[68:71]
  ds_read_b64_tr_b16 v[96:97], v196 offset:53248
  v_mfma_f32_16x16x32_bf16 v[68:71], v[108:111], a[208:211], v[68:71]
  ds_read_b64_tr_b16 v[98:99], v196 offset:53504
  buffer_load_dwordx4 v164, s[40:43], s78 offen offset:0 lds
  v_mfma_f32_16x16x32_bf16 v[76:79], v[104:107], a[196:199], v[76:79]
  ds_read_b64_tr_b16 v[100:101], v196 offset:55296
  v_mfma_f32_16x16x32_bf16 v[76:79], v[108:111], a[212:215], v[76:79]
  s_waitcnt lgkmcnt(7)
  ds_read_b64_tr_b16 v[102:103], v196 offset:55552
  v_mfma_f32_16x16x32_bf16 v[80:83], v[112:115], a[192:195], v[80:83]
  ds_read_b64_tr_b16 v[104:105], v197 offset:53248
  v_mfma_f32_16x16x32_bf16 v[80:83], v[116:119], a[208:211], v[80:83]
  ds_read_b64_tr_b16 v[106:107], v197 offset:53504
  buffer_load_dwordx4 v165, s[40:43], s78 offen offset:1024 lds
  v_mfma_f32_16x16x32_bf16 v[88:91], v[112:115], a[196:199], v[88:91]
  ds_read_b64_tr_b16 v[108:109], v197 offset:55296
  v_mfma_f32_16x16x32_bf16 v[88:91], v[116:119], a[212:215], v[88:91]
  s_waitcnt lgkmcnt(7)
  ds_read_b64_tr_b16 v[110:111], v197 offset:55552
  v_mfma_f32_16x16x32_bf16 v[84:87], v[120:123], a[192:195], v[84:87]
  ds_read_b64_tr_b16 v[112:113], v196 offset:61440
  v_mfma_f32_16x16x32_bf16 v[84:87], v[124:127], a[208:211], v[84:87]
  ds_read_b64_tr_b16 v[114:115], v196 offset:61696
  buffer_load_dwordx4 v166, s[40:43], s78 offen offset:2048 lds
  v_mfma_f32_16x16x32_bf16 v[92:95], v[120:123], a[196:199], v[92:95]
  ds_read_b64_tr_b16 v[116:117], v196 offset:63488
  v_mfma_f32_16x16x32_bf16 v[92:95], v[124:127], a[212:215], v[92:95]
  s_waitcnt lgkmcnt(7)
  ds_read_b64_tr_b16 v[118:119], v196 offset:63744
  v_mfma_f32_16x16x32_bf16 v[64:67], v[96:99], a[224:227], v[64:67]
  ds_read_b64_tr_b16 v[120:121], v197 offset:61440
  v_mfma_f32_16x16x32_bf16 v[64:67], v[100:103], a[240:243], v[64:67]
  ds_read_b64_tr_b16 v[122:123], v197 offset:61696
  buffer_load_dwordx4 v167, s[40:43], s78 offen offset:3072 lds
  v_mfma_f32_16x16x32_bf16 v[72:75], v[96:99], a[228:231], v[72:75]
  ds_read_b64_tr_b16 v[124:125], v197 offset:63488
  v_mfma_f32_16x16x32_bf16 v[72:75], v[100:103], a[244:247], v[72:75]
  s_waitcnt lgkmcnt(7)
  ds_read_b64_tr_b16 v[126:127], v197 offset:63744
  v_mfma_f32_16x16x32_bf16 v[68:71], v[104:107], a[224:227], v[68:71]
  s_waitcnt vmcnt(13)
  s_barrier
  ds_read_b64_tr_b16 v[216:217], v172 offset:0
  v_mfma_f32_16x16x32_bf16 v[68:71], v[108:111], a[240:243], v[68:71]
  s_add_u32 m0, s76, 32768
  s_nop 0
  buffer_load_dwordx4 v168, s[32:35], s79 offen offset:0 lds
  v_mfma_f32_16x16x32_bf16 v[76:79], v[104:107], a[228:231], v[76:79]
  ds_read_b64_tr_b16 v[218:219], v172 offset:512
  s_add_u32 s78, s92, 524288
  v_mfma_f32_16x16x32_bf16 v[76:79], v[108:111], a[244:247], v[76:79]
  s_waitcnt lgkmcnt(6)
  v_mfma_f32_16x16x32_bf16 v[80:83], v[112:115], a[224:227], v[80:83]
  ds_read_b64_tr_b16 v[220:221], v172 offset:4096
  v_mfma_f32_16x16x32_bf16 v[80:83], v[116:119], a[240:243], v[80:83]
  buffer_load_dwordx4 v169, s[32:35], s79 offen offset:1024 lds
  v_mfma_f32_16x16x32_bf16 v[88:91], v[112:115], a[228:231], v[88:91]
  ds_read_b64_tr_b16 v[222:223], v172 offset:4608
  v_mfma_f32_16x16x32_bf16 v[88:91], v[116:119], a[244:247], v[88:91]
  s_waitcnt lgkmcnt(4)
  v_mfma_f32_16x16x32_bf16 v[84:87], v[120:123], a[224:227], v[84:87]
  ds_read_b64_tr_b16 v[128:129], v173 offset:0
  v_mfma_f32_16x16x32_bf16 v[84:87], v[124:127], a[240:243], v[84:87]
  buffer_load_dwordx4 v170, s[32:35], s79 offen offset:2048 lds
  v_mfma_f32_16x16x32_bf16 v[92:95], v[120:123], a[228:231], v[92:95]
  ds_read_b64_tr_b16 v[130:131], v173 offset:512
  v_mfma_f32_16x16x32_bf16 v[92:95], v[124:127], a[244:247], v[92:95]
  s_waitcnt lgkmcnt(2)
  v_mfma_f32_16x16x32_bf16 v[32:35], v[216:219], a[0:3], 0
  ds_read_b64_tr_b16 v[132:133], v173 offset:4096
  v_mfma_f32_16x16x32_bf16 v[32:35], v[220:223], a[16:19], v[32:35]
  buffer_load_dwordx4 v171, s[32:35], s79 offen offset:3072 lds
  v_mfma_f32_16x16x32_bf16 v[40:43], v[216:219], a[4:7], 0
  s_mul_i32 s79, s67, 229376
  ds_read_b64_tr_b16 v[134:135], v173 offset:4608
  v_mfma_f32_16x16x32_bf16 v[40:43], v[220:223], a[20:23], v[40:43]
  s_add_u32 m0, s77, 98304
  v_mul_f32 v208, v64, v64
  v_mul_f32 v209, v65, v65
  v_mfma_f32_16x16x32_bf16 v[48:51], v[216:219], a[8:11], 0
  ds_read_b64_tr_b16 v[136:137], v172 offset:8192
  v_mul_f32 v210, v66, v66
  v_mul_f32 v211, v67, v67
  v_mfma_f32_16x16x32_bf16 v[48:51], v[220:223], a[24:27], v[48:51]
  buffer_load_dwordx4 v164, s[40:43], s78 offen offset:0 lds
  v_mfma_f32_16x16x32_bf16 v[56:59], v[216:219], a[12:15], 0
  ds_read_b64_tr_b16 v[138:139], v172 offset:8704
  v_mul_f32 v212, v68, v68
  v_mul_f32 v213, v69, v69
  v_mfma_f32_16x16x32_bf16 v[56:59], v[220:223], a[28:31], v[56:59]
  s_waitcnt lgkmcnt(2)
  v_mul_f32 v214, v70, v70
  v_mul_f32 v215, v71, v71
  v_mfma_f32_16x16x32_bf16 v[36:39], v[128:131], a[0:3], 0
  ds_read_b64_tr_b16 v[140:141], v172 offset:12288
  v_fmamk_f32 v208, v208, 0xbdd2d3e8, v206
  v_fmamk_f32 v209, v209, 0xbdd2d3e8, v206
  v_mfma_f32_16x16x32_bf16 v[36:39], v[132:135], a[16:19], v[36:39]
  buffer_load_dwordx4 v165, s[40:43], s78 offen offset:1024 lds
  v_mfma_f32_16x16x32_bf16 v[44:47], v[128:131], a[4:7], 0
  ds_read_b64_tr_b16 v[142:143], v172 offset:12800
  v_fmamk_f32 v210, v210, 0xbdd2d3e8, v206
  v_fmamk_f32 v211, v211, 0xbdd2d3e8, v206
  v_mfma_f32_16x16x32_bf16 v[44:47], v[132:135], a[20:23], v[44:47]
  v_fmamk_f32 v212, v212, 0xbdd2d3e8, v206
  v_fmamk_f32 v213, v213, 0xbdd2d3e8, v206
  v_mfma_f32_16x16x32_bf16 v[52:55], v[128:131], a[8:11], 0
  ds_read_b64_tr_b16 v[216:217], v173 offset:8192
  v_fmamk_f32 v214, v214, 0xbdd2d3e8, v206
  v_fmamk_f32 v215, v215, 0xbdd2d3e8, v206
  v_mfma_f32_16x16x32_bf16 v[52:55], v[132:135], a[24:27], v[52:55]
  buffer_load_dwordx4 v166, s[40:43], s78 offen offset:2048 lds
  v_mfma_f32_16x16x32_bf16 v[60:63], v[128:131], a[12:15], 0
  ds_read_b64_tr_b16 v[218:219], v173 offset:8704
  v_mul_f32 v208, v208, v64
  v_mul_f32 v209, v209, v65
  v_mfma_f32_16x16x32_bf16 v[60:63], v[132:135], a[28:31], v[60:63]
  s_waitcnt lgkmcnt(2)
  v_exp_f32 v208, v208
  v_mfma_f32_16x16x32_bf16 v[96:99], v[136:139], a[0:3], 0
  ds_read_b64_tr_b16 v[220:221], v173 offset:12288
  v_exp_f32 v209, v209
  v_mfma_f32_16x16x32_bf16 v[96:99], v[140:143], a[16:19], v[96:99]
  buffer_load_dwordx4 v167, s[40:43], s78 offen offset:3072 lds
L_pgK3:
  s_cbranch_execz L_back
  v_mfma_f32_16x16x32_bf16 v[104:107], v[136:139], a[4:7], 0
  ds_read_b64_tr_b16 v[222:223], v173 offset:12800
  v_mul_f32 v210, v210, v66
  v_mul_f32 v211, v211, v67
  v_mfma_f32_16x16x32_bf16 v[104:107], v[140:143], a[20:23], v[104:107]
  v_exp_f32 v210, v210
  v_mfma_f32_16x16x32_bf16 v[112:115], v[136:139], a[8:11], 0
  s_waitcnt vmcnt(12)
  s_barrier
  ds_read_b64_tr_b16 v[128:129], v172 offset:16384
  v_mfma_f32_16x16x32_bf16 v[112:115], v[140:143], a[24:27], v[112:115]
  s_add_u32 m0, s76, 49152
  s_nop 0
  buffer_load_dwordx4 v168, s[32:35], s79 offen offset:0 lds
  v_mfma_f32_16x16x32_bf16 v[120:123], v[136:139], a[12:15], 0
  ds_read_b64_tr_b16 v[130:131], v172 offset:16896
  s_add_u32 s78, s92, 557056
  v_mfma_f32_16x16x32_bf16 v[120:123], v[140:143], a[28:31], v[120:123]
  s_waitcnt lgkmcnt(2)
  v_exp_f32 v211, v211
  v_mfma_f32_16x16x32_bf16 v[100:103], v[216:219], a[0:3], 0
  ds_read_b64_tr_b16 v[132:133], v172 offset:20480
  v_mul_f32 v212, v212, v68
  v_mul_f32 v213, v213, v69
  v_mfma_f32_16x16x32_bf16 v[100:103], v[220:223], a[16:19], v[100:103]
  buffer_load_dwordx4 v169, s[32:35], s79 offen offset:1024 lds
  v_mfma_f32_16x16x32_bf16 v[108:111], v[216:219], a[4:7], 0
  ds_read_b64_tr_b16 v[134:135], v172 offset:20992
  v_exp_f32 v212, v212
  v_mfma_f32_16x16x32_bf16 v[108:111], v[220:223], a[20:23], v[108:111]
  v_exp_f32 v213, v213
  v_mfma_f32_16x16x32_bf16 v[116:119], v[216:219], a[8:11], 0
  ds_read_b64_tr_b16 v[136:137], v173 offset:16384
  v_mul_f32 v214, v214, v70
  v_mul_f32 v215, v215, v71
  v_mfma_f32_16x16x32_bf16 v[116:119], v[220:223], a[24:27], v[116:119]
  buffer_load_dwordx4 v170, s[32:35], s79 offen offset:2048 lds
  v_mfma_f32_16x16x32_bf16 v[124:127], v[216:219], a[12:15], 0
  ds_read_b64_tr_b16 v[138:139], v173 offset:16896
  v_exp_f32 v214, v214
  v_mfma_f32_16x16x32_bf16 v[124:127], v[220:223], a[28:31], v[124:127]
  s_waitcnt lgkmcnt(2)
  v_exp_f32 v215, v215
  v_mfma_f32_16x16x32_bf16 v[32:35], v[128:131], a[32:35], v[32:35]
  ds_read_b64_tr_b16 v[140:141], v173 offset:20480
  ds_read_b64_tr_b16 a[0:1], v200 offset:0
  v_mul_f32 v80, v64, v80
  v_mfma_f32_16x16x32_bf16 v[32:35], v[132:135], a[48:51], v[32:35]
  buffer_load_dwordx4 v171, s[32:35], s79 offen offset:3072 lds
  v_mfma_f32_16x16x32_bf16 v[40:43], v[128:131], a[36:39], v[40:43]
  s_mul_i32 s79, s68, 229376
  ds_read_b64_tr_b16 v[142:143], v173 offset:20992
  ds_read_b64_tr_b16 a[2:3], v200 offset:2048
  v_mul_f32 v81, v65, v81
  v_mfma_f32_16x16x32_bf16 v[40:43], v[132:135], a[52:55], v[40:43]
  s_add_u32 m0, s77, 102400
  ds_read_b64_tr_b16 a[4:5], v201 offset:0
  v_mul_f32 v82, v66, v82
  v_mfma_f32_16x16x32_bf16 v[48:51], v[128:131], a[40:43], v[48:51]
  ds_read_b64_tr_b16 v[216:217], v172 offset:24576
  ds_read_b64_tr_b16 a[6:7], v201 offset:2048
  v_mul_f32 v83, v67, v83
  v_mfma_f32_16x16x32_bf16 v[48:51], v[132:135], a[56:59], v[48:51]
  buffer_load_dwordx4 v164, s[40:43], s78 offen offset:0 lds
  v_mfma_f32_16x16x32_bf16 v[56:59], v[128:131], a[44:47], v[56:59]
  ds_read_b64_tr_b16 v[218:219], v172 offset:25088
  ds_read_b64_tr_b16 a[8:9], v202 offset:0
  v_mul_f32 v84, v68, v84
  v_mfma_f32_16x16x32_bf16 v[56:59], v[132:135], a[60:63], v[56:59]
  s_waitcnt lgkmcnt(6)
  ds_read_b64_tr_b16 a[10:11], v202 offset:2048
  v_mul_f32 v85, v69, v85
  v_mfma_f32_16x16x32_bf16 v[36:39], v[136:139], a[32:35], v[36:39]
  ds_read_b64_tr_b16 v[220:221], v172 offset:28672
  ds_read_b64_tr_b16 a[12:13], v203 offset:0
  v_mul_f32 v86, v70, v86
  v_mfma_f32_16x16x32_bf16 v[36:39], v[140:143], a[48:51], v[36:39]
  buffer_load_dwordx4 v165, s[40:43], s78 offen offset:1024 lds
  v_mfma_f32_16x16x32_bf16 v[44:47], v[136:139], a[36:39], v[44:47]
  ds_read_b64_tr_b16 v[222:223], v172 offset:29184
  ds_read_b64_tr_b16 a[14:15], v203 offset:2048
  v_mul_f32 v87, v71, v87
  v_mfma_f32_16x16x32_bf16 v[44:47], v[140:143], a[52:55], v[44:47]
  ds_read_b64_tr_b16 a[16:17], v200 offset:4096
  v_fma_f32 v208, v208, v184, v184
  v_mfma_f32_16x16x32_bf16 v[52:55], v[136:139], a[40:43], v[52:55]
  ds_read_b64_tr_b16 v[128:129], v173 offset:24576
  ds_read_b64_tr_b16 a[18:19], v200 offset:6144
  v_fma_f32 v209, v209, v184, v184
  v_mfma_f32_16x16x32_bf16 v[52:55], v[140:143], a[56:59], v[52:55]
  buffer_load_dwordx4 v166, s[40:43], s78 offen offset:2048 lds
  v_mfma_f32_16x16x32_bf16 v[60:63], v[136:139], a[44:47], v[60:63]
  ds_read_b64_tr_b16 v[130:131], v173 offset:25088
  ds_read_b64_tr_b16 a[20:21], v201 offset:4096
  v_fma_f32 v210, v210, v184, v184
  v_mfma_f32_16x16x32_bf16 v[60:63], v[140:143], a[60:63], v[60:63]
  s_waitcnt lgkmcnt(6)
  ds_read_b64_tr_b16 a[22:23], v201 offset:6144
  v_fma_f32 v211, v211, v184, v184
  v_mfma_f32_16x16x32_bf16 v[96:99], v[216:219], a[32:35], v[96:99]
  ds_read_b64_tr_b16 v[132:133], v173 offset:28672
  ds_read_b64_tr_b16 a[24:25], v202 offset:4096
  v_fma_f32 v212, v212, v184, v184
  v_mfma_f32_16x16x32_bf16 v[96:99], v[220:223], a[48:51], v[96:99]
  buffer_load_dwordx4 v167, s[40:43], s78 offen offset:3072 lds
  v_mfma_f32_16x16x32_bf16 v[104:107], v[216:219], a[36:39], v[104:107]
  ds_read_b64_tr_b16 v[134:135], v173 offset:29184
  ds_read_b64_tr_b16 a[26:27], v202 offset:6144
  v_fma_f32 v213, v213, v184, v184
  v_mfma_f32_16x16x32_bf16 v[104:107], v[220:223], a[52:55], v[104:107]
  ds_read_b64_tr_b16 a[28:29], v203 offset:4096
  v_fma_f32 v214, v214, v184, v184
  v_mfma_f32_16x16x32_bf16 v[112:115], v[216:219], a[40:43], v[112:115]
  s_waitcnt vmcnt(12)
  s_barrier
  ds_read_b64_tr_b16 v[136:137], v172 offset:32768
  v_mfma_f32_16x16x32_bf16 v[112:115], v[220:223], a[56:59], v[112:115]
  s_add_u32 m0, s76, 0
  s_nop 0
  buffer_load_dwordx4 v168, s[32:35], s79 offen offset:0 lds
  v_mfma_f32_16x16x32_bf16 v[120:123], v[216:219], a[44:47], v[120:123]
  ds_read_b64_tr_b16 v[138:139], v172 offset:33280
  ds_read_b64_tr_b16 a[30:31], v203 offset:6144
  v_mfma_f32_16x16x32_bf16 v[120:123], v[220:223], a[60:63], v[120:123]
  s_waitcnt lgkmcnt(5)
  v_rcp_f32 v208, v208
  v_mfma_f32_16x16x32_bf16 v[100:103], v[128:131], a[32:35], v[100:103]
  ds_read_b64_tr_b16 v[140:141], v172 offset:36864
  v_rcp_f32 v209, v209
  v_mfma_f32_16x16x32_bf16 v[100:103], v[132:135], a[48:51], v[100:103]
  buffer_load_dwordx4 v169, s[32:35], s79 offen offset:1024 lds
  v_mfma_f32_16x16x32_bf16 v[108:111], v[128:131], a[36:39], v[108:111]
  ds_read_b64_tr_b16 v[142:143], v172 offset:37376
  v_rcp_f32 v210, v210
  v_mfma_f32_16x16x32_bf16 v[108:111], v[132:135], a[52:55], v[108:111]
  v_rcp_f32 v211, v211
  v_mfma_f32_16x16x32_bf16 v[116:119], v[128:131], a[40:43], v[116:119]
  ds_read_b64_tr_b16 v[216:217], v173 offset:32768
  v_rcp_f32 v212, v212
  v_mfma_f32_16x16x32_bf16 v[116:119], v[132:135], a[56:59], v[116:119]
  buffer_load_dwordx4 v170, s[32:35], s79 offen offset:2048 lds
  v_mfma_f32_16x16x32_bf16 v[124:127], v[128:131], a[44:47], v[124:127]
  ds_read_b64_tr_b16 v[218:219], v173 offset:33280
  v_rcp_f32 v213, v213
  v_mfma_f32_16x16x32_bf16 v[124:127], v[132:135], a[60:63], v[124:127]
  s_waitcnt lgkmcnt(2)
  v_rcp_f32 v214, v214
  v_mfma_f32_16x16x32_bf16 v[32:35], v[136:139], a[64:67], v[32:35]
  ds_read_b64_tr_b16 v[220:221], v173 offset:36864
  ds_read_b64_tr_b16 a[32:33], v160 offset:0
  v_fma_f32 v215, v215, v184, v184
  v_mfma_f32_16x16x32_bf16 v[32:35], v[140:143], a[80:83], v[32:35]
  buffer_load_dwordx4 v171, s[32:35], s79 offen offset:3072 lds
  v_mfma_f32_16x16x32_bf16 v[40:43], v[136:139], a[68:71], v[40:43]
  s_mul_i32 s79, s69, 229376
  ds_read_b64_tr_b16 v[222:223], v173 offset:37376
  ds_read_b64_tr_b16 a[34:35], v160 offset:2048
  v_mul_f32 v80, v80, v208
  v_mfma_f32_16x16x32_bf16 v[40:43], v[140:143], a[84:87], v[40:43]
  ds_read_b64_tr_b16 a[36:37], v161 offset:0
  s_add_u32 m0, s77, 131072
  v_mfma_f32_16x16x32_bf16 v[48:51], v[136:139], a[72:75], v[48:51]
  s_add_u32 s78, s90, 0
  ds_read_b64_tr_b16 v[128:129], v172 offset:40960
  ds_read_b64_tr_b16 a[38:39], v161 offset:2048
  v_mul_f32 v81, v81, v209
  v_mfma_f32_16x16x32_bf16 v[48:51], v[140:143], a[88:91], v[48:51]
  buffer_load_dwordx4 v164, s[44:47], s78 offen offset:0 lds
  v_mfma_f32_16x16x32_bf16 v[56:59], v[136:139], a[76:79], v[56:59]
  ds_read_b64_tr_b16 v[130:131], v172 offset:41472
  ds_read_b64_tr_b16 a[40:41], v162 offset:0
  v_mul_f32 v82, v82, v210
  v_mfma_f32_16x16x32_bf16 v[56:59], v[140:143], a[92:95], v[56:59]
  s_waitcnt lgkmcnt(6)
  ds_read_b64_tr_b16 a[42:43], v162 offset:2048
  v_mul_f32 v83, v83, v211
  v_mfma_f32_16x16x32_bf16 v[36:39], v[216:219], a[64:67], v[36:39]
  ds_read_b64_tr_b16 v[132:133], v172 offset:45056
  ds_read_b64_tr_b16 a[44:45], v163 offset:0
  v_mul_f32 v84, v84, v212
  v_mfma_f32_16x16x32_bf16 v[36:39], v[220:223], a[80:83], v[36:39]
  buffer_load_dwordx4 v165, s[44:47], s78 offen offset:1024 lds
  v_mfma_f32_16x16x32_bf16 v[44:47], v[216:219], a[68:71], v[44:47]
  ds_read_b64_tr_b16 v[134:135], v172 offset:45568
  ds_read_b64_tr_b16 a[46:47], v163 offset:2048
  v_mul_f32 v85, v85, v213
  v_mfma_f32_16x16x32_bf16 v[44:47], v[220:223], a[84:87], v[44:47]
  ds_read_b64_tr_b16 a[48:49], v160 offset:4096
  v_mul_f32 v86, v86, v214
  v_mfma_f32_16x16x32_bf16 v[52:55], v[216:219], a[72:75], v[52:55]
  ds_read_b64_tr_b16 v[136:137], v173 offset:40960
  ds_read_b64_tr_b16 a[50:51], v160 offset:6144
  v_cvt_pk_bf16_f32 v144, v80, v81
  v_mfma_f32_16x16x32_bf16 v[52:55], v[220:223], a[88:91], v[52:55]
  buffer_load_dwordx4 v166, s[44:47], s78 offen offset:2048 lds
  v_mfma_f32_16x16x32_bf16 v[60:63], v[216:219], a[76:79], v[60:63]
  ds_read_b64_tr_b16 v[138:139], v173 offset:41472
  ds_read_b64_tr_b16 a[52:53], v161 offset:4096
  v_cvt_pk_bf16_f32 v145, v82, v83
  v_mfma_f32_16x16x32_bf16 v[60:63], v[220:223], a[92:95], v[60:63]
  s_waitcnt lgkmcnt(6)
  ds_read_b64_tr_b16 a[54:55], v161 offset:6144
  v_cvt_pk_bf16_f32 v146, v84, v85
  v_mfma_f32_16x16x32_bf16 v[96:99], v[128:131], a[64:67], v[96:99]
  ds_read_b64_tr_b16 v[140:141], v173 offset:45056
  ds_read_b64_tr_b16 a[56:57], v162 offset:4096
  v_mul_f32 v208, v72, v72
  v_mfma_f32_16x16x32_bf16 v[96:99], v[132:135], a[80:83], v[96:99]
  buffer_load_dwordx4 v167, s[44:47], s78 offen offset:3072 lds
  v_mfma_f32_16x16x32_bf16 v[104:107], v[128:131], a[68:71], v[104:107]
  ds_read_b64_tr_b16 v[142:143], v173 offset:45568
  ds_read_b64_tr_b16 a[58:59], v162 offset:6144
  v_mul_f32 v209, v73, v73
  v_mfma_f32_16x16x32_bf16 v[104:107], v[132:135], a[84:87], v[104:107]
  ds_read_b64_tr_b16 a[60:61], v163 offset:4096
  v_mul_f32 v210, v74, v74
  v_mfma_f32_16x16x32_bf16 v[112:115], v[128:131], a[72:75], v[112:115]
  s_waitcnt vmcnt(12)
  s_barrier
  ds_read_b64_tr_b16 v[216:217], v172 offset:49152
  v_mfma_f32_16x16x32_bf16 v[112:115], v[132:135], a[88:91], v[112:115]
  s_add_u32 m0, s76, 16384
  s_nop 0
  buffer_load_dwordx4 v168, s[32:35], s79 offen offset:0 lds
  v_mfma_f32_16x16x32_bf16 v[120:123], v[128:131], a[76:79], v[120:123]
  ds_read_b64_tr_b16 v[218:219], v172 offset:49664
  s_add_u32 s78, s90, 32768
  v_mfma_f32_16x16x32_bf16 v[120:123], v[132:135], a[92:95], v[120:123]
  s_waitcnt lgkmcnt(4)
  ds_read_b64_tr_b16 a[62:63], v163 offset:6144
  v_mul_f32 v211, v75, v75
  v_mfma_f32_16x16x32_bf16 v[100:103], v[136:139], a[64:67], v[100:103]
  ds_read_b64_tr_b16 v[220:221], v172 offset:53248
  v_rcp_f32 v215, v215
  v_mfma_f32_16x16x32_bf16 v[100:103], v[140:143], a[80:83], v[100:103]
  buffer_load_dwordx4 v169, s[32:35], s79 offen offset:1024 lds
  v_mfma_f32_16x16x32_bf16 v[108:111], v[136:139], a[68:71], v[108:111]
  ds_read_b64_tr_b16 v[222:223], v172 offset:53760
  v_mul_f32 v87, v87, v215
  v_cvt_pk_bf16_f32 v147, v86, v87
  v_mfma_f32_16x16x32_bf16 v[108:111], v[140:143], a[84:87], v[108:111]
  v_mul_f32 v212, v76, v76
  v_mul_f32 v213, v77, v77
  v_mfma_f32_16x16x32_bf16 v[116:119], v[136:139], a[72:75], v[116:119]
  ds_read_b64_tr_b16 v[128:129], v173 offset:49152
  v_mul_f32 v214, v78, v78
  v_mul_f32 v215, v79, v79
  v_mfma_f32_16x16x32_bf16 v[116:119], v[140:143], a[88:91], v[116:119]
  buffer_load_dwordx4 v170, s[32:35], s79 offen offset:2048 lds
  v_mfma_f32_16x16x32_bf16 v[124:127], v[136:139], a[76:79], v[124:127]
  ds_read_b64_tr_b16 v[130:131], v173 offset:49664
  v_fmamk_f32 v208, v208, 0xbdd2d3e8, v206
  v_fmamk_f32 v209, v209, 0xbdd2d3e8, v206
  v_mfma_f32_16x16x32_bf16 v[124:127], v[140:143], a[92:95], v[124:127]
  s_waitcnt lgkmcnt(2)
  v_fmamk_f32 v210, v210, 0xbdd2d3e8, v206
  v_fmamk_f32 v211, v211, 0xbdd2d3e8, v206
  v_mfma_f32_16x16x32_bf16 v[32:35], v[216:219], a[96:99], v[32:35]
  ds_read_b64_tr_b16 v[132:133], v173 offset:53248
  v_fmamk_f32 v212, v212, 0xbdd2d3e8, v206
  v_fmamk_f32 v213, v213, 0xbdd2d3e8, v206
  v_mfma_f32_16x16x32_bf16 v[32:35], v[220:223], a[112:115], v[32:35]
  buffer_load_dwordx4 v171, s[32:35], s79 offen offset:3072 lds
  v_mfma_f32_16x16x32_bf16 v[40:43], v[216:219], a[100:103], v[40:43]
  s_mul_i32 s79, s70, 229376
  ds_read_b64_tr_b16 v[134:135], v173 offset:53760
  v_fmamk_f32 v214, v214, 0xbdd2d3e8, v206
  v_fmamk_f32 v215, v215, 0xbdd2d3e8, v206
  v_mfma_f32_16x16x32_bf16 v[40:43], v[220:223], a[116:119], v[40:43]
  s_add_u32 m0, s77, 135168
  v_mul_f32 v208, v208, v72
  v_mul_f32 v209, v209, v73
  v_mfma_f32_16x16x32_bf16 v[48:51], v[216:219], a[104:107], v[48:51]
  ds_read_b64_tr_b16 v[136:137], v172 offset:57344
  v_exp_f32 v208, v208
  v_mfma_f32_16x16x32_bf16 v[48:51], v[220:223], a[120:123], v[48:51]
  buffer_load_dwordx4 v164, s[44:47], s78 offen offset:0 lds
  v_mfma_f32_16x16x32_bf16 v[56:59], v[216:219], a[108:111], v[56:59]
  ds_read_b64_tr_b16 v[138:139], v172 offset:57856
  v_exp_f32 v209, v209
  v_mfma_f32_16x16x32_bf16 v[56:59], v[220:223], a[124:127], v[56:59]
  s_waitcnt lgkmcnt(2)
  v_mul_f32 v210, v210, v74
  v_mul_f32 v211, v211, v75
  v_mfma_f32_16x16x32_bf16 v[36:39], v[128:131], a[96:99], v[36:39]
  ds_read_b64_tr_b16 v[140:141], v172 offset:61440
  v_exp_f32 v210, v210
  v_mfma_f32_16x16x32_bf16 v[36:39], v[132:135], a[112:115], v[36:39]
  buffer_load_dwordx4 v165, s[44:47], s78 offen offset:1024 lds
  v_mfma_f32_16x16x32_bf16 v[44:47], v[128:131], a[100:103], v[44:47]
  ds_read_b64_tr_b16 v[142:143], v172 offset:61952
  v_exp_f32 v211, v211
  v_mfma_f32_16x16x32_bf16 v[44:47], v[132:135], a[116:119], v[44:47]
  v_mul_f32 v212, v212, v76
  v_mul_f32 v213, v213, v77
  v_mfma_f32_16x16x32_bf16 v[52:55], v[128:131], a[104:107], v[52:55]
  ds_read_b64_tr_b16 v[216:217], v173 offset:57344
  v_exp_f32 v212, v212
  v_mfma_f32_16x16x32_bf16 v[52:55], v[132:135], a[120:123], v[52:55]
  buffer_load_dwordx4 v166, s[44:47], s78 offen offset:2048 lds
  v_mfma_f32_16x16x32_bf16 v[60:63], v[128:131], a[108:111], v[60:63]
  ds_read_b64_tr_b16 v[218:219], v173 offset:57856
  v_exp_f32 v213, v213
  v_mfma_f32_16x16x32_bf16 v[60:63], v[132:135], a[124:127], v[60:63]
  s_waitcnt lgkmcnt(2)
  v_mul_f32 v214, v214, v78
  v_mul_f32 v215, v215, v79
  v_mfma_f32_16x16x32_bf16 v[96:99], v[136:139], a[96:99], v[96:99]
  ds_read_b64_tr_b16 v[220:221], v173 offset:61440
  v_exp_f32 v214, v214
  v_mfma_f32_16x16x32_bf16 v[96:99], v[140:143], a[112:115], v[96:99]
  buffer_load_dwordx4 v167, s[44:47], s78 offen offset:3072 lds
  v_mfma_f32_16x16x32_bf16 v[104:107], v[136:139], a[100:103], v[104:107]
  ds_read_b64_tr_b16 v[222:223], v173 offset:61952
  v_exp_f32 v215, v215
  v_mfma_f32_16x16x32_bf16 v[104:107], v[140:143], a[116:119], v[104:107]
  v_mul_f32 v88, v72, v88
  v_mul_f32 v89, v73, v89
  v_mfma_f32_16x16x32_bf16 v[112:115], v[136:139], a[104:107], v[112:115]
  s_waitcnt vmcnt(12)
  s_barrier
  ds_read_b64_tr_b16 v[128:129], v172 offset:0
  v_mfma_f32_16x16x32_bf16 v[112:115], v[140:143], a[120:123], v[112:115]
  s_add_u32 m0, s76, 32768
  s_nop 0
  buffer_load_dwordx4 v168, s[32:35], s79 offen offset:0 lds
  v_mfma_f32_16x16x32_bf16 v[120:123], v[136:139], a[108:111], v[120:123]
  ds_read_b64_tr_b16 v[130:131], v172 offset:512
  s_add_u32 s78, s91, 0
  v_mfma_f32_16x16x32_bf16 v[120:123], v[140:143], a[124:127], v[120:123]
  s_waitcnt lgkmcnt(2)
  v_mul_f32 v90, v74, v90
  v_mul_f32 v91, v75, v91
  v_mfma_f32_16x16x32_bf16 v[100:103], v[216:219], a[96:99], v[100:103]
  ds_read_b64_tr_b16 v[132:133], v172 offset:4096
  v_mul_f32 v92, v76, v92
  v_mul_f32 v93, v77, v93
  v_mfma_f32_16x16x32_bf16 v[100:103], v[220:223], a[112:115], v[100:103]
  buffer_load_dwordx4 v169, s[32:35], s79 offen offset:1024 lds
  v_mfma_f32_16x16x32_bf16 v[108:111], v[216:219], a[100:103], v[108:111]
  ds_read_b64_tr_b16 v[134:135], v172 offset:4608
  v_mul_f32 v94, v78, v94
  v_mul_f32 v95, v79, v95
  v_mfma_f32_16x16x32_bf16 v[108:111], v[220:223], a[116:119], v[108:111]
  v_fma_f32 v208, v208, v185, v185
  v_fma_f32 v209, v209, v185, v185
  v_mfma_f32_16x16x32_bf16 v[116:119], v[216:219], a[104:107], v[116:119]
  ds_read_b64_tr_b16 v[136:137], v173 offset:0
  v_rcp_f32 v208, v208
  v_mfma_f32_16x16x32_bf16 v[116:119], v[220:223], a[120:123], v[116:119]
  buffer_load_dwordx4 v170, s[32:35], s79 offen offset:2048 lds
  v_mfma_f32_16x16x32_bf16 v[124:127], v[216:219], a[108:111], v[124:127]
  ds_read_b64_tr_b16 v[138:139], v173 offset:512
  v_rcp_f32 v209, v209
  v_mfma_f32_16x16x32_bf16 v[124:127], v[220:223], a[124:127], v[124:127]
  s_waitcnt lgkmcnt(2)
  v_fma_f32 v210, v210, v185, v185
  v_fma_f32 v211, v211, v185, v185
  v_mfma_f32_16x16x32_bf16 v[32:35], v[128:131], a[128:131], v[32:35]
  ds_read_b64_tr_b16 v[140:141], v173 offset:4096
  v_rcp_f32 v210, v210
  v_mfma_f32_16x16x32_bf16 v[32:35], v[132:135], a[144:147], v[32:35]
  buffer_load_dwordx4 v171, s[32:35], s79 offen offset:3072 lds
  v_mfma_f32_16x16x32_bf16 v[40:43], v[128:131], a[132:135], v[40:43]
  s_mul_i32 s79, s71, 229376
  ds_read_b64_tr_b16 v[142:143], v173 offset:4608
  v_rcp_f32 v211, v211
  v_mfma_f32_16x16x32_bf16 v[40:43], v[132:135], a[148:151], v[40:43]
  s_add_u32 m0, s77, 65536
  v_fma_f32 v212, v212, v185, v185
  v_fma_f32 v213, v213, v185, v185
  v_mfma_f32_16x16x32_bf16 v[48:51], v[128:131], a[136:139], v[48:51]
  ds_read_b64_tr_b16 v[216:217], v172 offset:8192
  v_rcp_f32 v212, v212
  v_mfma_f32_16x16x32_bf16 v[48:51], v[132:135], a[152:155], v[48:51]
  buffer_load_dwordx4 v164, s[44:47], s78 offen offset:0 lds
  v_mfma_f32_16x16x32_bf16 v[56:59], v[128:131], a[140:143], v[56:59]
  ds_read_b64_tr_b16 v[218:219], v172 offset:8704
  v_rcp_f32 v213, v213
  v_mfma_f32_16x16x32_bf16 v[56:59], v[132:135], a[156:159], v[56:59]
  s_waitcnt lgkmcnt(2)
  v_fma_f32 v214, v214, v185, v185
  v_fma_f32 v215, v215, v185, v185
  v_mfma_f32_16x16x32_bf16 v[36:39], v[136:139], a[128:131], v[36:39]
  ds_read_b64_tr_b16 v[220:221], v172 offset:12288
  v_rcp_f32 v214, v214
  v_mfma_f32_16x16x32_bf16 v[36:39], v[140:143], a[144:147], v[36:39]
  buffer_load_dwordx4 v165, s[44:47], s78 offen offset:1024 lds
  v_mfma_f32_16x16x32_bf16 v[44:47], v[136:139], a[132:135], v[44:47]
  ds_read_b64_tr_b16 v[222:223], v172 offset:12800
  v_rcp_f32 v215, v215
  v_mfma_f32_16x16x32_bf16 v[44:47], v[140:143], a[148:151], v[44:47]
  v_mul_f32 v88, v88, v208
  v_mul_f32 v89, v89, v209
  v_mfma_f32_16x16x32_bf16 v[52:55], v[136:139], a[136:139], v[52:55]
  ds_read_b64_tr_b16 v[128:129], v173 offset:8192
  v_mul_f32 v90, v90, v210
  v_mul_f32 v91, v91, v211
  v_mfma_f32_16x16x32_bf16 v[52:55], v[140:143], a[152:155], v[52:55]
  buffer_load_dwordx4 v166, s[44:47], s78 offen offset:2048 lds
  v_mfma_f32_16x16x32_bf16 v[60:63], v[136:139], a[140:143], v[60:63]
  ds_read_b64_tr_b16 v[130:131], v173 offset:8704
  v_mul_f32 v92, v92, v212
  v_mul_f32 v93, v93, v213
  v_mfma_f32_16x16x32_bf16 v[60:63], v[140:143], a[156:159], v[60:63]
  s_waitcnt lgkmcnt(2)
  v_mul_f32 v94, v94, v214
  v_mul_f32 v95, v95, v215
  v_mfma_f32_16x16x32_bf16 v[96:99], v[216:219], a[128:131], v[96:99]
  ds_read_b64_tr_b16 v[132:133], v173 offset:12288
  v_cvt_pk_bf16_f32 v148, v88, v89
  v_cvt_pk_bf16_f32 v149, v90, v91
  v_mfma_f32_16x16x32_bf16 v[96:99], v[220:223], a[144:147], v[96:99]
  buffer_load_dwordx4 v167, s[44:47], s78 offen offset:3072 lds
  v_mfma_f32_16x16x32_bf16 v[104:107], v[216:219], a[132:135], v[104:107]
  ds_read_b64_tr_b16 v[134:135], v173 offset:12800
  v_cvt_pk_bf16_f32 v150, v92, v93
  v_cvt_pk_bf16_f32 v151, v94, v95
  v_mfma_f32_16x16x32_bf16 v[104:107], v[220:223], a[148:151], v[104:107]
  buffer_store_dwordx4 v[144:147], v188, s[36:39], s89 offen offset:0 sc1
  v_mfma_f32_16x16x32_bf16 v[112:115], v[216:219], a[136:139], v[112:115]
  s_waitcnt vmcnt(13)
  s_barrier
  ds_read_b64_tr_b16 v[136:137], v172 offset:16384
  buffer_store_dwordx4 v[148:151], v188, s[36:39], s89 offen offset:1024 sc1
  v_mfma_f32_16x16x32_bf16 v[112:115], v[220:223], a[152:155], v[112:115]
  s_add_u32 m0, s76, 49152
  buffer_load_dword v178, v180, s[36:39], s96 offen offset:1024 sc1
  v_mfma_f32_16x16x32_bf16 v[120:123], v[216:219], a[140:143], v[120:123]
  ds_read_b64_tr_b16 v[138:139], v172 offset:16896
  s_add_u32 s78, s91, 32768
  v_mfma_f32_16x16x32_bf16 v[120:123], v[220:223], a[156:159], v[120:123]
  s_waitcnt lgkmcnt(2)
  buffer_load_dwordx4 v168, s[32:35], s79 offen offset:0 lds
  v_mfma_f32_16x16x32_bf16 v[100:103], v[128:131], a[128:131], v[100:103]
  ds_read_b64_tr_b16 v[140:141], v172 offset:20480
  v_mfma_f32_16x16x32_bf16 v[100:103], v[132:135], a[144:147], v[100:103]
  v_mfma_f32_16x16x32_bf16 v[108:111], v[128:131], a[132:135], v[108:111]
  ds_read_b64_tr_b16 v[142:143], v172 offset:20992
  v_mfma_f32_16x16x32_bf16 v[108:111], v[132:135], a[148:151], v[108:111]
  buffer_load_dwordx4 v169, s[32:35], s79 offen offset:1024 lds
  v_mfma_f32_16x16x32_bf16 v[116:119], v[128:131], a[136:139], v[116:119]
  ds_read_b64_tr_b16 v[216:217], v173 offset:16384
  v_mfma_f32_16x16x32_bf16 v[116:119], v[132:135], a[152:155], v[116:119]
  v_mfma_f32_16x16x32_bf16 v[124:127], v[128:131], a[140:143], v[124:127]
  ds_read_b64_tr_b16 v[218:219], v173 offset:16896
  v_mfma_f32_16x16x32_bf16 v[124:127], v[132:135], a[156:159], v[124:127]
  s_waitcnt lgkmcnt(2)
  buffer_load_dwordx4 v170, s[32:35], s79 offen offset:2048 lds
  v_mfma_f32_16x16x32_bf16 v[32:35], v[136:139], a[160:163], v[32:35]
  ds_read_b64_tr_b16 v[220:221], v173 offset:20480
  v_mfma_f32_16x16x32_bf16 v[32:35], v[140:143], a[176:179], v[32:35]
  v_mfma_f32_16x16x32_bf16 v[40:43], v[136:139], a[164:167], v[40:43]
  ds_read_b64_tr_b16 v[222:223], v173 offset:20992
  v_mfma_f32_16x16x32_bf16 v[40:43], v[140:143], a[180:183], v[40:43]
  buffer_load_dwordx4 v171, s[32:35], s79 offen offset:3072 lds
  v_mfma_f32_16x16x32_bf16 v[48:51], v[136:139], a[168:171], v[48:51]
  s_add_u32 m0, s77, 69632
  ds_read_b64_tr_b16 v[128:129], v172 offset:24576
  v_mfma_f32_16x16x32_bf16 v[48:51], v[140:143], a[184:187], v[48:51]
  v_mfma_f32_16x16x32_bf16 v[56:59], v[136:139], a[172:175], v[56:59]
  ds_read_b64_tr_b16 v[130:131], v172 offset:25088
  v_mfma_f32_16x16x32_bf16 v[56:59], v[140:143], a[188:191], v[56:59]
  s_waitcnt lgkmcnt(2)
  buffer_load_dwordx4 v164, s[44:47], s78 offen offset:0 lds
  v_mfma_f32_16x16x32_bf16 v[36:39], v[216:219], a[160:163], v[36:39]
  ds_read_b64_tr_b16 v[132:133], v172 offset:28672
  v_mfma_f32_16x16x32_bf16 v[36:39], v[220:223], a[176:179], v[36:39]
  v_mfma_f32_16x16x32_bf16 v[44:47], v[216:219], a[164:167], v[44:47]
  ds_read_b64_tr_b16 v[134:135], v172 offset:29184
  v_mfma_f32_16x16x32_bf16 v[44:47], v[220:223], a[180:183], v[44:47]
  buffer_load_dwordx4 v165, s[44:47], s78 offen offset:1024 lds
  v_mfma_f32_16x16x32_bf16 v[52:55], v[216:219], a[168:171], v[52:55]
  ds_read_b64_tr_b16 v[136:137], v173 offset:24576
  v_mfma_f32_16x16x32_bf16 v[52:55], v[220:223], a[184:187], v[52:55]
  v_mfma_f32_16x16x32_bf16 v[60:63], v[216:219], a[172:175], v[60:63]
  ds_read_b64_tr_b16 v[138:139], v173 offset:25088
  v_mfma_f32_16x16x32_bf16 v[60:63], v[220:223], a[188:191], v[60:63]
  s_waitcnt lgkmcnt(2)
  buffer_load_dwordx4 v166, s[44:47], s78 offen offset:2048 lds
  v_mfma_f32_16x16x32_bf16 v[96:99], v[128:131], a[160:163], v[96:99]
  ds_read_b64_tr_b16 v[140:141], v173 offset:28672
  v_mfma_f32_16x16x32_bf16 v[96:99], v[132:135], a[176:179], v[96:99]
  v_mfma_f32_16x16x32_bf16 v[104:107], v[128:131], a[164:167], v[104:107]
  ds_read_b64_tr_b16 v[142:143], v173 offset:29184
  v_mfma_f32_16x16x32_bf16 v[104:107], v[132:135], a[180:183], v[104:107]
  buffer_load_dwordx4 v167, s[44:47], s78 offen offset:3072 lds
  v_mfma_f32_16x16x32_bf16 v[112:115], v[128:131], a[168:171], v[112:115]
  s_waitcnt vmcnt(15)
  s_barrier
  ds_read_b64_tr_b16 v[216:217], v172 offset:32768
  v_mfma_f32_16x16x32_bf16 v[112:115], v[132:135], a[184:187], v[112:115]
  v_mfma_f32_16x16x32_bf16 v[120:123], v[128:131], a[172:175], v[120:123]
  ds_read_b64_tr_b16 v[218:219], v172 offset:33280
  v_mfma_f32_16x16x32_bf16 v[120:123], v[132:135], a[188:191], v[120:123]
  s_waitcnt lgkmcnt(2)
  v_mfma_f32_16x16x32_bf16 v[100:103], v[136:139], a[160:163], v[100:103]
  ds_read_b64_tr_b16 v[220:221], v172 offset:36864
  s_waitcnt vmcnt(8)
  v_cmp_ne_u32 vcc, v178, v176
  s_cbranch_vccnz L_slow0
L_ret0:
  v_mfma_f32_16x16x32_bf16 v[100:103], v[140:143], a[176:179], v[100:103]
  s_add_u32 s97, s93, 98304
  buffer_load_dwordx4 a[128:131], v190, s[36:39], s97 offen sc1
  v_mfma_f32_16x16x32_bf16 v[108:111], v[136:139], a[164:167], v[108:111]
  s_add_u32 s98, s93, 102400
  ds_read_b64_tr_b16 v[222:223], v172 offset:37376
  v_mfma_f32_16x16x32_bf16 v[108:111], v[140:143], a[180:183], v[108:111]
  v_mfma_f32_16x16x32_bf16 v[116:119], v[136:139], a[168:171], v[116:119]
  ds_read_b64_tr_b16 v[128:129], v173 offset:32768
  v_mfma_f32_16x16x32_bf16 v[116:119], v[140:143], a[184:187], v[116:119]
  buffer_load_dwordx4 a[144:147], v190, s[36:39], s98 offen sc1
  v_mfma_f32_16x16x32_bf16 v[124:127], v[136:139], a[172:175], v[124:127]
  ds_read_b64_tr_b16 v[130:131], v173 offset:33280
  v_mfma_f32_16x16x32_bf16 v[124:127], v[140:143], a[188:191], v[124:127]
  s_waitcnt lgkmcnt(2)
  v_mfma_f32_16x16x32_bf16 v[32:35], v[216:219], a[192:195], v[32:35]
  ds_read_b64_tr_b16 v[132:133], v173 offset:36864
  v_add_u32 v168, 0xfffe0000, v200
  v_mfma_f32_16x16x32_bf16 v[32:35], v[220:223], a[208:211], v[32:35]
  buffer_load_dwordx4 a[132:135], v191, s[36:39], s97 offen sc1
  v_mfma_f32_16x16x32_bf16 v[40:43], v[216:219], a[196:199], v[40:43]
  ds_read_b64_tr_b16 v[134:135], v173 offset:37376
  v_add_u32 v169, 0xfffe0000, v201
  v_mfma_f32_16x16x32_bf16 v[40:43], v[220:223], a[212:215], v[40:43]
  v_add_u32 v170, 0xfffe0000, v202
  v_add_u32 v171, 0xfffe0000, v203
  v_mfma_f32_16x16x32_bf16 v[48:51], v[216:219], a[200:203], v[48:51]
  ds_read_b64_tr_b16 v[136:137], v172 offset:40960
  v_mfma_f32_16x16x32_bf16 v[48:51], v[220:223], a[216:219], v[48:51]
  buffer_load_dwordx4 a[148:151], v191, s[36:39], s98 offen sc1
  v_mfma_f32_16x16x32_bf16 v[56:59], v[216:219], a[204:207], v[56:59]
  ds_read_b64_tr_b16 v[138:139], v172 offset:41472
  v_mfma_f32_16x16x32_bf16 v[56:59], v[220:223], a[220:223], v[56:59]
  s_waitcnt lgkmcnt(2)
  v_mfma_f32_16x16x32_bf16 v[36:39], v[128:131], a[192:195], v[36:39]
  ds_read_b64_tr_b16 v[140:141], v172 offset:45056
  v_mfma_f32_16x16x32_bf16 v[36:39], v[132:135], a[208:211], v[36:39]
  buffer_load_dwordx4 a[136:139], v204, s[36:39], s97 offen sc1
  v_mfma_f32_16x16x32_bf16 v[44:47], v[128:131], a[196:199], v[44:47]
  ds_read_b64_tr_b16 v[142:143], v172 offset:45568
  v_mfma_f32_16x16x32_bf16 v[44:47], v[132:135], a[212:215], v[44:47]
  v_mfma_f32_16x16x32_bf16 v[52:55], v[128:131], a[200:203], v[52:55]
  ds_read_b64_tr_b16 v[216:217], v173 offset:40960
  v_mfma_f32_16x16x32_bf16 v[52:55], v[132:135], a[216:219], v[52:55]
  buffer_load_dwordx4 a[152:155], v204, s[36:39], s98 offen sc1
  v_mfma_f32_16x16x32_bf16 v[60:63], v[128:131], a[204:207], v[60:63]
  ds_read_b64_tr_b16 v[218:219], v173 offset:41472
  v_mfma_f32_16x16x32_bf16 v[60:63], v[132:135], a[220:223], v[60:63]
  s_waitcnt lgkmcnt(2)
  v_mfma_f32_16x16x32_bf16 v[96:99], v[136:139], a[192:195], v[96:99]
  ds_read_b64_tr_b16 v[220:221], v173 offset:45056
  v_mfma_f32_16x16x32_bf16 v[96:99], v[140:143], a[208:211], v[96:99]
  buffer_load_dwordx4 a[140:143], v205, s[36:39], s97 offen sc1
  v_mfma_f32_16x16x32_bf16 v[104:107], v[136:139], a[196:199], v[104:107]
  s_add_u32 s97, s94, 98304
  ds_read_b64_tr_b16 v[222:223], v173 offset:45568
  v_mfma_f32_16x16x32_bf16 v[104:107], v[140:143], a[212:215], v[104:107]
  v_mfma_f32_16x16x32_bf16 v[112:115], v[136:139], a[200:203], v[112:115]
  s_waitcnt vmcnt(11)
  s_barrier
  buffer_store_dword v176, v182, s[36:39], 0 offen offset:8 sc1
  ds_read_b64_tr_b16 v[128:129], v172 offset:49152
  v_mfma_f32_16x16x32_bf16 v[112:115], v[140:143], a[216:219], v[112:115]
  buffer_load_dwordx4 a[156:159], v205, s[36:39], s98 offen sc1
  v_mfma_f32_16x16x32_bf16 v[120:123], v[136:139], a[204:207], v[120:123]
  s_add_u32 s98, s94, 102400
  ds_read_b64_tr_b16 v[130:131], v172 offset:49664
  v_mfma_f32_16x16x32_bf16 v[120:123], v[140:143], a[220:223], v[120:123]
  s_waitcnt lgkmcnt(2)
  v_mfma_f32_16x16x32_bf16 v[100:103], v[216:219], a[192:195], v[100:103]
  ds_read_b64_tr_b16 v[132:133], v172 offset:53248
  v_mfma_f32_16x16x32_bf16 v[100:103], v[220:223], a[208:211], v[100:103]
  buffer_load_dwordx4 a[160:163], v190, s[36:39], s97 offen sc1
  v_mfma_f32_16x16x32_bf16 v[108:111], v[216:219], a[196:199], v[108:111]
  ds_read_b64_tr_b16 v[134:135], v172 offset:53760
  v_mfma_f32_16x16x32_bf16 v[108:111], v[220:223], a[212:215], v[108:111]
  v_mfma_f32_16x16x32_bf16 v[116:119], v[216:219], a[200:203], v[116:119]
L_pgK4:
  s_cbranch_execz L_back
  ds_read_b64_tr_b16 v[136:137], v173 offset:49152
  v_mfma_f32_16x16x32_bf16 v[116:119], v[220:223], a[216:219], v[116:119]
  buffer_load_dwordx4 a[176:179], v190, s[36:39], s98 offen sc1
  v_mfma_f32_16x16x32_bf16 v[124:127], v[216:219], a[204:207], v[124:127]
  ds_read_b64_tr_b16 v[138:139], v173 offset:49664
  v_mfma_f32_16x16x32_bf16 v[124:127], v[220:223], a[220:223], v[124:127]
  s_waitcnt lgkmcnt(2)
  v_mfma_f32_16x16x32_bf16 v[32:35], v[128:131], a[224:227], v[32:35]
  ds_read_b64_tr_b16 v[140:141], v173 offset:53248
  v_mfma_f32_16x16x32_bf16 v[32:35], v[132:135], a[240:243], v[32:35]
  buffer_load_dwordx4 a[164:167], v191, s[36:39], s97 offen sc1
  v_mfma_f32_16x16x32_bf16 v[40:43], v[128:131], a[228:231], v[40:43]
  ds_read_b64_tr_b16 v[142:143], v173 offset:53760
  v_mfma_f32_16x16x32_bf16 v[40:43], v[132:135], a[244:247], v[40:43]
  v_mfma_f32_16x16x32_bf16 v[48:51], v[128:131], a[232:235], v[48:51]
  ds_read_b64_tr_b16 v[216:217], v172 offset:57344
  v_mfma_f32_16x16x32_bf16 v[48:51], v[132:135], a[248:251], v[48:51]
  buffer_load_dwordx4 a[180:183], v191, s[36:39], s98 offen sc1
  v_mfma_f32_16x16x32_bf16 v[56:59], v[128:131], a[236:239], v[56:59]
  ds_read_b64_tr_b16 v[218:219], v172 offset:57856
  v_mfma_f32_16x16x32_bf16 v[56:59], v[132:135], a[252:255], v[56:59]
  s_waitcnt lgkmcnt(2)
  v_mfma_f32_16x16x32_bf16 v[36:39], v[136:139], a[224:227], v[36:39]
  ds_read_b64_tr_b16 v[220:221], v172 offset:61440
  v_mfma_f32_16x16x32_bf16 v[36:39], v[140:143], a[240:243], v[36:39]
  buffer_load_dwordx4 a[168:171], v204, s[36:39], s97 offen sc1
  v_mfma_f32_16x16x32_bf16 v[44:47], v[136:139], a[228:231], v[44:47]
  ds_read_b64_tr_b16 v[222:223], v172 offset:61952
  v_mfma_f32_16x16x32_bf16 v[44:47], v[140:143], a[244:247], v[44:47]
  v_mfma_f32_16x16x32_bf16 v[52:55], v[136:139], a[232:235], v[52:55]
  ds_read_b64_tr_b16 v[128:129], v173 offset:57344
  v_mfma_f32_16x16x32_bf16 v[52:55], v[140:143], a[248:251], v[52:55]
  buffer_load_dwordx4 a[184:187], v204, s[36:39], s98 offen sc1
  v_mfma_f32_16x16x32_bf16 v[60:63], v[136:139], a[236:239], v[60:63]
  ds_read_b64_tr_b16 v[130:131], v173 offset:57856
  v_mfma_f32_16x16x32_bf16 v[60:63], v[140:143], a[252:255], v[60:63]
  s_waitcnt lgkmcnt(2)
  v_mfma_f32_16x16x32_bf16 v[96:99], v[216:219], a[224:227], v[96:99]
  ds_read_b64_tr_b16 v[132:133], v173 offset:61440
  v_mfma_f32_16x16x32_bf16 v[96:99], v[220:223], a[240:243], v[96:99]
  buffer_load_dwordx4 a[172:175], v205, s[36:39], s97 offen sc1
  v_mfma_f32_16x16x32_bf16 v[104:107], v[216:219], a[228:231], v[104:107]
  ds_read_b64_tr_b16 v[134:135], v173 offset:61952
  v_mfma_f32_16x16x32_bf16 v[104:107], v[220:223], a[244:247], v[104:107]
  v_mfma_f32_16x16x32_bf16 v[112:115], v[216:219], a[232:235], v[112:115]
  v_mfma_f32_16x16x32_bf16 v[112:115], v[220:223], a[248:251], v[112:115]
  buffer_load_dwordx4 a[188:191], v205, s[36:39], s98 offen sc1
  v_mfma_f32_16x16x32_bf16 v[120:123], v[216:219], a[236:239], v[120:123]
  v_mfma_f32_16x16x32_bf16 v[120:123], v[220:223], a[252:255], v[120:123]
  s_waitcnt lgkmcnt(0)
  v_mfma_f32_16x16x32_bf16 v[100:103], v[128:131], a[224:227], v[100:103]
  s_barrier
  v_mfma_f32_16x16x32_bf16 v[100:103], v[132:135], a[240:243], v[100:103]
  v_mfma_f32_16x16x32_bf16 v[108:111], v[128:131], a[228:231], v[108:111]
  v_mfma_f32_16x16x32_bf16 v[108:111], v[132:135], a[244:247], v[108:111]
  v_mfma_f32_16x16x32_bf16 v[116:119], v[128:131], a[232:235], v[116:119]
  v_mfma_f32_16x16x32_bf16 v[116:119], v[132:135], a[248:251], v[116:119]
  v_mfma_f32_16x16x32_bf16 v[124:127], v[128:131], a[236:239], v[124:127]
  v_mfma_f32_16x16x32_bf16 v[124:127], v[132:135], a[252:255], v[124:127]
  v_pk_mul_f32 v[208:209], v[32:33], v[32:33]
  v_pk_mul_f32 v[210:211], v[34:35], v[34:35]
  v_pk_mul_f32 v[212:213], v[36:37], v[36:37]
  v_pk_mul_f32 v[214:215], v[38:39], v[38:39]
  s_add_u32 s78, s90, 0
  s_add_u32 m0, s77, 0
  s_nop 0
  buffer_load_dwordx4 v164, s[40:43], s78 offen offset:0 lds
  v_pk_fma_f32 v[208:209], v[208:209], s[24:25], v[206:207] op_sel_hi:[1,0,0]
  v_pk_fma_f32 v[210:211], v[210:211], s[24:25], v[206:207] op_sel_hi:[1,0,0]
  v_pk_fma_f32 v[212:213], v[212:213], s[24:25], v[206:207] op_sel_hi:[1,0,0]
  v_pk_fma_f32 v[214:215], v[214:215], s[24:25], v[206:207] op_sel_hi:[1,0,0]
  v_pk_mul_f32 v[208:209], v[208:209], v[32:33]
  v_pk_mul_f32 v[210:211], v[210:211], v[34:35]
  v_pk_mul_f32 v[212:213], v[212:213], v[36:37]
  v_pk_mul_f32 v[214:215], v[214:215], v[38:39]
  v_exp_f32 v208, v208
  v_exp_f32 v209, v209
  v_exp_f32 v210, v210
  v_exp_f32 v211, v211
  v_exp_f32 v212, v212
  v_exp_f32 v213, v213
  v_exp_f32 v214, v214
  v_exp_f32_e64 v215, v215
  v_pk_mul_f32 v[96:97], v[32:33], v[96:97]
  v_pk_mul_f32 v[98:99], v[34:35], v[98:99]
  v_pk_mul_f32 v[100:101], v[36:37], v[100:101]
  v_pk_mul_f32 v[102:103], v[38:39], v[102:103]
  v_pk_fma_f32 v[208:209], v[208:209], v[184:185], v[184:185] op_sel_hi:[1,0,0]
  v_pk_fma_f32 v[210:211], v[210:211], v[184:185], v[184:185] op_sel_hi:[1,0,0]
  buffer_load_dwordx4 v165, s[40:43], s78 offen offset:1024 lds
  v_pk_fma_f32 v[212:213], v[212:213], v[184:185], v[184:185] op_sel_hi:[1,0,0]
  v_pk_fma_f32 v[214:215], v[214:215], v[184:185], v[184:185] op_sel_hi:[1,0,0]
  v_rcp_f32 v208, v208
  v_rcp_f32 v209, v209
  v_rcp_f32 v210, v210
  v_rcp_f32 v211, v211
  v_rcp_f32 v212, v212
  v_rcp_f32 v213, v213
  v_rcp_f32 v214, v214
  v_rcp_f32 v215, v215
  v_pk_mul_f32 v[96:97], v[96:97], v[208:209]
  v_pk_mul_f32 v[98:99], v[98:99], v[210:211]
  v_pk_mul_f32 v[100:101], v[100:101], v[212:213]
  v_pk_mul_f32 v[102:103], v[102:103], v[214:215]
  v_cvt_pk_bf16_f32 v144, v96, v97
  v_cvt_pk_bf16_f32 v145, v98, v99
  v_cvt_pk_bf16_f32 v146, v100, v101
  v_cvt_pk_bf16_f32 v147, v102, v103
  buffer_store_dwordx4 v[144:147], v188, s[36:39], s88 offen offset:0 sc1
  v_pk_mul_f32 v[208:209], v[40:41], v[40:41]
  v_pk_mul_f32 v[210:211], v[42:43], v[42:43]
  v_pk_mul_f32 v[212:213], v[44:45], v[44:45]
  buffer_load_dwordx4 v166, s[40:43], s78 offen offset:2048 lds
  v_pk_mul_f32 v[214:215], v[46:47], v[46:47]
  v_pk_fma_f32 v[208:209], v[208:209], s[24:25], v[206:207] op_sel_hi:[1,0,0]
  v_pk_fma_f32 v[210:211], v[210:211], s[24:25], v[206:207] op_sel_hi:[1,0,0]
  v_pk_fma_f32 v[212:213], v[212:213], s[24:25], v[206:207] op_sel_hi:[1,0,0]
  v_pk_fma_f32 v[214:215], v[214:215], s[24:25], v[206:207] op_sel_hi:[1,0,0]
  v_pk_mul_f32 v[208:209], v[208:209], v[40:41]
  v_pk_mul_f32 v[210:211], v[210:211], v[42:43]
  v_pk_mul_f32 v[212:213], v[212:213], v[44:45]
  v_pk_mul_f32 v[214:215], v[214:215], v[46:47]
  v_exp_f32 v208, v208
  v_exp_f32 v209, v209
  v_exp_f32 v210, v210
  v_exp_f32 v211, v211
  v_exp_f32 v212, v212
  v_exp_f32 v213, v213
  v_exp_f32 v214, v214
  v_exp_f32 v215, v215
  v_pk_mul_f32 v[104:105], v[40:41], v[104:105]
  v_pk_mul_f32 v[106:107], v[42:43], v[106:107]
  v_pk_mul_f32 v[108:109], v[44:45], v[108:109]
  v_pk_mul_f32 v[110:111], v[46:47], v[110:111]
  v_pk_fma_f32 v[208:209], v[208:209], v[184:185], v[184:185] op_sel:[0,1,1] op_sel_hi:[1,1,1]
  buffer_load_dwordx4 v167, s[40:43], s78 offen offset:3072 lds
  v_pk_fma_f32 v[210:211], v[210:211], v[184:185], v[184:185] op_sel:[0,1,1] op_sel_hi:[1,1,1]
  v_pk_fma_f32 v[212:213], v[212:213], v[184:185], v[184:185] op_sel:[0,1,1] op_sel_hi:[1,1,1]
  v_pk_fma_f32 v[214:215], v[214:215], v[184:185], v[184:185] op_sel:[0,1,1] op_sel_hi:[1,1,1]
  v_rcp_f32 v208, v208
  v_rcp_f32 v209, v209
  v_rcp_f32 v210, v210
  v_rcp_f32 v211, v211
  v_rcp_f32 v212, v212
  v_rcp_f32 v213, v213
  v_rcp_f32 v214, v214
  v_rcp_f32 v215, v215
  v_pk_mul_f32 v[104:105], v[104:105], v[208:209]
  v_pk_mul_f32 v[106:107], v[106:107], v[210:211]
  v_pk_mul_f32 v[108:109], v[108:109], v[212:213]
  v_pk_mul_f32 v[110:111], v[110:111], v[214:215]
  v_cvt_pk_bf16_f32 v148, v104, v105
  v_cvt_pk_bf16_f32 v149, v106, v107
  v_cvt_pk_bf16_f32 v150, v108, v109
  v_cvt_pk_bf16_f32 v151, v110, v111
  buffer_store_dwordx4 v[148:151], v188, s[36:39], s88 offen offset:1024 sc1
  v_pk_mul_f32 v[208:209], v[48:49], v[48:49]
  v_pk_mul_f32 v[210:211], v[50:51], v[50:51]
  s_add_u32 s78, s90, 32768
  s_add_u32 m0, s77, 4096
  s_nop 0
  buffer_load_dwordx4 v164, s[40:43], s78 offen offset:0 lds
  v_pk_mul_f32 v[212:213], v[52:53], v[52:53]
  v_pk_mul_f32 v[214:215], v[54:55], v[54:55]
  v_pk_fma_f32 v[208:209], v[208:209], s[24:25], v[206:207] op_sel_hi:[1,0,0]
  v_pk_fma_f32 v[210:211], v[210:211], s[24:25], v[206:207] op_sel_hi:[1,0,0]
  v_pk_fma_f32 v[212:213], v[212:213], s[24:25], v[206:207] op_sel_hi:[1,0,0]
  v_pk_fma_f32 v[214:215], v[214:215], s[24:25], v[206:207] op_sel_hi:[1,0,0]
  v_pk_mul_f32 v[208:209], v[208:209], v[48:49]
  v_pk_mul_f32 v[210:211], v[210:211], v[50:51]
  v_pk_mul_f32 v[212:213], v[212:213], v[52:53]
  v_pk_mul_f32 v[214:215], v[214:215], v[54:55]
  v_exp_f32 v208, v208
  v_exp_f32 v209, v209
  v_exp_f32 v210, v210
  v_exp_f32 v211, v211
  v_exp_f32 v212, v212
  v_exp_f32 v213, v213
  v_exp_f32 v214, v214
  v_exp_f32_e64 v215, v215
  v_pk_mul_f32 v[112:113], v[48:49], v[112:113]
  v_pk_mul_f32 v[114:115], v[50:51], v[114:115]
  v_pk_mul_f32 v[116:117], v[52:53], v[116:117]
  v_pk_mul_f32 v[118:119], v[54:55], v[118:119]
  buffer_load_dwordx4 v165, s[40:43], s78 offen offset:1024 lds
  v_pk_fma_f32 v[208:209], v[208:209], v[186:187], v[186:187] op_sel_hi:[1,0,0]
  v_pk_fma_f32 v[210:211], v[210:211], v[186:187], v[186:187] op_sel_hi:[1,0,0]
  v_pk_fma_f32 v[212:213], v[212:213], v[186:187], v[186:187] op_sel_hi:[1,0,0]
  v_pk_fma_f32 v[214:215], v[214:215], v[186:187], v[186:187] op_sel_hi:[1,0,0]
  v_rcp_f32 v208, v208
  v_rcp_f32 v209, v209
  v_rcp_f32 v210, v210
  v_rcp_f32 v211, v211
  v_rcp_f32 v212, v212
  v_rcp_f32 v213, v213
  v_rcp_f32 v214, v214
  v_rcp_f32 v215, v215
  v_pk_mul_f32 v[112:113], v[112:113], v[208:209]
  v_pk_mul_f32 v[114:115], v[114:115], v[210:211]
  v_pk_mul_f32 v[116:117], v[116:117], v[212:213]
  v_pk_mul_f32 v[118:119], v[118:119], v[214:215]
  v_cvt_pk_bf16_f32 v152, v112, v113
  v_cvt_pk_bf16_f32 v153, v114, v115
  v_cvt_pk_bf16_f32 v154, v116, v117
  v_cvt_pk_bf16_f32 v155, v118, v119
  buffer_store_dwordx4 v[152:155], v189, s[36:39], s88 offen offset:0 sc1
  v_pk_mul_f32 v[208:209], v[56:57], v[56:57]
  buffer_load_dwordx4 v166, s[40:43], s78 offen offset:2048 lds
  v_pk_mul_f32 v[210:211], v[58:59], v[58:59]
  v_pk_mul_f32 v[212:213], v[60:61], v[60:61]
  v_pk_mul_f32 v[214:215], v[62:63], v[62:63]
  v_pk_fma_f32 v[208:209], v[208:209], s[24:25], v[206:207] op_sel_hi:[1,0,0]
  v_pk_fma_f32 v[210:211], v[210:211], s[24:25], v[206:207] op_sel_hi:[1,0,0]
  v_pk_fma_f32 v[212:213], v[212:213], s[24:25], v[206:207] op_sel_hi:[1,0,0]
  v_pk_fma_f32 v[214:215], v[214:215], s[24:25], v[206:207] op_sel_hi:[1,0,0]
  v_pk_mul_f32 v[208:209], v[208:209], v[56:57]
  v_pk_mul_f32 v[210:211], v[210:211], v[58:59]
  v_pk_mul_f32 v[212:213], v[212:213], v[60:61]
  v_pk_mul_f32 v[214:215], v[214:215], v[62:63]
  v_exp_f32 v208, v208
  v_exp_f32 v209, v209
  v_exp_f32 v210, v210
  v_exp_f32 v211, v211
  v_exp_f32 v212, v212
  v_exp_f32 v213, v213
  v_exp_f32 v214, v214
  v_exp_f32 v215, v215
  v_pk_mul_f32 v[120:121], v[56:57], v[120:121]
  v_pk_mul_f32 v[122:123], v[58:59], v[122:123]
  v_pk_mul_f32 v[124:125], v[60:61], v[124:125]
  buffer_load_dwordx4 v167, s[40:43], s78 offen offset:3072 lds
  v_pk_mul_f32 v[126:127], v[62:63], v[126:127]
  v_pk_fma_f32 v[208:209], v[208:209], v[186:187], v[186:187] op_sel:[0,1,1] op_sel_hi:[1,1,1]
  v_pk_fma_f32 v[210:211], v[210:211], v[186:187], v[186:187] op_sel:[0,1,1] op_sel_hi:[1,1,1]
  v_pk_fma_f32 v[212:213], v[212:213], v[186:187], v[186:187] op_sel:[0,1,1] op_sel_hi:[1,1,1]
  v_pk_fma_f32 v[214:215], v[214:215], v[186:187], v[186:187] op_sel:[0,1,1] op_sel_hi:[1,1,1]
  v_rcp_f32 v208, v208
  v_rcp_f32 v209, v209
  v_rcp_f32 v210, v210
  v_rcp_f32 v211, v211
  v_rcp_f32 v212, v212
  v_rcp_f32 v213, v213
  v_rcp_f32 v214, v214
  v_rcp_f32 v215, v215
  v_pk_mul_f32 v[120:121], v[120:121], v[208:209]
  v_pk_mul_f32 v[122:123], v[122:123], v[210:211]
  v_pk_mul_f32 v[124:125], v[124:125], v[212:213]
  v_pk_mul_f32 v[126:127], v[126:127], v[214:215]
  v_cvt_pk_bf16_f32 v156, v120, v121
  v_cvt_pk_bf16_f32 v157, v122, v123
  v_cvt_pk_bf16_f32 v158, v124, v125
  v_cvt_pk_bf16_f32 v159, v126, v127
  buffer_store_dwordx4 v[156:159], v189, s[36:39], s88 offen offset:1024 sc1
  s_waitcnt vmcnt(27)
  v_mfma_f32_16x16x32_bf16 v[0:3], a[0:3], a[128:131], 0
  s_add_u32 s78, s91, 0
  v_mfma_f32_16x16x32_bf16 v[0:3], a[16:19], a[144:147], v[0:3]
  s_add_u32 m0, s77, 32768
  s_nop 0
  buffer_load_dwordx4 v164, s[40:43], s78 offen offset:0 lds
  v_mfma_f32_16x16x32_bf16 v[4:7], a[4:7], a[128:131], 0
  ds_read_b64_tr_b16 a[224:225], v160 offset:32768
  v_mfma_f32_16x16x32_bf16 v[4:7], a[20:23], a[144:147], v[4:7]
  ds_read_b64_tr_b16 a[226:227], v160 offset:34816
  v_mfma_f32_16x16x32_bf16 v[8:11], a[8:11], a[128:131], 0
  ds_read_b64_tr_b16 a[228:229], v161 offset:32768
  v_mfma_f32_16x16x32_bf16 v[8:11], a[24:27], a[144:147], v[8:11]
  buffer_load_dwordx4 v165, s[40:43], s78 offen offset:1024 lds
  v_mfma_f32_16x16x32_bf16 v[12:15], a[12:15], a[128:131], 0
  ds_read_b64_tr_b16 a[230:231], v161 offset:34816
  v_mfma_f32_16x16x32_bf16 v[12:15], a[28:31], a[144:147], v[12:15]
  s_waitcnt vmcnt(27)
  ds_read_b64_tr_b16 a[232:233], v162 offset:32768
  v_mfma_f32_16x16x32_bf16 a[64:67], a[0:3], a[132:135], 0
  ds_read_b64_tr_b16 a[234:235], v162 offset:34816
  v_mfma_f32_16x16x32_bf16 a[64:67], a[16:19], a[148:151], a[64:67]
  buffer_load_dwordx4 v166, s[40:43], s78 offen offset:2048 lds
  v_mfma_f32_16x16x32_bf16 a[68:71], a[4:7], a[132:135], 0
  ds_read_b64_tr_b16 a[236:237], v163 offset:32768
  v_mfma_f32_16x16x32_bf16 a[68:71], a[20:23], a[148:151], a[68:71]
  ds_read_b64_tr_b16 a[238:239], v163 offset:34816
  v_mfma_f32_16x16x32_bf16 a[72:75], a[8:11], a[132:135], 0
  ds_read_b64_tr_b16 a[240:241], v160 offset:36864
  v_mfma_f32_16x16x32_bf16 a[72:75], a[24:27], a[148:151], a[72:75]
  buffer_load_dwordx4 v167, s[40:43], s78 offen offset:3072 lds
  v_mfma_f32_16x16x32_bf16 a[76:79], a[12:15], a[132:135], 0
  s_add_u32 s78, s91, 32768
  ds_read_b64_tr_b16 a[242:243], v160 offset:38912
  s_add_u32 m0, s77, 36864
  v_mfma_f32_16x16x32_bf16 a[76:79], a[28:31], a[148:151], a[76:79]
  s_waitcnt vmcnt(27)
  ds_read_b64_tr_b16 a[244:245], v161 offset:36864
  v_mfma_f32_16x16x32_bf16 a[80:83], a[0:3], a[136:139], 0
  ds_read_b64_tr_b16 a[246:247], v161 offset:38912
  v_mfma_f32_16x16x32_bf16 a[80:83], a[16:19], a[152:155], a[80:83]
  buffer_load_dwordx4 v164, s[40:43], s78 offen offset:0 lds
  v_mfma_f32_16x16x32_bf16 a[84:87], a[4:7], a[136:139], 0
  ds_read_b64_tr_b16 a[248:249], v162 offset:36864
  v_mfma_f32_16x16x32_bf16 a[84:87], a[20:23], a[152:155], a[84:87]
  ds_read_b64_tr_b16 a[250:251], v162 offset:38912
  v_mfma_f32_16x16x32_bf16 a[88:91], a[8:11], a[136:139], 0
  ds_read_b64_tr_b16 a[252:253], v163 offset:36864
  v_mfma_f32_16x16x32_bf16 a[88:91], a[24:27], a[152:155], a[88:91]
  buffer_load_dwordx4 v165, s[40:43], s78 offen offset:1024 lds
  v_mfma_f32_16x16x32_bf16 a[92:95], a[12:15], a[136:139], 0
  ds_read_b64_tr_b16 a[254:255], v163 offset:38912
  v_mfma_f32_16x16x32_bf16 a[92:95], a[28:31], a[152:155], a[92:95]
  s_waitcnt vmcnt(26)
  v_mfma_f32_16x16x32_bf16 a[96:99], a[0:3], a[140:143], 0
  v_mfma_f32_16x16x32_bf16 a[96:99], a[16:19], a[156:159], a[96:99]
  buffer_load_dwordx4 v166, s[40:43], s78 offen offset:2048 lds
  v_mfma_f32_16x16x32_bf16 a[100:103], a[4:7], a[140:143], 0
  v_mfma_f32_16x16x32_bf16 a[100:103], a[20:23], a[156:159], a[100:103]
  v_mfma_f32_16x16x32_bf16 a[104:107], a[8:11], a[140:143], 0
  v_mfma_f32_16x16x32_bf16 a[104:107], a[24:27], a[156:159], a[104:107]
  buffer_load_dwordx4 v167, s[40:43], s78 offen offset:3072 lds
  v_mfma_f32_16x16x32_bf16 a[108:111], a[12:15], a[140:143], 0
  v_mfma_f32_16x16x32_bf16 a[108:111], a[28:31], a[156:159], a[108:111]
  s_waitcnt vmcnt(26)
  v_mfma_f32_16x16x32_bf16 v[0:3], a[32:35], a[160:163], v[0:3]
  s_waitcnt vmcnt(9)
  ds_read_b64_tr_b16 a[0:1], v168 offset:0
  v_mfma_f32_16x16x32_bf16 v[0:3], a[48:51], a[176:179], v[0:3]
  ds_read_b64_tr_b16 a[2:3], v168 offset:2048
  v_mfma_f32_16x16x32_bf16 v[4:7], a[36:39], a[160:163], v[4:7]
  ds_read_b64_tr_b16 a[4:5], v169 offset:0
  v_mfma_f32_16x16x32_bf16 v[4:7], a[52:55], a[176:179], v[4:7]
  ds_read_b64_tr_b16 a[6:7], v169 offset:2048
  v_mfma_f32_16x16x32_bf16 v[8:11], a[40:43], a[160:163], v[8:11]
  ds_read_b64_tr_b16 a[8:9], v170 offset:0
  v_mfma_f32_16x16x32_bf16 v[8:11], a[56:59], a[176:179], v[8:11]
  ds_read_b64_tr_b16 a[10:11], v170 offset:2048
  v_mfma_f32_16x16x32_bf16 v[12:15], a[44:47], a[160:163], v[12:15]
  ds_read_b64_tr_b16 a[12:13], v171 offset:0
  v_mfma_f32_16x16x32_bf16 v[12:15], a[60:63], a[176:179], v[12:15]
  ds_read_b64_tr_b16 a[14:15], v171 offset:2048
  v_mfma_f32_16x16x32_bf16 a[64:67], a[32:35], a[164:167], a[64:67]
  ds_read_b64_tr_b16 a[16:17], v168 offset:4096
  v_mfma_f32_16x16x32_bf16 a[64:67], a[48:51], a[180:183], a[64:67]
  ds_read_b64_tr_b16 a[18:19], v168 offset:6144
  v_mfma_f32_16x16x32_bf16 a[68:71], a[36:39], a[164:167], a[68:71]
  ds_read_b64_tr_b16 a[20:21], v169 offset:4096
  v_mfma_f32_16x16x32_bf16 a[68:71], a[52:55], a[180:183], a[68:71]
  ds_read_b64_tr_b16 a[22:23], v169 offset:6144
  v_mfma_f32_16x16x32_bf16 a[72:75], a[40:43], a[164:167], a[72:75]
  ds_read_b64_tr_b16 a[24:25], v170 offset:4096
  v_mfma_f32_16x16x32_bf16 a[72:75], a[56:59], a[180:183], a[72:75]
  ds_read_b64_tr_b16 a[26:27], v170 offset:6144
  v_mfma_f32_16x16x32_bf16 a[76:79], a[44:47], a[164:167], a[76:79]
  ds_read_b64_tr_b16 a[28:29], v171 offset:4096
  v_mfma_f32_16x16x32_bf16 a[76:79], a[60:63], a[180:183], a[76:79]
  ds_read_b64_tr_b16 a[30:31], v171 offset:6144
  v_mfma_f32_16x16x32_bf16 a[80:83], a[32:35], a[168:171], a[80:83]
  buffer_load_dword v179, v181, s[36:39], s96 offen offset:8 sc1
  v_mfma_f32_16x16x32_bf16 a[80:83], a[48:51], a[184:187], a[80:83]
  v_add_u32 v208, s77, v183
  v_xor_b32 v209, 8192, v208
  v_mfma_f32_16x16x32_bf16 a[84:87], a[36:39], a[168:171], a[84:87]
  v_xor_b32 v210, 16384, v208
  v_xor_b32 v211, 24576, v208
  v_mfma_f32_16x16x32_bf16 a[84:87], a[52:55], a[184:187], a[84:87]
  v_and_b32 v212, 15, v175
  v_lshl_add_u32 v212, s58, 4, v212
  v_mfma_f32_16x16x32_bf16 a[88:91], a[40:43], a[168:171], a[88:91]
  v_lshlrev_b32 v212, 10, v212
  v_lshrrev_b32_e64 v213, 5, v175
  v_mfma_f32_16x16x32_bf16 a[88:91], a[56:59], a[184:187], a[88:91]
  v_lshl_add_u32 v212, v213, 4, v212
  v_bfe_u32 v213, v175, 4, 1
  v_mfma_f32_16x16x32_bf16 a[92:95], a[44:47], a[168:171], a[92:95]
  v_lshl_add_u32 v212, v213, 5, v212
  v_mfma_f32_16x16x32_bf16 a[92:95], a[60:63], a[184:187], a[92:95]
  v_mfma_f32_16x16x32_bf16 a[96:99], a[32:35], a[172:175], a[96:99]
  s_waitcnt vmcnt(9)
  s_barrier
  buffer_store_dword v176, v182, s[36:39], 0 offen offset:4 sc1
  v_mfma_f32_16x16x32_bf16 a[96:99], a[48:51], a[188:191], a[96:99]
  v_mfma_f32_16x16x32_bf16 a[100:103], a[36:39], a[172:175], a[100:103]
  v_mfma_f32_16x16x32_bf16 a[100:103], a[52:55], a[188:191], a[100:103]
  v_mfma_f32_16x16x32_bf16 a[104:107], a[40:43], a[172:175], a[104:107]
  v_mfma_f32_16x16x32_bf16 a[104:107], a[56:59], a[188:191], a[104:107]
  v_mfma_f32_16x16x32_bf16 a[108:111], a[44:47], a[172:175], a[108:111]
  v_mfma_f32_16x16x32_bf16 a[108:111], a[60:63], a[188:191], a[108:111]
  s_waitcnt vmcnt(1)
  v_cmp_ne_u32 vcc, v179, v176
  s_cbranch_vccnz L_slow2
L_ret2:
  s_add_u32 s97, s95, 65536
  buffer_load_dwordx4 a[192:195], v190, s[36:39], s97 offen sc1
  s_add_u32 s98, s95, 69632
  buffer_load_dwordx4 a[208:211], v190, s[36:39], s98 offen sc1
  buffer_load_dwordx4 a[196:199], v191, s[36:39], s97 offen sc1
  buffer_load_dwordx4 a[212:215], v191, s[36:39], s98 offen sc1
  buffer_load_dwordx4 a[200:203], v204, s[36:39], s97 offen sc1
  buffer_load_dwordx4 a[216:219], v204, s[36:39], s98 offen sc1
  buffer_load_dwordx4 a[204:207], v205, s[36:39], s97 offen sc1
  buffer_load_dwordx4 a[220:223], v205, s[36:39], s98 offen sc1
  s_waitcnt lgkmcnt(15)
  s_add_u32 s78, s90, 1310720
  s_add_u32 m0, s77, 98304
  s_nop 0
  buffer_load_dwordx4 v164, s[40:43], s78 offen offset:0 lds
  buffer_load_dwordx4 v165, s[40:43], s78 offen offset:1024 lds
  s_waitcnt vmcnt(8)
  v_mfma_f32_16x16x32_bf16 v[0:3], a[224:227], a[192:195], v[0:3]
  buffer_load_dwordx4 v166, s[40:43], s78 offen offset:2048 lds
  v_mfma_f32_16x16x32_bf16 v[0:3], a[240:243], a[208:211], v[0:3]
  v_mfma_f32_16x16x32_bf16 v[4:7], a[228:231], a[192:195], v[4:7]
  v_mfma_f32_16x16x32_bf16 v[4:7], a[244:247], a[208:211], v[4:7]
  buffer_load_dwordx4 v167, s[40:43], s78 offen offset:3072 lds
  v_mfma_f32_16x16x32_bf16 v[8:11], a[232:235], a[192:195], v[8:11]
  s_add_u32 s78, s90, 1343488
  v_mfma_f32_16x16x32_bf16 v[8:11], a[248:251], a[208:211], v[8:11]
  s_add_u32 m0, s77, 102400
  v_mfma_f32_16x16x32_bf16 v[12:15], a[236:239], a[192:195], v[12:15]
  buffer_load_dword v178, v180, s[36:39], s96 offen offset:4 sc1
  v_mfma_f32_16x16x32_bf16 v[12:15], a[252:255], a[208:211], v[12:15]
  s_waitcnt vmcnt(9)
  buffer_load_dwordx4 v164, s[40:43], s78 offen offset:0 lds
  v_mfma_f32_16x16x32_bf16 a[64:67], a[224:227], a[196:199], a[64:67]
  v_mfma_f32_16x16x32_bf16 a[64:67], a[240:243], a[212:215], a[64:67]
  v_mfma_f32_16x16x32_bf16 a[68:71], a[228:231], a[196:199], a[68:71]
  buffer_load_dwordx4 v165, s[40:43], s78 offen offset:1024 lds
  v_mfma_f32_16x16x32_bf16 a[68:71], a[244:247], a[212:215], a[68:71]
  v_mfma_f32_16x16x32_bf16 a[72:75], a[232:235], a[196:199], a[72:75]
  v_mfma_f32_16x16x32_bf16 a[72:75], a[248:251], a[212:215], a[72:75]
  buffer_load_dwordx4 v166, s[40:43], s78 offen offset:2048 lds
  v_mfma_f32_16x16x32_bf16 a[76:79], a[236:239], a[196:199], a[76:79]
  v_mfma_f32_16x16x32_bf16 a[76:79], a[252:255], a[212:215], a[76:79]
  s_waitcnt vmcnt(10)
  v_mfma_f32_16x16x32_bf16 a[80:83], a[224:227], a[200:203], a[80:83]
  buffer_load_dwordx4 v167, s[40:43], s78 offen offset:3072 lds
  v_mfma_f32_16x16x32_bf16 a[80:83], a[240:243], a[216:219], a[80:83]
  s_waitcnt lgkmcnt(0)
  s_add_u32 m0, s77, 0
  v_mfma_f32_16x16x32_bf16 a[84:87], a[228:231], a[200:203], a[84:87]
  s_add_u32 s78, s91, 1310720
  v_mfma_f32_16x16x32_bf16 a[84:87], a[244:247], a[216:219], a[84:87]
  buffer_load_dwordx4 v164, s[40:43], s78 offen offset:0 lds
  v_mfma_f32_16x16x32_bf16 a[88:91], a[232:235], a[200:203], a[88:91]
  v_mfma_f32_16x16x32_bf16 a[88:91], a[248:251], a[216:219], a[88:91]
  v_mfma_f32_16x16x32_bf16 a[92:95], a[236:239], a[200:203], a[92:95]
  buffer_load_dwordx4 v165, s[40:43], s78 offen offset:1024 lds
  v_mfma_f32_16x16x32_bf16 a[92:95], a[252:255], a[216:219], a[92:95]
  s_waitcnt vmcnt(11)
  v_mfma_f32_16x16x32_bf16 a[96:99], a[224:227], a[204:207], a[96:99]
  v_mfma_f32_16x16x32_bf16 a[96:99], a[240:243], a[220:223], a[96:99]
  buffer_load_dwordx4 v166, s[40:43], s78 offen offset:2048 lds
  v_mfma_f32_16x16x32_bf16 a[100:103], a[228:231], a[204:207], a[100:103]
  v_mfma_f32_16x16x32_bf16 a[100:103], a[244:247], a[220:223], a[100:103]
  v_mfma_f32_16x16x32_bf16 a[104:107], a[232:235], a[204:207], a[104:107]
  buffer_load_dwordx4 v167, s[40:43], s78 offen offset:3072 lds
  v_mfma_f32_16x16x32_bf16 a[104:107], a[248:251], a[220:223], a[104:107]
  s_add_u32 s78, s91, 1343488
  v_mfma_f32_16x16x32_bf16 a[108:111], a[236:239], a[204:207], a[108:111]
  s_add_u32 m0, s77, 4096
  v_mfma_f32_16x16x32_bf16 a[108:111], a[252:255], a[220:223], a[108:111]
  buffer_load_dwordx4 v164, s[40:43], s78 offen offset:0 lds
  buffer_load_dwordx4 v165, s[40:43], s78 offen offset:1024 lds
  buffer_load_dwordx4 v166, s[40:43], s78 offen offset:2048 lds
  buffer_load_dwordx4 v167, s[40:43], s78 offen offset:3072 lds
  s_waitcnt vmcnt(12)
  v_cmp_ne_u32 vcc, v178, v176
  s_cbranch_vccnz L_slow3
L_ret3:
  s_add_u32 s97, s93, 0
  buffer_load_dwordx4 a[32:35], v190, s[36:39], s97 offen sc1
  s_add_u32 s98, s93, 4096
  buffer_load_dwordx4 a[48:51], v190, s[36:39], s98 offen sc1
  buffer_load_dwordx4 a[36:39], v191, s[36:39], s97 offen sc1
  buffer_load_dwordx4 a[52:55], v191, s[36:39], s98 offen sc1
  buffer_load_dword v179, v180, s[36:39], s96 offen offset:1028 sc1
  buffer_load_dwordx4 a[40:43], v204, s[36:39], s97 offen sc1
  buffer_load_dwordx4 a[56:59], v204, s[36:39], s98 offen sc1
  buffer_load_dwordx4 a[44:47], v205, s[36:39], s97 offen sc1
  buffer_load_dwordx4 a[60:63], v205, s[36:39], s98 offen sc1
  s_add_u32 s97, s94, 0
  buffer_load_dwordx4 a[128:131], v190, s[36:39], s97 offen sc1
  s_add_u32 s98, s94, 4096
  buffer_load_dwordx4 a[144:147], v190, s[36:39], s98 offen sc1
  s_waitcnt vmcnt(9)
  v_mfma_f32_16x16x32_bf16 v[0:3], a[0:3], a[32:35], v[0:3]
  buffer_load_dwordx4 a[132:135], v191, s[36:39], s97 offen sc1
  v_mfma_f32_16x16x32_bf16 v[0:3], a[16:19], a[48:51], v[0:3]
  ds_read_b64_tr_b16 v[128:129], v168 offset:32768
  v_mfma_f32_16x16x32_bf16 v[4:7], a[4:7], a[32:35], v[4:7]
  ds_read_b64_tr_b16 v[130:131], v168 offset:34816
  v_mfma_f32_16x16x32_bf16 v[4:7], a[20:23], a[48:51], v[4:7]
  ds_read_b64_tr_b16 v[132:133], v169 offset:32768
  v_mfma_f32_16x16x32_bf16 v[8:11], a[8:11], a[32:35], v[8:11]
  buffer_load_dwordx4 a[148:151], v191, s[36:39], s98 offen sc1
  v_mfma_f32_16x16x32_bf16 v[8:11], a[24:27], a[48:51], v[8:11]
  ds_read_b64_tr_b16 v[134:135], v169 offset:34816
  v_mfma_f32_16x16x32_bf16 v[12:15], a[12:15], a[32:35], v[12:15]
  ds_read_b64_tr_b16 v[136:137], v170 offset:32768
  v_mfma_f32_16x16x32_bf16 v[12:15], a[28:31], a[48:51], v[12:15]
  s_waitcnt vmcnt(9)
  ds_read_b64_tr_b16 v[138:139], v170 offset:34816
  v_mfma_f32_16x16x32_bf16 a[64:67], a[0:3], a[36:39], a[64:67]
  buffer_load_dwordx4 a[136:139], v204, s[36:39], s97 offen sc1
  v_mfma_f32_16x16x32_bf16 a[64:67], a[16:19], a[52:55], a[64:67]
  ds_read_b64_tr_b16 v[140:141], v171 offset:32768
  v_mfma_f32_16x16x32_bf16 a[68:71], a[4:7], a[36:39], a[68:71]
  ds_read_b64_tr_b16 v[142:143], v171 offset:34816
  v_mfma_f32_16x16x32_bf16 a[68:71], a[20:23], a[52:55], a[68:71]
  ds_read_b64_tr_b16 v[144:145], v168 offset:36864
  v_mfma_f32_16x16x32_bf16 a[72:75], a[8:11], a[36:39], a[72:75]
  buffer_load_dwordx4 a[152:155], v204, s[36:39], s98 offen sc1
  v_mfma_f32_16x16x32_bf16 a[72:75], a[24:27], a[52:55], a[72:75]
  ds_read_b64_tr_b16 v[146:147], v168 offset:38912
  v_mfma_f32_16x16x32_bf16 a[76:79], a[12:15], a[36:39], a[76:79]
  ds_read_b64_tr_b16 v[148:149], v169 offset:36864
  v_mfma_f32_16x16x32_bf16 a[76:79], a[28:31], a[52:55], a[76:79]
  s_waitcnt vmcnt(8)
  ds_read_b64_tr_b16 v[150:151], v169 offset:38912
  v_mfma_f32_16x16x32_bf16 a[80:83], a[0:3], a[40:43], a[80:83]
  buffer_load_dwordx4 a[140:143], v205, s[36:39], s97 offen sc1
  v_mfma_f32_16x16x32_bf16 a[80:83], a[16:19], a[56:59], a[80:83]
  ds_read_b64_tr_b16 v[152:153], v170 offset:36864
  v_mfma_f32_16x16x32_bf16 a[84:87], a[4:7], a[40:43], a[84:87]
  ds_read_b64_tr_b16 v[154:155], v170 offset:38912
  v_mfma_f32_16x16x32_bf16 a[84:87], a[20:23], a[56:59], a[84:87]
  ds_read_b64_tr_b16 v[156:157], v171 offset:36864
  v_mfma_f32_16x16x32_bf16 a[88:91], a[8:11], a[40:43], a[88:91]
  buffer_load_dwordx4 a[156:159], v205, s[36:39], s98 offen sc1
  v_mfma_f32_16x16x32_bf16 a[88:91], a[24:27], a[56:59], a[88:91]
  v_cmp_ne_u32 vcc, v179, v176
  s_cbranch_vccnz L_slow4
L_ret4:
  v_mfma_f32_16x16x32_bf16 a[92:95], a[12:15], a[40:43], a[92:95]
  s_add_u32 s97, s93, 163840
  ds_read_b64_tr_b16 v[158:159], v171 offset:38912
  v_mfma_f32_16x16x32_bf16 a[92:95], a[28:31], a[56:59], a[92:95]
  s_waitcnt vmcnt(8)
  v_mfma_f32_16x16x32_bf16 a[96:99], a[0:3], a[44:47], a[96:99]
  buffer_load_dwordx4 a[160:163], v190, s[36:39], s97 offen sc1
  v_mfma_f32_16x16x32_bf16 a[96:99], a[16:19], a[60:63], a[96:99]
  v_mfma_f32_16x16x32_bf16 a[100:103], a[4:7], a[44:47], a[100:103]
  v_mfma_f32_16x16x32_bf16 a[100:103], a[20:23], a[60:63], a[100:103]
  v_mfma_f32_16x16x32_bf16 a[104:107], a[8:11], a[44:47], a[104:107]
  v_mfma_f32_16x16x32_bf16 a[104:107], a[24:27], a[60:63], a[104:107]
  v_mfma_f32_16x16x32_bf16 a[108:111], a[12:15], a[44:47], a[108:111]
  v_mfma_f32_16x16x32_bf16 a[108:111], a[28:31], a[60:63], a[108:111]
  s_waitcnt vmcnt(7) lgkmcnt(0)
  v_mfma_f32_16x16x32_bf16 v[0:3], v[128:131], a[128:131], v[0:3]
  s_add_u32 s98, s93, 167936
  buffer_load_dwordx4 a[176:179], v190, s[36:39], s98 offen sc1
  v_mfma_f32_16x16x32_bf16 v[0:3], v[144:147], a[144:147], v[0:3]
  ds_read_b64_tr_b16 v[16:17], v160 offset:32768
  v_mfma_f32_16x16x32_bf16 v[4:7], v[132:135], a[128:131], v[4:7]
  ds_read_b64_tr_b16 v[18:19], v160 offset:34816
  v_mfma_f32_16x16x32_bf16 v[4:7], v[148:151], a[144:147], v[4:7]
  ds_read_b64_tr_b16 v[20:21], v161 offset:32768
  v_mfma_f32_16x16x32_bf16 v[8:11], v[136:139], a[128:131], v[8:11]
  buffer_load_dwordx4 a[164:167], v191, s[36:39], s97 offen sc1
  v_mfma_f32_16x16x32_bf16 v[8:11], v[152:155], a[144:147], v[8:11]
  ds_read_b64_tr_b16 v[22:23], v161 offset:34816
  v_mfma_f32_16x16x32_bf16 v[12:15], v[140:143], a[128:131], v[12:15]
  ds_read_b64_tr_b16 v[24:25], v162 offset:32768
  v_mfma_f32_16x16x32_bf16 v[12:15], v[156:159], a[144:147], v[12:15]
  s_waitcnt vmcnt(7)
  ds_read_b64_tr_b16 v[26:27], v162 offset:34816
  v_mfma_f32_16x16x32_bf16 a[64:67], v[128:131], a[132:135], a[64:67]
  buffer_load_dwordx4 a[180:183], v191, s[36:39], s98 offen sc1
  v_mfma_f32_16x16x32_bf16 a[64:67], v[144:147], a[148:151], a[64:67]
  ds_read_b64_tr_b16 v[28:29], v163 offset:32768
  v_mfma_f32_16x16x32_bf16 a[68:71], v[132:135], a[132:135], a[68:71]
  ds_read_b64_tr_b16 v[30:31], v163 offset:34816
  v_mfma_f32_16x16x32_bf16 a[68:71], v[148:151], a[148:151], a[68:71]
L_pgK5:
  s_cbranch_execz L_back
  ds_read_b64_tr_b16 v[32:33], v160 offset:36864
  v_mfma_f32_16x16x32_bf16 a[72:75], v[136:139], a[132:135], a[72:75]
  buffer_load_dwordx4 a[168:171], v204, s[36:39], s97 offen sc1
  v_mfma_f32_16x16x32_bf16 a[72:75], v[152:155], a[148:151], a[72:75]
  ds_read_b64_tr_b16 v[34:35], v160 offset:38912
  v_mfma_f32_16x16x32_bf16 a[76:79], v[140:143], a[132:135], a[76:79]
  ds_read_b64_tr_b16 v[36:37], v161 offset:36864
  v_mfma_f32_16x16x32_bf16 a[76:79], v[156:159], a[148:151], a[76:79]
  s_waitcnt vmcnt(7)
  ds_read_b64_tr_b16 v[38:39], v161 offset:38912
  v_mfma_f32_16x16x32_bf16 a[80:83], v[128:131], a[136:139], a[80:83]
  buffer_load_dwordx4 a[184:187], v204, s[36:39], s98 offen sc1
  v_mfma_f32_16x16x32_bf16 a[80:83], v[144:147], a[152:155], a[80:83]
  ds_read_b64_tr_b16 v[40:41], v162 offset:36864
  v_mfma_f32_16x16x32_bf16 a[84:87], v[132:135], a[136:139], a[84:87]
  ds_read_b64_tr_b16 v[42:43], v162 offset:38912
  v_mfma_f32_16x16x32_bf16 a[84:87], v[148:151], a[152:155], a[84:87]
  ds_read_b64_tr_b16 v[44:45], v163 offset:36864
  v_mfma_f32_16x16x32_bf16 a[88:91], v[136:139], a[136:139], a[88:91]
  buffer_load_dwordx4 a[172:175], v205, s[36:39], s97 offen sc1
  v_mfma_f32_16x16x32_bf16 a[88:91], v[152:155], a[152:155], a[88:91]
  s_add_u32 s97, s94, 163840
  ds_read_b64_tr_b16 v[46:47], v163 offset:38912
  v_mfma_f32_16x16x32_bf16 a[92:95], v[140:143], a[136:139], a[92:95]
  v_mfma_f32_16x16x32_bf16 a[92:95], v[156:159], a[152:155], a[92:95]
  s_waitcnt vmcnt(7)
  v_mfma_f32_16x16x32_bf16 a[96:99], v[128:131], a[140:143], a[96:99]
  buffer_load_dwordx4 a[188:191], v205, s[36:39], s98 offen sc1
  v_mfma_f32_16x16x32_bf16 a[96:99], v[144:147], a[156:159], a[96:99]
  v_mfma_f32_16x16x32_bf16 a[100:103], v[132:135], a[140:143], a[100:103]
  v_mfma_f32_16x16x32_bf16 a[100:103], v[148:151], a[156:159], a[100:103]
  v_mfma_f32_16x16x32_bf16 a[104:107], v[136:139], a[140:143], a[104:107]
  buffer_load_dwordx4 a[192:195], v190, s[36:39], s97 offen sc1
  v_mfma_f32_16x16x32_bf16 a[104:107], v[152:155], a[156:159], a[104:107]
  v_mfma_f32_16x16x32_bf16 a[108:111], v[140:143], a[140:143], a[108:111]
  v_mfma_f32_16x16x32_bf16 a[108:111], v[156:159], a[156:159], a[108:111]
  s_waitcnt vmcnt(7) lgkmcnt(0)
  v_mfma_f32_16x16x32_bf16 v[0:3], v[16:19], a[160:163], v[0:3]
  s_add_u32 s98, s94, 167936
  buffer_load_dwordx4 a[208:211], v190, s[36:39], s98 offen sc1
  v_mfma_f32_16x16x32_bf16 v[0:3], v[32:35], a[176:179], v[0:3]
  ds_read_b64_tr_b16 v[128:129], v168 offset:0
  v_mfma_f32_16x16x32_bf16 v[4:7], v[20:23], a[160:163], v[4:7]
  ds_read_b64_tr_b16 v[130:131], v168 offset:2048
  v_mfma_f32_16x16x32_bf16 v[4:7], v[36:39], a[176:179], v[4:7]
  ds_read_b64_tr_b16 v[132:133], v169 offset:0
  v_mfma_f32_16x16x32_bf16 v[8:11], v[24:27], a[160:163], v[8:11]
  buffer_load_dwordx4 a[196:199], v191, s[36:39], s97 offen sc1
  v_mfma_f32_16x16x32_bf16 v[8:11], v[40:43], a[176:179], v[8:11]
  ds_read_b64_tr_b16 v[134:135], v169 offset:2048
  v_mfma_f32_16x16x32_bf16 v[12:15], v[28:31], a[160:163], v[12:15]
  ds_read_b64_tr_b16 v[136:137], v170 offset:0
  v_mfma_f32_16x16x32_bf16 v[12:15], v[44:47], a[176:179], v[12:15]
  s_waitcnt vmcnt(7)
  ds_read_b64_tr_b16 v[138:139], v170 offset:2048
  v_mfma_f32_16x16x32_bf16 a[64:67], v[16:19], a[164:167], a[64:67]
  buffer_load_dwordx4 a[212:215], v191, s[36:39], s98 offen sc1
  v_mfma_f32_16x16x32_bf16 a[64:67], v[32:35], a[180:183], a[64:67]
  ds_read_b64_tr_b16 v[140:141], v171 offset:0
  v_mfma_f32_16x16x32_bf16 a[68:71], v[20:23], a[164:167], a[68:71]
  ds_read_b64_tr_b16 v[142:143], v171 offset:2048
  v_mfma_f32_16x16x32_bf16 a[68:71], v[36:39], a[180:183], a[68:71]
  ds_read_b64_tr_b16 v[144:145], v168 offset:4096
  v_mfma_f32_16x16x32_bf16 a[72:75], v[24:27], a[164:167], a[72:75]
  buffer_load_dwordx4 a[200:203], v204, s[36:39], s97 offen sc1
  v_mfma_f32_16x16x32_bf16 a[72:75], v[40:43], a[180:183], a[72:75]
  ds_read_b64_tr_b16 v[146:147], v168 offset:6144
  v_mfma_f32_16x16x32_bf16 a[76:79], v[28:31], a[164:167], a[76:79]
  ds_read_b64_tr_b16 v[148:149], v169 offset:4096
  v_mfma_f32_16x16x32_bf16 a[76:79], v[44:47], a[180:183], a[76:79]
  s_waitcnt vmcnt(7)
  ds_read_b64_tr_b16 v[150:151], v169 offset:6144
  v_mfma_f32_16x16x32_bf16 a[80:83], v[16:19], a[168:171], a[80:83]
  buffer_load_dwordx4 a[216:219], v204, s[36:39], s98 offen sc1
  v_mfma_f32_16x16x32_bf16 a[80:83], v[32:35], a[184:187], a[80:83]
  ds_read_b64_tr_b16 v[152:153], v170 offset:4096
  v_mfma_f32_16x16x32_bf16 a[84:87], v[20:23], a[168:171], a[84:87]
  ds_read_b64_tr_b16 v[154:155], v170 offset:6144
  v_mfma_f32_16x16x32_bf16 a[84:87], v[36:39], a[184:187], a[84:87]
  ds_read_b64_tr_b16 v[156:157], v171 offset:4096
  v_mfma_f32_16x16x32_bf16 a[88:91], v[24:27], a[168:171], a[88:91]
  buffer_load_dwordx4 a[204:207], v205, s[36:39], s97 offen sc1
  v_mfma_f32_16x16x32_bf16 a[88:91], v[40:43], a[184:187], a[88:91]
  s_add_u32 s97, s93, 229376
  ds_read_b64_tr_b16 v[158:159], v171 offset:6144
  v_mfma_f32_16x16x32_bf16 a[92:95], v[28:31], a[168:171], a[92:95]
  v_mfma_f32_16x16x32_bf16 a[92:95], v[44:47], a[184:187], a[92:95]
  s_waitcnt vmcnt(7)
  v_mfma_f32_16x16x32_bf16 a[96:99], v[16:19], a[172:175], a[96:99]
  buffer_load_dwordx4 a[220:223], v205, s[36:39], s98 offen sc1
  v_mfma_f32_16x16x32_bf16 a[96:99], v[32:35], a[188:191], a[96:99]
  ds_read_b64_tr_b16 v[64:65], v200 offset:0
  ds_read_b64_tr_b16 v[66:67], v200 offset:2048
  v_mfma_f32_16x16x32_bf16 a[100:103], v[20:23], a[172:175], a[100:103]
  ds_read_b64_tr_b16 v[68:69], v200 offset:4096
  ds_read_b64_tr_b16 v[70:71], v200 offset:6144
  v_mfma_f32_16x16x32_bf16 a[100:103], v[36:39], a[188:191], a[100:103]
  ds_read_b64_tr_b16 v[72:73], v160 offset:0
  ds_read_b64_tr_b16 v[74:75], v160 offset:2048
  v_mfma_f32_16x16x32_bf16 a[104:107], v[24:27], a[172:175], a[104:107]
  buffer_load_dwordx4 a[236:239], v205, s[36:39], s97 offen sc1
  v_mfma_f32_16x16x32_bf16 a[104:107], v[40:43], a[188:191], a[104:107]
  ds_read_b64_tr_b16 v[76:77], v160 offset:4096
  ds_read_b64_tr_b16 v[78:79], v160 offset:6144
  v_mfma_f32_16x16x32_bf16 a[108:111], v[28:31], a[172:175], a[108:111]
  ds_read_b64_tr_b16 v[80:81], v201 offset:0
  ds_read_b64_tr_b16 v[82:83], v201 offset:2048
  v_mfma_f32_16x16x32_bf16 a[108:111], v[44:47], a[188:191], a[108:111]
  s_waitcnt vmcnt(7) lgkmcnt(10)
  ds_read_b64_tr_b16 v[84:85], v201 offset:4096
  ds_read_b64_tr_b16 v[86:87], v201 offset:6144
  v_mfma_f32_16x16x32_bf16 v[0:3], v[128:131], a[192:195], v[0:3]
  s_add_u32 s98, s93, 233472
  buffer_load_dwordx4 a[252:255], v205, s[36:39], s98 offen sc1
  v_mfma_f32_16x16x32_bf16 v[0:3], v[144:147], a[208:211], v[0:3]
  s_add_u32 s99, s94, 229376
  ds_read_b64_tr_b16 v[88:89], v161 offset:0
  s_add_u32 s79, s94, 233472
  v_mfma_f32_16x16x32_bf16 v[4:7], v[132:135], a[192:195], v[4:7]
  ds_read_b64_tr_b16 v[90:91], v161 offset:2048
  v_mfma_f32_16x16x32_bf16 v[4:7], v[148:151], a[208:211], v[4:7]
  ds_read_b64_tr_b16 v[92:93], v161 offset:4096
  ds_read_b64_tr_b16 v[94:95], v161 offset:6144
  v_mfma_f32_16x16x32_bf16 v[8:11], v[136:139], a[192:195], v[8:11]
  buffer_load_dwordx4 a[12:15], v205, s[36:39], s99 offen sc1
  v_mfma_f32_16x16x32_bf16 v[8:11], v[152:155], a[208:211], v[8:11]
  ds_read_b64_tr_b16 v[96:97], v202 offset:0
  ds_read_b64_tr_b16 v[98:99], v202 offset:2048
  v_mfma_f32_16x16x32_bf16 v[12:15], v[140:143], a[192:195], v[12:15]
  ds_read_b64_tr_b16 v[100:101], v202 offset:4096
  ds_read_b64_tr_b16 v[102:103], v202 offset:6144
  v_mfma_f32_16x16x32_bf16 v[12:15], v[156:159], a[208:211], v[12:15]
  s_waitcnt vmcnt(7)
  ds_read_b64_tr_b16 v[104:105], v162 offset:0
  ds_read_b64_tr_b16 v[106:107], v162 offset:2048
  v_mfma_f32_16x16x32_bf16 a[64:67], v[128:131], a[196:199], a[64:67]
  buffer_load_dwordx4 a[28:31], v205, s[36:39], s79 offen sc1
  v_mfma_f32_16x16x32_bf16 a[64:67], v[144:147], a[212:215], a[64:67]
  ds_read_b64_tr_b16 v[108:109], v162 offset:4096
  ds_read_b64_tr_b16 v[110:111], v162 offset:6144
  v_mfma_f32_16x16x32_bf16 a[68:71], v[132:135], a[196:199], a[68:71]
  ds_read_b64_tr_b16 v[112:113], v203 offset:0
  ds_read_b64_tr_b16 v[114:115], v203 offset:2048
  v_mfma_f32_16x16x32_bf16 a[68:71], v[148:151], a[212:215], a[68:71]
  ds_read_b64_tr_b16 v[116:117], v203 offset:4096
  ds_read_b64_tr_b16 v[118:119], v203 offset:6144
  v_mfma_f32_16x16x32_bf16 a[72:75], v[136:139], a[196:199], a[72:75]
  buffer_load_dwordx4 a[232:235], v204, s[36:39], s97 offen sc1
  v_mfma_f32_16x16x32_bf16 a[72:75], v[152:155], a[212:215], a[72:75]
  ds_read_b64_tr_b16 v[120:121], v163 offset:0
  ds_read_b64_tr_b16 v[122:123], v163 offset:2048
  v_mfma_f32_16x16x32_bf16 a[76:79], v[140:143], a[196:199], a[76:79]
  ds_read_b64_tr_b16 v[124:125], v163 offset:4096
  ds_read_b64_tr_b16 v[126:127], v163 offset:6144
  v_mfma_f32_16x16x32_bf16 a[76:79], v[156:159], a[212:215], a[76:79]
  s_waitcnt vmcnt(7)
  v_mfma_f32_16x16x32_bf16 a[80:83], v[128:131], a[200:203], a[80:83]
  buffer_load_dwordx4 a[248:251], v204, s[36:39], s98 offen sc1
  v_mfma_f32_16x16x32_bf16 a[80:83], v[144:147], a[216:219], a[80:83]
  v_mfma_f32_16x16x32_bf16 a[84:87], v[132:135], a[200:203], a[84:87]
  v_mfma_f32_16x16x32_bf16 a[84:87], v[148:151], a[216:219], a[84:87]
  v_mfma_f32_16x16x32_bf16 a[88:91], v[136:139], a[200:203], a[88:91]
  buffer_load_dwordx4 a[8:11], v204, s[36:39], s99 offen sc1
  v_mfma_f32_16x16x32_bf16 a[88:91], v[152:155], a[216:219], a[88:91]
  v_mfma_f32_16x16x32_bf16 a[92:95], v[140:143], a[200:203], a[92:95]
  v_mfma_f32_16x16x32_bf16 a[92:95], v[156:159], a[216:219], a[92:95]
  s_waitcnt vmcnt(7)
  v_mfma_f32_16x16x32_bf16 a[96:99], v[128:131], a[204:207], a[96:99]
  buffer_load_dwordx4 a[24:27], v204, s[36:39], s79 offen sc1
  v_mfma_f32_16x16x32_bf16 a[96:99], v[144:147], a[220:223], a[96:99]
  v_mfma_f32_16x16x32_bf16 a[100:103], v[132:135], a[204:207], a[100:103]
  v_mfma_f32_16x16x32_bf16 a[100:103], v[148:151], a[220:223], a[100:103]
  v_mfma_f32_16x16x32_bf16 a[104:107], v[136:139], a[204:207], a[104:107]
  buffer_load_dwordx4 a[228:231], v191, s[36:39], s97 offen sc1
  v_mfma_f32_16x16x32_bf16 a[104:107], v[152:155], a[220:223], a[104:107]
  v_mfma_f32_16x16x32_bf16 a[108:111], v[140:143], a[204:207], a[108:111]
  v_mfma_f32_16x16x32_bf16 a[108:111], v[156:159], a[220:223], a[108:111]
  s_waitcnt vmcnt(5) lgkmcnt(15)
  v_mfma_f32_16x16x32_bf16 a[96:99], v[64:67], a[236:239], a[96:99]
  buffer_load_dwordx4 a[244:247], v191, s[36:39], s98 offen sc1
  v_mfma_f32_16x16x32_bf16 a[96:99], v[68:71], a[252:255], a[96:99]
  v_mfma_f32_16x16x32_bf16 a[96:99], v[72:75], a[12:15], a[96:99]
  v_mfma_f32_16x16x32_bf16 a[96:99], v[76:79], a[28:31], a[96:99]
  v_mfma_f32_16x16x32_bf16 a[100:103], v[80:83], a[236:239], a[100:103]
  buffer_load_dwordx4 a[4:7], v191, s[36:39], s99 offen sc1
  v_mfma_f32_16x16x32_bf16 a[100:103], v[84:87], a[252:255], a[100:103]
  v_mfma_f32_16x16x32_bf16 a[100:103], v[88:91], a[12:15], a[100:103]
  v_mfma_f32_16x16x32_bf16 a[100:103], v[92:95], a[28:31], a[100:103]
  s_waitcnt lgkmcnt(0)
  v_mfma_f32_16x16x32_bf16 a[104:107], v[96:99], a[236:239], a[104:107]
  buffer_load_dwordx4 a[20:23], v191, s[36:39], s79 offen sc1
  v_mfma_f32_16x16x32_bf16 a[104:107], v[100:103], a[252:255], a[104:107]
  v_mfma_f32_16x16x32_bf16 a[104:107], v[104:107], a[12:15], a[104:107]
  v_mfma_f32_16x16x32_bf16 a[104:107], v[108:111], a[28:31], a[104:107]
  ds_write_b128 v208, a[96:99] offset:0
  v_mfma_f32_16x16x32_bf16 a[108:111], v[112:115], a[236:239], a[108:111]
  buffer_load_dwordx4 a[224:227], v190, s[36:39], s97 offen sc1
  v_mfma_f32_16x16x32_bf16 a[108:111], v[116:119], a[252:255], a[108:111]
  v_mfma_f32_16x16x32_bf16 a[108:111], v[120:123], a[12:15], a[108:111]
  v_mfma_f32_16x16x32_bf16 a[108:111], v[124:127], a[28:31], a[108:111]
  s_waitcnt vmcnt(5)
  ds_write_b128 v208, a[100:103] offset:1024
  v_mfma_f32_16x16x32_bf16 a[80:83], v[64:67], a[232:235], a[80:83]
  buffer_load_dwordx4 a[240:243], v190, s[36:39], s98 offen sc1
  v_mfma_f32_16x16x32_bf16 a[80:83], v[68:71], a[248:251], a[80:83]
  v_mfma_f32_16x16x32_bf16 a[80:83], v[72:75], a[8:11], a[80:83]
  v_mfma_f32_16x16x32_bf16 a[80:83], v[76:79], a[24:27], a[80:83]
  ds_write_b128 v208, a[104:107] offset:2048
  v_mfma_f32_16x16x32_bf16 a[84:87], v[80:83], a[232:235], a[84:87]
  buffer_load_dwordx4 a[0:3], v190, s[36:39], s99 offen sc1
  v_mfma_f32_16x16x32_bf16 a[84:87], v[84:87], a[248:251], a[84:87]
  v_mfma_f32_16x16x32_bf16 a[84:87], v[88:91], a[8:11], a[84:87]
  v_mfma_f32_16x16x32_bf16 a[84:87], v[92:95], a[24:27], a[84:87]
  ds_write_b128 v208, a[108:111] offset:3072
  v_mfma_f32_16x16x32_bf16 a[88:91], v[96:99], a[232:235], a[88:91]
  buffer_load_dwordx4 a[16:19], v190, s[36:39], s79 offen sc1
  v_mfma_f32_16x16x32_bf16 a[88:91], v[100:103], a[248:251], a[88:91]
  v_mfma_f32_16x16x32_bf16 a[88:91], v[104:107], a[8:11], a[88:91]
  v_mfma_f32_16x16x32_bf16 a[88:91], v[108:111], a[24:27], a[88:91]
  ds_write_b128 v208, a[80:83] offset:36864
  v_mfma_f32_16x16x32_bf16 a[92:95], v[112:115], a[232:235], a[92:95]
  v_mfma_f32_16x16x32_bf16 a[92:95], v[116:119], a[248:251], a[92:95]
  v_mfma_f32_16x16x32_bf16 a[92:95], v[120:123], a[8:11], a[92:95]
  v_mfma_f32_16x16x32_bf16 a[92:95], v[124:127], a[24:27], a[92:95]
  s_waitcnt vmcnt(4)
  ds_write_b128 v208, a[84:87] offset:37888
  v_mfma_f32_16x16x32_bf16 a[64:67], v[64:67], a[228:231], a[64:67]
  v_mfma_f32_16x16x32_bf16 a[64:67], v[68:71], a[244:247], a[64:67]
  v_mfma_f32_16x16x32_bf16 a[64:67], v[72:75], a[4:7], a[64:67]
  v_mfma_f32_16x16x32_bf16 a[64:67], v[76:79], a[20:23], a[64:67]
  ds_write_b128 v208, a[88:91] offset:38912
  v_mfma_f32_16x16x32_bf16 a[68:71], v[80:83], a[228:231], a[68:71]
  v_mfma_f32_16x16x32_bf16 a[68:71], v[84:87], a[244:247], a[68:71]
  v_mfma_f32_16x16x32_bf16 a[68:71], v[88:91], a[4:7], a[68:71]
  v_mfma_f32_16x16x32_bf16 a[68:71], v[92:95], a[20:23], a[68:71]
  ds_write_b128 v208, a[92:95] offset:39936
  v_mfma_f32_16x16x32_bf16 a[72:75], v[96:99], a[228:231], a[72:75]
  v_mfma_f32_16x16x32_bf16 a[72:75], v[100:103], a[244:247], a[72:75]
  v_mfma_f32_16x16x32_bf16 a[72:75], v[104:107], a[4:7], a[72:75]
  v_mfma_f32_16x16x32_bf16 a[72:75], v[108:111], a[20:23], a[72:75]
  ds_write_b128 v208, a[64:67] offset:32768
  v_mfma_f32_16x16x32_bf16 a[76:79], v[112:115], a[228:231], a[76:79]
  v_mfma_f32_16x16x32_bf16 a[76:79], v[116:119], a[244:247], a[76:79]
  v_mfma_f32_16x16x32_bf16 a[76:79], v[120:123], a[4:7], a[76:79]
  v_mfma_f32_16x16x32_bf16 a[76:79], v[124:127], a[20:23], a[76:79]
  s_waitcnt vmcnt(0)
  ds_write_b128 v208, a[68:71] offset:33792
  v_mfma_f32_16x16x32_bf16 v[0:3], v[64:67], a[224:227], v[0:3]
  v_mfma_f32_16x16x32_bf16 v[0:3], v[68:71], a[240:243], v[0:3]
  v_mfma_f32_16x16x32_bf16 v[0:3], v[72:75], a[0:3], v[0:3]
  v_mfma_f32_16x16x32_bf16 v[0:3], v[76:79], a[16:19], v[0:3]
  ds_write_b128 v208, a[72:75] offset:34816
  v_mfma_f32_16x16x32_bf16 v[4:7], v[80:83], a[224:227], v[4:7]
  v_mfma_f32_16x16x32_bf16 v[4:7], v[84:87], a[240:243], v[4:7]
  v_mfma_f32_16x16x32_bf16 v[4:7], v[88:91], a[0:3], v[4:7]
  v_mfma_f32_16x16x32_bf16 v[4:7], v[92:95], a[16:19], v[4:7]
  ds_write_b128 v208, a[76:79] offset:35840
  v_mfma_f32_16x16x32_bf16 v[8:11], v[96:99], a[224:227], v[8:11]
  v_mfma_f32_16x16x32_bf16 v[8:11], v[100:103], a[240:243], v[8:11]
  v_mfma_f32_16x16x32_bf16 v[8:11], v[104:107], a[0:3], v[8:11]
  s_waitcnt lgkmcnt(0)
  s_barrier
  ds_read_b128 v[16:19], v209 offset:32768
  ds_read_b128 v[32:35], v210 offset:36864
  v_mfma_f32_16x16x32_bf16 v[8:11], v[108:111], a[16:19], v[8:11]
  ds_read_b128 v[48:51], v211 offset:0
  ds_read_b128 v[20:23], v209 offset:33792
  v_mfma_f32_16x16x32_bf16 v[12:15], v[112:115], a[224:227], v[12:15]
  ds_read_b128 v[36:39], v210 offset:37888
  ds_read_b128 v[52:55], v211 offset:1024
  v_mfma_f32_16x16x32_bf16 v[12:15], v[116:119], a[240:243], v[12:15]
  ds_read_b128 v[24:27], v209 offset:34816
  ds_read_b128 v[40:43], v210 offset:38912
  v_mfma_f32_16x16x32_bf16 v[12:15], v[120:123], a[0:3], v[12:15]
  ds_read_b128 v[56:59], v211 offset:2048
  ds_read_b128 v[28:31], v209 offset:35840
  v_mfma_f32_16x16x32_bf16 v[12:15], v[124:127], a[16:19], v[12:15]
  ds_read_b128 v[44:47], v210 offset:39936
  ds_read_b128 v[60:63], v211 offset:3072
  s_waitcnt lgkmcnt(11)
  v_pk_add_f32 v[0:1], v[0:1], v[16:17]
  v_pk_add_f32 v[2:3], v[2:3], v[18:19]
  s_waitcnt lgkmcnt(10)
  v_pk_add_f32 v[0:1], v[0:1], v[32:33]
  v_pk_add_f32 v[2:3], v[2:3], v[34:35]
  s_waitcnt lgkmcnt(9)
  v_pk_add_f32 v[0:1], v[0:1], v[48:49]
  v_pk_add_f32 v[2:3], v[2:3], v[50:51]
  v_cvt_pk_bf16_f32 v216, v0, v1
  v_cvt_pk_bf16_f32 v217, v2, v3
  s_waitcnt lgkmcnt(8)
  v_pk_add_f32 v[4:5], v[4:5], v[20:21]
  v_pk_add_f32 v[6:7], v[6:7], v[22:23]
  s_waitcnt lgkmcnt(7)
  v_pk_add_f32 v[4:5], v[4:5], v[36:37]
  v_pk_add_f32 v[6:7], v[6:7], v[38:39]
  s_waitcnt lgkmcnt(6)
  v_pk_add_f32 v[4:5], v[4:5], v[52:53]
  v_pk_add_f32 v[6:7], v[6:7], v[54:55]
  v_cvt_pk_bf16_f32 v218, v4, v5
  v_cvt_pk_bf16_f32 v219, v6, v7
  s_nop 0
  v_permlane16_swap_b32 v216, v218
  v_permlane16_swap_b32 v217, v219
  buffer_store_dwordx4 v[216:219], v212, s[48:51], 0 offen offset:0 sc1
  s_waitcnt lgkmcnt(5)
  v_pk_add_f32 v[8:9], v[8:9], v[24:25]
  v_pk_add_f32 v[10:11], v[10:11], v[26:27]
  s_waitcnt lgkmcnt(4)
  v_pk_add_f32 v[8:9], v[8:9], v[40:41]
  v_pk_add_f32 v[10:11], v[10:11], v[42:43]
  s_waitcnt lgkmcnt(3)
  v_pk_add_f32 v[8:9], v[8:9], v[56:57]
  v_pk_add_f32 v[10:11], v[10:11], v[58:59]
  v_cvt_pk_bf16_f32 v220, v8, v9
  v_cvt_pk_bf16_f32 v221, v10, v11
  s_waitcnt lgkmcnt(2)
  v_pk_add_f32 v[12:13], v[12:13], v[28:29]
  v_pk_add_f32 v[14:15], v[14:15], v[30:31]
  s_waitcnt lgkmcnt(1)
  v_pk_add_f32 v[12:13], v[12:13], v[44:45]
  v_pk_add_f32 v[14:15], v[14:15], v[46:47]
  s_waitcnt lgkmcnt(0)
  v_pk_add_f32 v[12:13], v[12:13], v[60:61]
  v_pk_add_f32 v[14:15], v[14:15], v[62:63]
  v_cvt_pk_bf16_f32 v222, v12, v13
  v_cvt_pk_bf16_f32 v223, v14, v15
  s_nop 0
  v_permlane16_swap_b32 v220, v222
  v_permlane16_swap_b32 v221, v223
  buffer_store_dwordx4 v[220:223], v212, s[48:51], 0 offen offset:64 sc1
  s_endpgm
L_slow0:
  s_mov_b32 s3, 0
L_slow0_l:
  buffer_load_dword v178, v180, s[36:39], s96 offen offset:1024 sc1
  s_add_u32 s3, s3, 1
  s_waitcnt vmcnt(0)
  v_cmp_ne_u32 vcc, v178, v176
  s_cbranch_vccz L_ret0
  s_cmp_le_u32 s3, 262144
  s_cbranch_scc1 L_slow0_l
  s_branch L_ret0
L_slow1:
  s_mov_b32 s3, 0
L_slow1_l:
  s_add_u32 s3, s3, 1
  s_cmp_gt_u32 s3, 131072
  s_cbranch_scc1 L_ret1
  buffer_load_dword v176, off, s[52:55], 0 sc1
  s_waitcnt vmcnt(0)
  v_cmp_eq_u32 vcc, 0, v176
  s_cbranch_vccnz L_slow1_l
  s_branch L_ret1
L_slow2:
  s_mov_b32 s3, 0
L_slow2_l:
  buffer_load_dword v179, v181, s[36:39], s96 offen offset:8 sc1
  s_add_u32 s3, s3, 1
  s_waitcnt vmcnt(0)
  v_cmp_ne_u32 vcc, v179, v176
  s_cbranch_vccz L_ret2
  s_cmp_le_u32 s3, 262144
  s_cbranch_scc1 L_slow2_l
  s_branch L_ret2
L_slow3:
  s_mov_b32 s3, 0
L_slow3_l:
  buffer_load_dword v178, v180, s[36:39], s96 offen offset:4 sc1
  s_add_u32 s3, s3, 1
  s_waitcnt vmcnt(0)
  v_cmp_ne_u32 vcc, v178, v176
  s_cbranch_vccz L_ret3
  s_cmp_le_u32 s3, 262144
  s_cbranch_scc1 L_slow3_l
  s_branch L_ret3
L_slow4:
  s_mov_b32 s3, 0
L_slow4_l:
  buffer_load_dword v179, v180, s[36:39], s96 offen offset:1028 sc1
  s_add_u32 s3, s3, 1
  s_waitcnt vmcnt(0)
  v_cmp_ne_u32 vcc, v179, v176
  s_cbranch_vccz L_ret4
  s_cmp_le_u32 s3, 262144
  s_cbranch_scc1 L_slow4_l
  s_branch L_ret4
.p2align 12
L_pgQ0:
  s_cbranch_execz L_pgQ4
L_typeQ:
  s_mov_b32 m0, s87
  s_nop 0
  global_load_lds_dwordx4 v70, s[12:13]
  s_lshl_b32 s78, s65, 7
  s_add_u32 m0, s76, 81920
  s_nop 0
  buffer_load_dwordx4 v164, s[28:31], s78 offen offset:0 lds
  buffer_load_dwordx4 v165, s[28:31], s78 offen offset:1024 lds
  buffer_load_dwordx4 v166, s[28:31], s78 offen offset:2048 lds
  buffer_load_dwordx4 v167, s[28:31], s78 offen offset:3072 lds
  s_mul_i32 s79, s65, 229376
  s_add_u32 m0, s76, 16384
  s_nop 0
  buffer_load_dwordx4 v168, s[32:35], s79 offen offset:0 lds
  buffer_load_dwordx4 v169, s[32:35], s79 offen offset:1024 lds
  buffer_load_dwordx4 v170, s[32:35], s79 offen offset:2048 lds
  buffer_load_dwordx4 v171, s[32:35], s79 offen offset:3072 lds
  s_waitcnt vmcnt(9) lgkmcnt(0)
  s_barrier
  ds_read_b64_tr_b16 v[128:129], v172 offset:0
  ds_read_b64_tr_b16 v[130:131], v172 offset:512
  ds_read_b64_tr_b16 v[132:133], v172 offset:4096
  ds_read_b64_tr_b16 v[134:135], v172 offset:4608
  ds_read_b128 a[0:3], v160 offset:0
  ds_read_b128 a[16:19], v162 offset:0
  ds_read_b128 a[4:7], v160 offset:2048
  ds_read_b128 a[20:23], v162 offset:2048
  ds_read_b128 a[8:11], v161 offset:0
  ds_read_b128 a[24:27], v163 offset:0
  ds_read_b128 a[12:15], v161 offset:2048
  ds_read_b128 a[28:31], v163 offset:2048
  ds_read_b64_tr_b16 v[136:137], v173 offset:0
  ds_read_b64_tr_b16 v[138:139], v173 offset:512
  s_waitcnt lgkmcnt(9)
  v_mfma_f32_16x16x32_bf16 v[0:3], v[128:131], a[0:3], 0
  s_lshl_b32 s78, s66, 7
  ds_read_b64_tr_b16 v[140:141], v173 offset:4096
  s_mul_i32 s79, s66, 229376
  s_waitcnt lgkmcnt(9)
  v_mfma_f32_16x16x32_bf16 v[0:3], v[132:135], a[16:19], v[0:3]
  s_add_u32 m0, s76, 98304
  s_nop 0
  buffer_load_dwordx4 v164, s[28:31], s78 offen offset:0 lds
  s_waitcnt lgkmcnt(8)
  v_mfma_f32_16x16x32_bf16 v[8:11], v[128:131], a[4:7], 0
  ds_read_b64_tr_b16 v[142:143], v173 offset:4608
  s_waitcnt lgkmcnt(8)
  v_mfma_f32_16x16x32_bf16 v[8:11], v[132:135], a[20:23], v[8:11]
  s_waitcnt lgkmcnt(4)
  v_mfma_f32_16x16x32_bf16 v[16:19], v[128:131], a[8:11], 0
  ds_read_b64_tr_b16 v[112:113], v172 offset:8192
  buffer_load_dwordx4 v165, s[28:31], s78 offen offset:1024 lds
  v_mfma_f32_16x16x32_bf16 v[16:19], v[132:135], a[24:27], v[16:19]
  v_mfma_f32_16x16x32_bf16 v[24:27], v[128:131], a[12:15], 0
  ds_read_b64_tr_b16 v[114:115], v172 offset:8704
  buffer_load_dwordx4 v166, s[28:31], s78 offen offset:2048 lds
  v_mfma_f32_16x16x32_bf16 v[24:27], v[132:135], a[28:31], v[24:27]
  s_waitcnt lgkmcnt(2)
  s_mov_b64 s[52:53], s[24:25]
  s_movk_i32 s54, 256
  s_mov_b32 s55, 0x20000
  s_or_b32 s56, s56, 1
  s_lshl_b32 s77, s58, 13
  v_mov_b32 v72, s56
  v_lshl_add_u32 v73, s2, 8, v69
  v_lshlrev_b32 v73, 8, v73
  buffer_store_dword v72, v73, s[52:55], 0 offen sc1
  s_mov_b32 s24, 0xbdd2d3e8
  v_lshl_add_u32 v74, v65, 2, v66
  v_mfma_f32_16x16x32_bf16 v[4:7], v[136:139], a[0:3], 0
  ds_read_b64_tr_b16 v[116:117], v172 offset:12288
  v_mfma_f32_16x16x32_bf16 v[4:7], v[140:143], a[16:19], v[4:7]
  buffer_load_dwordx4 v167, s[28:31], s78 offen offset:3072 lds
  v_mfma_f32_16x16x32_bf16 v[12:15], v[136:139], a[4:7], 0
  s_add_u32 m0, s76, 32768
  ds_read_b64_tr_b16 v[118:119], v172 offset:12800
  v_mfma_f32_16x16x32_bf16 v[12:15], v[140:143], a[20:23], v[12:15]
  buffer_load_dwordx4 v168, s[32:35], s79 offen offset:0 lds
  v_mfma_f32_16x16x32_bf16 v[20:23], v[136:139], a[8:11], 0
  ds_read_b64_tr_b16 v[128:129], v173 offset:8192
  v_mfma_f32_16x16x32_bf16 v[20:23], v[140:143], a[24:27], v[20:23]
  v_mfma_f32_16x16x32_bf16 v[28:31], v[136:139], a[12:15], 0
  ds_read_b64_tr_b16 v[130:131], v173 offset:8704
  buffer_load_dwordx4 v169, s[32:35], s79 offen offset:1024 lds
  v_mfma_f32_16x16x32_bf16 v[28:31], v[140:143], a[28:31], v[28:31]
  s_waitcnt lgkmcnt(2)
  v_lshrrev_b32 v75, 1, v67
  v_lshl_add_u32 v75, s60, 1, v75
  v_lshlrev_b32 v75, 9, v75
  v_lshl_add_u32 v75, v74, 5, v75
  v_add_u32 v80, 115712, v75
  v_and_b32 v76, 1, v66
  v_mul_u32_u24 v76, 0x8000, v76
  v_lshl_or_b32 v76, v76, 16, v76
  v_bfe_i32 v77, v175, 3, 1
  v_bfe_u32 v78, v74, 1, 2
  v_lshlrev_b32 v78, 5, v78
  v_lshl_add_u32 v78, v67, 3, v78
  v_mfma_f32_16x16x32_bf16 v[32:35], v[112:115], a[0:3], 0
  ds_read_b64_tr_b16 v[132:133], v173 offset:12288
  buffer_load_dwordx4 v170, s[32:35], s79 offen offset:2048 lds
  v_mfma_f32_16x16x32_bf16 v[32:35], v[116:119], a[16:19], v[32:35]
  v_mfma_f32_16x16x32_bf16 v[40:43], v[112:115], a[4:7], 0
  ds_read_b64_tr_b16 v[134:135], v173 offset:12800
  v_mfma_f32_16x16x32_bf16 v[40:43], v[116:119], a[20:23], v[40:43]
  buffer_load_dwordx4 v171, s[32:35], s79 offen offset:3072 lds
  v_mfma_f32_16x16x32_bf16 v[48:51], v[112:115], a[8:11], 0
  s_waitcnt vmcnt(9)
  s_barrier
  ds_read_b64_tr_b16 v[136:137], v172 offset:16384
  ds_read_b128 v[96:99], v174 offset:0
  ds_read_b128 v[100:103], v174 offset:64
  v_mfma_f32_16x16x32_bf16 v[48:51], v[116:119], a[24:27], v[48:51]
  s_lshl_b32 s78, s67, 7
  ds_read_b128 a[32:35], v160 offset:16384
  ds_read_b128 a[48:51], v162 offset:16384
  v_mfma_f32_16x16x32_bf16 v[56:59], v[112:115], a[12:15], 0
  s_mul_i32 s79, s67, 229376
  ds_read_b64_tr_b16 v[138:139], v172 offset:16896
  s_add_u32 m0, s76, 65536
  v_mfma_f32_16x16x32_bf16 v[56:59], v[116:119], a[28:31], v[56:59]
  s_waitcnt lgkmcnt(3)
  ds_read_b128 a[36:39], v160 offset:18432
  ds_read_b128 a[52:55], v162 offset:18432
  v_lshl_add_u32 v78, v74, 7, v78
  s_add_u32 s4, s77, 0x20000
  v_add_u32 v200, s4, v78
  v_xor_b32 v201, 32, v200
  v_xor_b32 v202, 64, v200
  v_xor_b32 v203, 96, v200
  v_mov_b32 v206, 0xc0135761
  v_mov_b32 v207, 0x3fb8aa3b
  v_lshl_add_u32 v188, s60, 11, v183
  v_xor_b32 v189, 2048, v188
  v_lshl_add_u32 v190, s58, 10, v183
  v_xor_b32 v191, 1024, v190
  v_mfma_f32_16x16x32_bf16 v[36:39], v[128:131], a[0:3], 0
  ds_read_b64_tr_b16 v[140:141], v172 offset:20480
  buffer_load_dwordx4 v164, s[28:31], s78 offen offset:0 lds
  v_mfma_f32_16x16x32_bf16 v[36:39], v[132:135], a[16:19], v[36:39]
  ds_read_b128 a[40:43], v161 offset:16384
  v_mfma_f32_16x16x32_bf16 v[44:47], v[128:131], a[4:7], 0
  ds_read_b64_tr_b16 v[142:143], v172 offset:20992
  v_mfma_f32_16x16x32_bf16 v[44:47], v[132:135], a[20:23], v[44:47]
  ds_read_b128 a[56:59], v163 offset:16384
  v_mfma_f32_16x16x32_bf16 v[52:55], v[128:131], a[8:11], 0
  ds_read_b64_tr_b16 v[112:113], v173 offset:16384
  v_mfma_f32_16x16x32_bf16 v[52:55], v[132:135], a[24:27], v[52:55]
  ds_read_b128 a[44:47], v161 offset:18432
  ds_read_b128 a[60:63], v163 offset:18432
  v_mfma_f32_16x16x32_bf16 v[60:63], v[128:131], a[12:15], 0
  ds_read_b64_tr_b16 v[114:115], v173 offset:16896
  buffer_load_dwordx4 v165, s[28:31], s78 offen offset:1024 lds
  v_mfma_f32_16x16x32_bf16 v[60:63], v[132:135], a[28:31], v[60:63]
  s_waitcnt lgkmcnt(5)
  v_xor_b32 v204, 2048, v190
  v_xor_b32 v205, 3072, v190
  v_lshlrev_b32 v225, 3, v69
  v_add_u32 v225, 117760, v225
  s_lshl4_add_u32 s4, s62, s61
  s_lshl_b32 s4, s4, 7
  s_add_u32 s4, s4, 11076608
  v_lshlrev_b32 v79, 24, v69
  v_min_u32 v79, 2147483392, v79
  v_max_u32 v182, s4, v79
  v_lshrrev_b32 v75, 5, v175
  v_mfma_f32_16x16x32_bf16 v[216:219], v[96:99], a[0:3], 0
  v_mfma_f32_16x16x32_bf16 v[216:219], v[100:103], a[16:19], v[216:219]
  v_mfma_f32_16x16x32_bf16 v[220:223], v[96:99], a[4:7], 0
  buffer_load_dwordx4 v166, s[28:31], s78 offen offset:2048 lds
  v_mfma_f32_16x16x32_bf16 v[220:223], v[100:103], a[20:23], v[220:223]
  v_mfma_f32_16x16x32_bf16 v[0:3], v[136:139], a[32:35], v[0:3]
  ds_read_b64_tr_b16 v[116:117], v173 offset:20480
  v_mfma_f32_16x16x32_bf16 v[0:3], v[140:143], a[48:51], v[0:3]
  ds_read_b128 v[104:107], v174 offset:128
  ds_read_b128 v[108:111], v174 offset:192
  v_mfma_f32_16x16x32_bf16 v[8:11], v[136:139], a[36:39], v[8:11]
  ds_read_b64_tr_b16 v[118:119], v173 offset:20992
  v_mfma_f32_16x16x32_bf16 v[8:11], v[140:143], a[52:55], v[8:11]
  s_waitcnt lgkmcnt(5)
  buffer_load_dwordx4 v167, s[28:31], s78 offen offset:3072 lds
  v_mfma_f32_16x16x32_bf16 v[16:19], v[136:139], a[40:43], v[16:19]
  s_add_u32 m0, s76, 49152
  ds_read_b64_tr_b16 v[128:129], v172 offset:24576
  v_mfma_f32_16x16x32_bf16 v[16:19], v[140:143], a[56:59], v[16:19]
  v_mfma_f32_16x16x32_bf16 v[24:27], v[136:139], a[44:47], v[24:27]
  ds_read_b64_tr_b16 v[130:131], v172 offset:25088
  v_mfma_f32_16x16x32_bf16 v[24:27], v[140:143], a[60:63], v[24:27]
  s_waitcnt lgkmcnt(2)
  buffer_load_dwordx4 v168, s[32:35], s79 offen offset:0 lds
  v_lshlrev_b32 v75, 2, v75
  v_and_b32 v78, 31, v175
  v_sub_u32 v75, v78, v75
  v_and_b32 v78, 1, v75
  v_lshlrev_b32 v78, 4, v78
  v_mov_b32 v79, 0x3f80
  v_lshlrev_b32 v78, v78, v79
  v_and_b32 v75, -2, v75
  s_add_u32 s4, s77, 98304
  v_add_u32 v252, s4, v183
  v_and_b32 v253, 0xffffbfff, v252
  v_lshlrev_b32 v226, 11, v68
  v_mfma_f32_16x16x32_bf16 v[4:7], v[112:115], a[32:35], v[4:7]
  ds_read_b64_tr_b16 v[132:133], v172 offset:28672
  v_mfma_f32_16x16x32_bf16 v[4:7], v[116:119], a[48:51], v[4:7]
  v_mfma_f32_16x16x32_bf16 v[12:15], v[112:115], a[36:39], v[12:15]
  ds_read_b64_tr_b16 v[134:135], v172 offset:29184
  v_mfma_f32_16x16x32_bf16 v[12:15], v[116:119], a[52:55], v[12:15]
  v_mfma_f32_16x16x32_bf16 v[20:23], v[112:115], a[40:43], v[20:23]
  ds_read_b64_tr_b16 v[136:137], v173 offset:24576
  buffer_load_dwordx4 v169, s[32:35], s79 offen offset:1024 lds
  v_mfma_f32_16x16x32_bf16 v[20:23], v[116:119], a[56:59], v[20:23]
  v_mfma_f32_16x16x32_bf16 v[28:31], v[112:115], a[44:47], v[28:31]
  ds_read_b64_tr_b16 v[138:139], v173 offset:25088
  v_mfma_f32_16x16x32_bf16 v[28:31], v[116:119], a[60:63], v[28:31]
  s_waitcnt lgkmcnt(2)
  v_cmp_eq_u32 s[8:9], 0, v75
  s_nop 1
  v_cndmask_b32 v228, 0, v78, s[8:9]
  v_cmp_eq_u32 s[8:9], 2, v75
  s_nop 1
  v_cndmask_b32 v229, 0, v78, s[8:9]
  v_cmp_eq_u32 s[8:9], 8, v75
  s_nop 1
  v_cndmask_b32 v230, 0, v78, s[8:9]
  v_cmp_eq_u32 s[8:9], 10, v75
  s_nop 1
  v_cndmask_b32 v231, 0, v78, s[8:9]
  ds_read_b64_tr_b16 v[236:237], v80 offset:0
  ds_read_b64_tr_b16 v[240:241], v80 offset:8
  ds_read_b64_tr_b16 v[244:245], v80 offset:16
  ds_read_b64_tr_b16 v[248:249], v80 offset:24
  v_mfma_f32_16x16x32_bf16 v[216:219], v[104:107], a[32:35], v[216:219]
  buffer_load_dwordx4 v170, s[32:35], s79 offen offset:2048 lds
  v_mfma_f32_16x16x32_bf16 v[216:219], v[108:111], a[48:51], v[216:219]
  v_mfma_f32_16x16x32_bf16 v[32:35], v[128:131], a[32:35], v[32:35]
  ds_read_b64_tr_b16 v[140:141], v173 offset:28672
  v_mfma_f32_16x16x32_bf16 v[32:35], v[132:135], a[48:51], v[32:35]
  v_mfma_f32_16x16x32_bf16 v[40:43], v[128:131], a[36:39], v[40:43]
  ds_read_b64_tr_b16 v[142:143], v173 offset:29184
  v_mfma_f32_16x16x32_bf16 v[40:43], v[132:135], a[52:55], v[40:43]
  buffer_load_dwordx4 v171, s[32:35], s79 offen offset:3072 lds
  v_mfma_f32_16x16x32_bf16 v[48:51], v[128:131], a[40:43], v[48:51]
  s_waitcnt vmcnt(8)
  s_barrier
  ds_read_b64_tr_b16 v[112:113], v172 offset:32768
  v_mfma_f32_16x16x32_bf16 v[48:51], v[132:135], a[56:59], v[48:51]
  s_lshl_b32 s78, s68, 7
  ds_read_b128 a[64:67], v160 offset:32768
  ds_read_b128 a[80:83], v162 offset:32768
  s_add_u32 m0, s76, 81920
  v_mfma_f32_16x16x32_bf16 v[56:59], v[128:131], a[44:47], v[56:59]
  s_mul_i32 s79, s68, 229376
  ds_read_b64_tr_b16 v[114:115], v172 offset:33280
  buffer_load_dwordx4 v164, s[28:31], s78 offen offset:0 lds
  v_mfma_f32_16x16x32_bf16 v[56:59], v[132:135], a[60:63], v[56:59]
  s_waitcnt lgkmcnt(4)
  ds_read_b128 a[68:71], v160 offset:34816
  ds_read_b128 a[84:87], v162 offset:34816
  s_mov_b64 s[36:37], s[26:27]
  s_mov_b32 s38, 12582912
  s_mov_b32 s39, 0x20000
  s_lshl_b32 s97, s61, 7
  s_add_u32 s98, s97, 2560
  s_add_u32 s80, s84, s98
  s_addc_u32 s81, s85, 0
  s_sub_u32 s82, 1835008, s98
  s_add_u32 s84, s6, s97
  s_addc_u32 s85, s7, 0
  s_sub_u32 s86, 1572864, s97
  v_mfma_f32_16x16x32_bf16 v[36:39], v[136:139], a[32:35], v[36:39]
  ds_read_b64_tr_b16 v[116:117], v172 offset:36864
  v_mfma_f32_16x16x32_bf16 v[36:39], v[140:143], a[48:51], v[36:39]
  ds_read_b128 a[72:75], v161 offset:32768
  v_mfma_f32_16x16x32_bf16 v[44:47], v[136:139], a[36:39], v[44:47]
  ds_read_b64_tr_b16 v[118:119], v172 offset:37376
  buffer_load_dwordx4 v165, s[28:31], s78 offen offset:1024 lds
  v_mfma_f32_16x16x32_bf16 v[44:47], v[140:143], a[52:55], v[44:47]
  ds_read_b128 a[88:91], v163 offset:32768
  v_mfma_f32_16x16x32_bf16 v[52:55], v[136:139], a[40:43], v[52:55]
  ds_read_b64_tr_b16 v[128:129], v173 offset:32768
  v_mfma_f32_16x16x32_bf16 v[52:55], v[140:143], a[56:59], v[52:55]
  ds_read_b128 a[76:79], v161 offset:34816
  ds_read_b128 a[92:95], v163 offset:34816
  v_mfma_f32_16x16x32_bf16 v[60:63], v[136:139], a[44:47], v[60:63]
  ds_read_b64_tr_b16 v[130:131], v173 offset:33280
  buffer_load_dwordx4 v166, s[28:31], s78 offen offset:2048 lds
  v_mfma_f32_16x16x32_bf16 v[60:63], v[140:143], a[60:63], v[60:63]
  s_waitcnt lgkmcnt(5)
  s_add_u32 s97, s63, s59
  s_add_u32 s72, s97, 0
  s_and_b32 s72, s72, 7
  s_add_u32 s73, s97, 2
  s_and_b32 s73, s73, 7
  s_add_u32 s74, s97, 4
  s_and_b32 s74, s74, 7
  s_add_u32 s75, s97, 6
  s_and_b32 s75, s75, 7
  s_lshl1_add_u32 s97, s62, s59
  s_mul_i32 s97, s97, 294912
  s_lshl1_add_u32 s98, s61, s60
  v_mfma_f32_16x16x32_bf16 v[220:223], v[104:107], a[36:39], v[220:223]
  v_mfma_f32_16x16x32_bf16 v[220:223], v[108:111], a[52:55], v[220:223]
  v_mfma_f32_16x16x32_bf16 v[0:3], v[112:115], a[64:67], v[0:3]
  ds_read_b64_tr_b16 v[132:133], v173 offset:36864
  buffer_load_dwordx4 v167, s[28:31], s78 offen offset:3072 lds
  v_mfma_f32_16x16x32_bf16 v[0:3], v[116:119], a[80:83], v[0:3]
  s_add_u32 m0, s76, 0
  ds_read_b128 v[96:99], v174 offset:256
  ds_read_b128 v[100:103], v174 offset:320
  v_mfma_f32_16x16x32_bf16 v[8:11], v[112:115], a[68:71], v[8:11]
  s_cmp_eq_u32 s60, 0
  s_cselect_b64 s[12:13], s[6:7], s[14:15]
  s_cselect_b64 s[20:21], s[16:17], s[18:19]
  s_cmp_eq_u32 s59, 0
  s_cselect_b64 s[12:13], s[12:13], s[20:21]
  ds_read_b64_tr_b16 v[134:135], v173 offset:37376
  v_mfma_f32_16x16x32_bf16 v[8:11], v[116:119], a[84:87], v[8:11]
  s_waitcnt lgkmcnt(5)
  s_cmp_eq_u32 s58, 0
  s_movk_i32 s20, 1024
  s_cselect_b32 s20, 3072, s20
  s_cselect_b32 s21, 2, 3
  s_cselect_b32 s5, 0, 524288
  s_cmp_eq_u32 s59, s60
  s_cselect_b32 s20, s20, 3584
  s_cselect_b32 s21, s21, 2
  s_cselect_b32 s5, s5, 1024
  s_cselect_b32 s3, 3, 2
  v_mfma_f32_16x16x32_bf16 v[16:19], v[112:115], a[72:75], v[16:19]
  ds_read_b64_tr_b16 v[136:137], v172 offset:40960
  buffer_load_dwordx4 v168, s[32:35], s79 offen offset:0 lds
  v_mfma_f32_16x16x32_bf16 v[16:19], v[116:119], a[88:91], v[16:19]
  v_lshrrev_b32 v87, s3, v175
  v_lshlrev_b32 v86, s3, v87
  v_mfma_f32_16x16x32_bf16 v[24:27], v[112:115], a[76:79], v[24:27]
  ds_read_b64_tr_b16 v[138:139], v172 offset:41472
  v_sub_u32 v86, v175, v86
  v_lshl_add_u32 v86, v86, 7, s5
  v_mfma_f32_16x16x32_bf16 v[24:27], v[116:119], a[92:95], v[24:27]
  s_waitcnt lgkmcnt(2)
  s_lshl_b32 s99, s98, 12
  s_add_u32 s88, s99, s97
  s_add_u32 s87, s88, 98304
  s_add_u32 s89, s88, 229376
  s_add_u32 s88, s88, 163840
  s_bfe_u32 s99, s2, 196611
  s_xor_b32 s97, s99, s83
  s_and_b32 s97, s97, 1
  s_bfe_u32 s98, s2, 65542
  s_lshl1_add_u32 s97, s98, s97
  s_and_b32 s90, s2, 7
  s_lshl2_add_u32 s97, s90, s97
  v_mfma_f32_16x16x32_bf16 v[4:7], v[128:131], a[64:67], v[4:7]
  s_mul_i32 s5, s21, s2
  ds_read_b64_tr_b16 v[140:141], v172 offset:45056
  buffer_load_dwordx4 v169, s[32:35], s79 offen offset:1024 lds
  v_mfma_f32_16x16x32_bf16 v[4:7], v[132:135], a[80:83], v[4:7]
  s_sub_u32 s21, s21, 1
  v_min_u32 v87, s21, v87
  v_add_u32 v87, s5, v87
  v_mad_u32_u24 v87, v87, s20, v86
  v_mfma_f32_16x16x32_bf16 v[12:15], v[128:131], a[68:71], v[12:15]
  ds_read_b64_tr_b16 v[142:143], v172 offset:45568
  v_mfma_f32_16x16x32_bf16 v[12:15], v[132:135], a[84:87], v[12:15]
  v_mfma_f32_16x16x32_bf16 v[20:23], v[128:131], a[72:75], v[20:23]
  ds_read_b64_tr_b16 v[112:113], v173 offset:40960
  buffer_load_dwordx4 v170, s[32:35], s79 offen offset:2048 lds
  v_mfma_f32_16x16x32_bf16 v[20:23], v[132:135], a[88:91], v[20:23]
  v_mfma_f32_16x16x32_bf16 v[28:31], v[128:131], a[76:79], v[28:31]
  ds_read_b64_tr_b16 v[114:115], v173 offset:41472
  v_mfma_f32_16x16x32_bf16 v[28:31], v[132:135], a[92:95], v[28:31]
  s_waitcnt lgkmcnt(2)
  s_lshr_b32 s90, s99, 1
  s_add_u32 s98, s98, s90
  s_lshl1_add_u32 s90, s58, s98
  s_add_u32 s91, s90, 1
  s_add_u32 s92, s58, s98
  s_and_b32 s92, s92, 3
  v_and_b32 v181, 1, v175
  v_add_u32 v180, s90, v181
  v_and_b32 v180, 7, v180
  v_lshlrev_b32 v180, 7, v180
  v_lshl_add_u32 v181, s92, 1, v181
  v_mfma_f32_16x16x32_bf16 v[216:219], v[96:99], a[64:67], v[216:219]
  buffer_load_dwordx4 v171, s[32:35], s79 offen offset:3072 lds
  v_mfma_f32_16x16x32_bf16 v[216:219], v[100:103], a[80:83], v[216:219]
  v_mfma_f32_16x16x32_bf16 v[32:35], v[136:139], a[64:67], v[32:35]
  ds_read_b64_tr_b16 v[116:117], v173 offset:45056
  v_mfma_f32_16x16x32_bf16 v[32:35], v[140:143], a[80:83], v[32:35]
  v_mfma_f32_16x16x32_bf16 v[40:43], v[136:139], a[68:71], v[40:43]
  ds_read_b64_tr_b16 v[118:119], v173 offset:45568
  global_load_dword v85, v87, s[12:13]
  v_mfma_f32_16x16x32_bf16 v[40:43], v[140:143], a[84:87], v[40:43]
  v_mfma_f32_16x16x32_bf16 v[48:51], v[136:139], a[72:75], v[48:51]
  s_waitcnt vmcnt(9)
  s_barrier
  ds_read_b64_tr_b16 v[128:129], v172 offset:49152
  v_mfma_f32_16x16x32_bf16 v[48:51], v[140:143], a[88:91], v[48:51]
  s_lshl_b32 s78, s69, 7
  ds_read_b128 a[96:99], v160 offset:0
  ds_read_b128 a[112:115], v162 offset:0
  s_add_u32 m0, s76, 98304
  v_mfma_f32_16x16x32_bf16 v[56:59], v[136:139], a[76:79], v[56:59]
  s_mul_i32 s79, s69, 229376
  ds_read_b64_tr_b16 v[130:131], v172 offset:49664
  buffer_load_dwordx4 v164, s[28:31], s78 offen offset:0 lds
  v_mfma_f32_16x16x32_bf16 v[56:59], v[140:143], a[92:95], v[56:59]
  s_waitcnt lgkmcnt(4)
  ds_read_b128 a[100:103], v160 offset:2048
  ds_read_b128 a[116:119], v162 offset:2048
  v_lshlrev_b32_e64 v181, 7, v181
  s_and_b32 s90, s90, 7
  s_and_b32 s91, s91, 7
  s_mul_i32 s98, s97, 36
  s_add_u32 s93, s90, s98
  s_lshl_b32 s93, s93, 13
  s_lshl_b32 s90, s90, 16
  s_add_u32 s94, s91, s98
  s_lshl_b32 s94, s94, 13
  s_lshl_b32 s91, s91, 16
  s_add_u32 s95, s92, s98
  s_lshl_b32 s95, s95, 13
  v_mfma_f32_16x16x32_bf16 v[36:39], v[112:115], a[64:67], v[36:39]
  ds_read_b64_tr_b16 v[132:133], v172 offset:53248
  v_mfma_f32_16x16x32_bf16 v[36:39], v[116:119], a[80:83], v[36:39]
  ds_read_b128 a[104:107], v161 offset:0
  v_mfma_f32_16x16x32_bf16 v[44:47], v[112:115], a[68:71], v[44:47]
  ds_read_b64_tr_b16 v[134:135], v172 offset:53760
  v_mfma_f32_16x16x32_bf16 v[44:47], v[116:119], a[84:87], v[44:47]
  ds_read_b128 a[120:123], v163 offset:0
  buffer_load_dwordx4 v165, s[28:31], s78 offen offset:1024 lds
  v_mfma_f32_16x16x32_bf16 v[52:55], v[112:115], a[72:75], v[52:55]
  ds_read_b64_tr_b16 v[136:137], v173 offset:49152
  v_mfma_f32_16x16x32_bf16 v[52:55], v[116:119], a[88:91], v[52:55]
  ds_read_b128 a[108:111], v161 offset:2048
  ds_read_b128 a[124:127], v163 offset:2048
  v_mfma_f32_16x16x32_bf16 v[60:63], v[112:115], a[76:79], v[60:63]
  ds_read_b64_tr_b16 v[138:139], v173 offset:49664
  v_mfma_f32_16x16x32_bf16 v[60:63], v[116:119], a[92:95], v[60:63]
  s_waitcnt lgkmcnt(5)
  buffer_load_dwordx4 v166, s[28:31], s78 offen offset:2048 lds
  s_lshl_b32 s92, s92, 16
  s_lshr_b32 s96, s97, 1
  s_lshl_b32 s96, s96, 11
  s_add_u32 s96, s96, 11075584
  s_lshl_b32 s99, s99, 7
  s_add_u32 s40, s18, s99
  s_addc_u32 s41, s19, 0
  s_sub_u32 s42, 1835008, s99
  s_mov_b32 s43, 0x20000
  s_add_u32 s44, s10, s99
  s_addc_u32 s45, s11, 0
  s_sub_u32 s46, 524288, s99
  v_mfma_f32_16x16x32_bf16 v[220:223], v[96:99], a[68:71], v[220:223]
  v_mfma_f32_16x16x32_bf16 v[220:223], v[100:103], a[84:87], v[220:223]
  v_mfma_f32_16x16x32_bf16 v[0:3], v[128:131], a[96:99], v[0:3]
  ds_read_b64_tr_b16 v[140:141], v173 offset:53248
  v_mfma_f32_16x16x32_bf16 v[0:3], v[132:135], a[112:115], v[0:3]
  ds_read_b128 v[104:107], v174 offset:384
  ds_read_b128 v[108:111], v174 offset:448
  v_mfma_f32_16x16x32_bf16 v[8:11], v[128:131], a[100:103], v[8:11]
  ds_read_b64_tr_b16 v[142:143], v173 offset:53760
  buffer_load_dwordx4 v167, s[28:31], s78 offen offset:3072 lds
  v_mfma_f32_16x16x32_bf16 v[8:11], v[132:135], a[116:119], v[8:11]
  s_waitcnt lgkmcnt(5)
  v_mfma_f32_16x16x32_bf16 v[16:19], v[128:131], a[104:107], v[16:19]
  s_add_u32 m0, s76, 16384
  ds_read_b64_tr_b16 v[112:113], v172 offset:57344
  v_mfma_f32_16x16x32_bf16 v[16:19], v[132:135], a[120:123], v[16:19]
  v_mfma_f32_16x16x32_bf16 v[24:27], v[128:131], a[108:111], v[24:27]
  ds_read_b64_tr_b16 v[114:115], v172 offset:57856
  buffer_load_dwordx4 v168, s[32:35], s79 offen offset:0 lds
  v_mfma_f32_16x16x32_bf16 v[24:27], v[132:135], a[124:127], v[24:27]
  s_waitcnt lgkmcnt(2)
  s_mov_b32 s47, 0x20000
  s_lshl_b32 s97, s97, 16
  s_add_u32 s97, s97, s99
  s_add_u32 s48, s22, s97
  s_addc_u32 s49, s23, 0
  s_sub_u32 s50, 2097152, s97
  s_mov_b32 s51, 0x20000
  v_bitop3_b32 v238, v236, v76, v77 bitop3:0x28
  v_bitop3_b32 v236, v236, v76, v77 bitop3:0x14
  v_bitop3_b32 v239, v237, v76, v77 bitop3:0x28
  v_bitop3_b32 v237, v237, v76, v77 bitop3:0x14
  v_mfma_f32_16x16x32_bf16 v[4:7], v[136:139], a[96:99], v[4:7]
  ds_read_b64_tr_b16 v[116:117], v172 offset:61440
  v_mfma_f32_16x16x32_bf16 v[4:7], v[140:143], a[112:115], v[4:7]
  v_mfma_f32_16x16x32_bf16 v[12:15], v[136:139], a[100:103], v[12:15]
  ds_read_b64_tr_b16 v[118:119], v172 offset:61952
  v_mfma_f32_16x16x32_bf16 v[12:15], v[140:143], a[116:119], v[12:15]
  buffer_load_dwordx4 v169, s[32:35], s79 offen offset:1024 lds
  v_mfma_f32_16x16x32_bf16 v[20:23], v[136:139], a[104:107], v[20:23]
  ds_read_b64_tr_b16 v[128:129], v173 offset:57344
  v_mfma_f32_16x16x32_bf16 v[20:23], v[140:143], a[120:123], v[20:23]
  v_mfma_f32_16x16x32_bf16 v[28:31], v[136:139], a[108:111], v[28:31]
  ds_read_b64_tr_b16 v[130:131], v173 offset:57856
  v_mfma_f32_16x16x32_bf16 v[28:31], v[140:143], a[124:127], v[28:31]
  s_waitcnt lgkmcnt(2)
  buffer_load_dwordx4 v170, s[32:35], s79 offen offset:2048 lds
  v_bitop3_b32 v242, v240, v76, v77 bitop3:0x28
  v_bitop3_b32 v240, v240, v76, v77 bitop3:0x14
  v_bitop3_b32 v243, v241, v76, v77 bitop3:0x28
  v_bitop3_b32 v241, v241, v76, v77 bitop3:0x14
  v_bitop3_b32 v246, v244, v76, v77 bitop3:0x28
  v_bitop3_b32 v244, v244, v76, v77 bitop3:0x14
  v_bitop3_b32 v247, v245, v76, v77 bitop3:0x28
  v_bitop3_b32 v245, v245, v76, v77 bitop3:0x14
  v_bitop3_b32 v250, v248, v76, v77 bitop3:0x28
  v_bitop3_b32 v248, v248, v76, v77 bitop3:0x14
  v_bitop3_b32 v251, v249, v76, v77 bitop3:0x28
  v_bitop3_b32 v249, v249, v76, v77 bitop3:0x14
  v_mfma_f32_16x16x32_bf16 v[216:219], v[104:107], a[96:99], v[216:219]
  v_mfma_f32_16x16x32_bf16 v[216:219], v[108:111], a[112:115], v[216:219]
  v_mfma_f32_16x16x32_bf16 v[32:35], v[112:115], a[96:99], v[32:35]
  ds_read_b64_tr_b16 v[132:133], v173 offset:61440
  v_mfma_f32_16x16x32_bf16 v[32:35], v[116:119], a[112:115], v[32:35]
  v_mfma_f32_16x16x32_bf16 v[40:43], v[112:115], a[100:103], v[40:43]
  ds_read_b64_tr_b16 v[134:135], v173 offset:61952
  buffer_load_dwordx4 v171, s[32:35], s79 offen offset:3072 lds
  v_mfma_f32_16x16x32_bf16 v[40:43], v[116:119], a[116:119], v[40:43]
  v_mfma_f32_16x16x32_bf16 v[48:51], v[112:115], a[104:107], v[48:51]
  s_waitcnt vmcnt(9)
  s_barrier
  ds_read_b64_tr_b16 v[136:137], v172 offset:0
  v_mfma_f32_16x16x32_bf16 v[48:51], v[116:119], a[120:123], v[48:51]
  s_lshl_b32 s78, s70, 7
  ds_read_b128 a[128:131], v160 offset:16384
  ds_read_b128 a[144:147], v162 offset:16384
  s_add_u32 m0, s76, 65536
  v_mfma_f32_16x16x32_bf16 v[56:59], v[112:115], a[108:111], v[56:59]
  s_mul_i32 s79, s70, 229376
  ds_read_b64_tr_b16 v[138:139], v172 offset:512
  buffer_load_dwordx4 v164, s[28:31], s78 offen offset:0 lds
  v_mfma_f32_16x16x32_bf16 v[56:59], v[116:119], a[124:127], v[56:59]
  s_waitcnt lgkmcnt(4)
  ds_read_b128 a[132:135], v160 offset:18432
  ds_read_b128 a[148:151], v162 offset:18432
  s_lshl1_add_u32 s97, s61, s60
  s_lshl1_add_u32 s97, s97, s59
  s_mov_b32 s57, 0
  s_lshl_b32 s98, s97, 14
  s_add_u32 s25, s98, 10485760
  s_lshl_b32 s97, s97, 10
  s_add_u32 s26, s97, 11010048
  s_lshl_b32 s97, s61, 7
  s_add_u32 s27, s97, 11075584
  v_lshrrev_b32 v93, 3, v175
  v_and_b32 v94, 2, v93
  v_lshl_add_u32 v93, s60, 5, v93
  v_mfma_f32_16x16x32_bf16 v[36:39], v[128:131], a[96:99], v[36:39]
  ds_read_b64_tr_b16 v[140:141], v172 offset:4096
  v_mfma_f32_16x16x32_bf16 v[36:39], v[132:135], a[112:115], v[36:39]
  ds_read_b128 a[136:139], v161 offset:16384
  v_mfma_f32_16x16x32_bf16 v[44:47], v[128:131], a[100:103], v[44:47]
  ds_read_b64_tr_b16 v[142:143], v172 offset:4608
  v_mfma_f32_16x16x32_bf16 v[44:47], v[132:135], a[116:119], v[44:47]
  ds_read_b128 a[152:155], v163 offset:16384
  buffer_load_dwordx4 v165, s[28:31], s78 offen offset:1024 lds
  v_mfma_f32_16x16x32_bf16 v[52:55], v[128:131], a[104:107], v[52:55]
  ds_read_b64_tr_b16 v[112:113], v173 offset:0
  v_mfma_f32_16x16x32_bf16 v[52:55], v[132:135], a[120:123], v[52:55]
  ds_read_b128 a[140:143], v161 offset:18432
  ds_read_b128 a[156:159], v163 offset:18432
  v_mfma_f32_16x16x32_bf16 v[60:63], v[128:131], a[108:111], v[60:63]
  ds_read_b64_tr_b16 v[114:115], v173 offset:512
  v_mfma_f32_16x16x32_bf16 v[60:63], v[132:135], a[124:127], v[60:63]
  s_waitcnt lgkmcnt(5)
  buffer_load_dwordx4 v166, s[28:31], s78 offen offset:2048 lds
  v_mul_u32_u24 v93, 3072, v93
  v_and_b32 v95, 7, v175
  v_xor_b32 v94, v94, v95
  v_lshl_add_u32 v92, v94, 4, v93
  v_xor_b32_e64 v93, 64, v92
  v_add_u32 v93, 23552, v93
  v_add_u32 v94, 47104, v92
  v_add_u32 v95, 47104, v93
  s_lshl2_add_u32 s3, s2, s58
  s_mul_i32 s3, s3, 14
  v_min_u32 v89, 13, v175
  v_add_lshl_u32 v89, v89, s3, 7
  v_mfma_f32_16x16x32_bf16 v[220:223], v[104:107], a[100:103], v[220:223]
  v_mfma_f32_16x16x32_bf16 v[220:223], v[108:111], a[116:119], v[220:223]
  v_mfma_f32_16x16x32_bf16 v[0:3], v[136:139], a[128:131], v[0:3]
  ds_read_b64_tr_b16 v[116:117], v173 offset:4096
  v_mfma_f32_16x16x32_bf16 v[0:3], v[140:143], a[144:147], v[0:3]
  ds_read_b128 v[96:99], v174 offset:512
  ds_read_b128 v[100:103], v174 offset:576
  v_mfma_f32_16x16x32_bf16 v[8:11], v[136:139], a[132:135], v[8:11]
  ds_read_b64_tr_b16 v[118:119], v173 offset:4608
  buffer_load_dwordx4 v167, s[28:31], s78 offen offset:3072 lds
  v_mfma_f32_16x16x32_bf16 v[8:11], v[140:143], a[148:151], v[8:11]
  s_waitcnt lgkmcnt(5)
  v_mfma_f32_16x16x32_bf16 v[16:19], v[136:139], a[136:139], v[16:19]
L_pgQ1:
  s_cbranch_execz L_pgQ5
  s_add_u32 m0, s76, 32768
  ds_read_b64_tr_b16 v[128:129], v172 offset:8192
  v_mfma_f32_16x16x32_bf16 v[16:19], v[140:143], a[152:155], v[16:19]
  v_mfma_f32_16x16x32_bf16 v[24:27], v[136:139], a[140:143], v[24:27]
  ds_read_b64_tr_b16 v[130:131], v172 offset:8704
  buffer_load_dwordx4 v168, s[32:35], s79 offen offset:0 lds
  v_mfma_f32_16x16x32_bf16 v[24:27], v[140:143], a[156:159], v[24:27]
  s_waitcnt lgkmcnt(2)
  v_mfma_f32_16x16x32_bf16 v[4:7], v[112:115], a[128:131], v[4:7]
  ds_read_b64_tr_b16 v[132:133], v172 offset:12288
  v_mfma_f32_16x16x32_bf16 v[4:7], v[116:119], a[144:147], v[4:7]
  v_mfma_f32_16x16x32_bf16 v[12:15], v[112:115], a[132:135], v[12:15]
  ds_read_b64_tr_b16 v[134:135], v172 offset:12800
  v_mfma_f32_16x16x32_bf16 v[12:15], v[116:119], a[148:151], v[12:15]
  buffer_load_dwordx4 v169, s[32:35], s79 offen offset:1024 lds
  v_mfma_f32_16x16x32_bf16 v[20:23], v[112:115], a[136:139], v[20:23]
  ds_read_b64_tr_b16 v[136:137], v173 offset:8192
  v_mfma_f32_16x16x32_bf16 v[20:23], v[116:119], a[152:155], v[20:23]
  v_mfma_f32_16x16x32_bf16 v[28:31], v[112:115], a[140:143], v[28:31]
  ds_read_b64_tr_b16 v[138:139], v173 offset:8704
  v_mfma_f32_16x16x32_bf16 v[28:31], v[116:119], a[156:159], v[28:31]
  s_waitcnt lgkmcnt(2)
  buffer_load_dwordx4 v170, s[32:35], s79 offen offset:2048 lds
  v_mfma_f32_16x16x32_bf16 v[216:219], v[96:99], a[128:131], v[216:219]
  v_mfma_f32_16x16x32_bf16 v[216:219], v[100:103], a[144:147], v[216:219]
  v_mfma_f32_16x16x32_bf16 v[32:35], v[128:131], a[128:131], v[32:35]
  ds_read_b64_tr_b16 v[140:141], v173 offset:12288
  v_mfma_f32_16x16x32_bf16 v[32:35], v[132:135], a[144:147], v[32:35]
  v_mfma_f32_16x16x32_bf16 v[40:43], v[128:131], a[132:135], v[40:43]
  ds_read_b64_tr_b16 v[142:143], v173 offset:12800
  buffer_load_dwordx4 v171, s[32:35], s79 offen offset:3072 lds
  v_mfma_f32_16x16x32_bf16 v[40:43], v[132:135], a[148:151], v[40:43]
  v_mfma_f32_16x16x32_bf16 v[48:51], v[128:131], a[136:139], v[48:51]
  s_waitcnt vmcnt(8)
  s_barrier
  ds_read_b64_tr_b16 v[112:113], v172 offset:16384
  v_mfma_f32_16x16x32_bf16 v[48:51], v[132:135], a[152:155], v[48:51]
  s_lshl_b32 s78, s71, 7
  ds_read_b128 a[160:163], v160 offset:32768
  ds_read_b128 a[176:179], v162 offset:32768
  s_add_u32 m0, s76, 81920
  v_mfma_f32_16x16x32_bf16 v[56:59], v[128:131], a[140:143], v[56:59]
  s_mul_i32 s79, s71, 229376
  ds_read_b64_tr_b16 v[114:115], v172 offset:16896
  buffer_load_dwordx4 v164, s[28:31], s78 offen offset:0 lds
  v_mfma_f32_16x16x32_bf16 v[56:59], v[132:135], a[156:159], v[56:59]
  s_waitcnt lgkmcnt(4)
  ds_read_b128 a[164:167], v160 offset:34816
  ds_read_b128 a[180:183], v162 offset:34816
  v_mfma_f32_16x16x32_bf16 v[36:39], v[136:139], a[128:131], v[36:39]
  ds_read_b64_tr_b16 v[116:117], v172 offset:20480
  v_mfma_f32_16x16x32_bf16 v[36:39], v[140:143], a[144:147], v[36:39]
  ds_read_b128 a[168:171], v161 offset:32768
  v_mfma_f32_16x16x32_bf16 v[44:47], v[136:139], a[132:135], v[44:47]
  ds_read_b64_tr_b16 v[118:119], v172 offset:20992
  buffer_load_dwordx4 v165, s[28:31], s78 offen offset:1024 lds
  v_mfma_f32_16x16x32_bf16 v[44:47], v[140:143], a[148:151], v[44:47]
  ds_read_b128 a[184:187], v163 offset:32768
  v_mfma_f32_16x16x32_bf16 v[52:55], v[136:139], a[136:139], v[52:55]
  ds_read_b64_tr_b16 v[128:129], v173 offset:16384
  v_mfma_f32_16x16x32_bf16 v[52:55], v[140:143], a[152:155], v[52:55]
  ds_read_b128 a[172:175], v161 offset:34816
  ds_read_b128 a[188:191], v163 offset:34816
  v_mfma_f32_16x16x32_bf16 v[60:63], v[136:139], a[140:143], v[60:63]
  ds_read_b64_tr_b16 v[130:131], v173 offset:16896
  buffer_load_dwordx4 v166, s[28:31], s78 offen offset:2048 lds
  v_mfma_f32_16x16x32_bf16 v[60:63], v[140:143], a[156:159], v[60:63]
  s_waitcnt lgkmcnt(5)
  v_mfma_f32_16x16x32_bf16 v[220:223], v[96:99], a[132:135], v[220:223]
  v_mfma_f32_16x16x32_bf16 v[220:223], v[100:103], a[148:151], v[220:223]
  v_mfma_f32_16x16x32_bf16 v[0:3], v[112:115], a[160:163], v[0:3]
  ds_read_b64_tr_b16 v[132:133], v173 offset:20480
  v_mfma_f32_16x16x32_bf16 v[0:3], v[116:119], a[176:179], v[0:3]
  ds_read_b128 v[104:107], v174 offset:640
  ds_read_b128 v[108:111], v174 offset:704
  v_mfma_f32_16x16x32_bf16 v[8:11], v[112:115], a[164:167], v[8:11]
  ds_read_b64_tr_b16 v[134:135], v173 offset:20992
  buffer_load_dwordx4 v167, s[28:31], s78 offen offset:3072 lds
  v_mfma_f32_16x16x32_bf16 v[8:11], v[116:119], a[180:183], v[8:11]
  s_waitcnt lgkmcnt(5)
  v_mfma_f32_16x16x32_bf16 v[16:19], v[112:115], a[168:171], v[16:19]
  s_add_u32 m0, s76, 49152
  ds_read_b64_tr_b16 v[136:137], v172 offset:24576
  v_mfma_f32_16x16x32_bf16 v[16:19], v[116:119], a[184:187], v[16:19]
  v_mfma_f32_16x16x32_bf16 v[24:27], v[112:115], a[172:175], v[24:27]
  ds_read_b64_tr_b16 v[138:139], v172 offset:25088
  buffer_load_dwordx4 v168, s[32:35], s79 offen offset:0 lds
  v_mfma_f32_16x16x32_bf16 v[24:27], v[116:119], a[188:191], v[24:27]
  s_waitcnt lgkmcnt(2)
  v_mov_b32 v168, v92
  v_mfma_f32_16x16x32_bf16 v[4:7], v[128:131], a[160:163], v[4:7]
  ds_read_b64_tr_b16 v[140:141], v172 offset:28672
  v_mfma_f32_16x16x32_bf16 v[4:7], v[132:135], a[176:179], v[4:7]
  v_mfma_f32_16x16x32_bf16 v[12:15], v[128:131], a[164:167], v[12:15]
  ds_read_b64_tr_b16 v[142:143], v172 offset:29184
  buffer_load_dwordx4 v169, s[32:35], s79 offen offset:1024 lds
  v_mfma_f32_16x16x32_bf16 v[12:15], v[132:135], a[180:183], v[12:15]
  v_mov_b32 v169, v93
  v_mfma_f32_16x16x32_bf16 v[20:23], v[128:131], a[168:171], v[20:23]
  ds_read_b64_tr_b16 v[112:113], v173 offset:24576
  v_mfma_f32_16x16x32_bf16 v[20:23], v[132:135], a[184:187], v[20:23]
  v_mfma_f32_16x16x32_bf16 v[28:31], v[128:131], a[172:175], v[28:31]
  ds_read_b64_tr_b16 v[114:115], v173 offset:25088
  buffer_load_dwordx4 v170, s[32:35], s79 offen offset:2048 lds
  v_mfma_f32_16x16x32_bf16 v[28:31], v[132:135], a[188:191], v[28:31]
  s_waitcnt lgkmcnt(2)
  v_mov_b32 v170, v94
  v_mfma_f32_16x16x32_bf16 v[216:219], v[104:107], a[160:163], v[216:219]
  v_mfma_f32_16x16x32_bf16 v[216:219], v[108:111], a[176:179], v[216:219]
  v_mfma_f32_16x16x32_bf16 v[32:35], v[136:139], a[160:163], v[32:35]
  ds_read_b64_tr_b16 v[116:117], v173 offset:28672
  v_mfma_f32_16x16x32_bf16 v[32:35], v[140:143], a[176:179], v[32:35]
  buffer_load_dwordx4 v171, s[32:35], s79 offen offset:3072 lds
  v_mov_b32 v171, v95
  v_mfma_f32_16x16x32_bf16 v[40:43], v[136:139], a[164:167], v[40:43]
  s_mov_b64 s[32:33], s[84:85]
  ds_read_b64_tr_b16 v[118:119], v173 offset:29184
  s_mul_i32 s79, s72, 196608
  v_mfma_f32_16x16x32_bf16 v[40:43], v[140:143], a[180:183], v[40:43]
  s_mov_b32 s34, s86
  v_mfma_f32_16x16x32_bf16 v[48:51], v[136:139], a[168:171], v[48:51]
  s_waitcnt vmcnt(8)
  s_barrier
  ds_read_b64_tr_b16 v[128:129], v172 offset:32768
  v_mfma_f32_16x16x32_bf16 v[48:51], v[140:143], a[184:187], v[48:51]
  s_add_u32 m0, s76, 0
  ds_read_b128 a[192:195], v160 offset:0
  ds_read_b128 a[208:211], v162 offset:0
  buffer_load_dwordx4 v168, s[32:35], s79 offen offset:0 lds
  v_mfma_f32_16x16x32_bf16 v[56:59], v[136:139], a[172:175], v[56:59]
  ds_read_b64_tr_b16 v[130:131], v172 offset:33280
  v_lshrrev_b32 v165, 3, v175
  v_and_b32 v166, 6, v165
  v_lshlrev_b32 v165, 10, v165
  v_mfma_f32_16x16x32_bf16 v[56:59], v[140:143], a[188:191], v[56:59]
  s_waitcnt lgkmcnt(4)
  ds_read_b128 a[196:199], v160 offset:2048
  ds_read_b128 a[212:215], v162 offset:2048
  v_and_b32 v167, 7, v175
  v_xor_b32 v166, v166, v167
  v_mfma_f32_16x16x32_bf16 v[36:39], v[112:115], a[160:163], v[36:39]
  ds_read_b64_tr_b16 v[132:133], v172 offset:36864
  v_lshl_add_u32 v164, v166, 4, v165
  v_add_u32 v165, 7168, v164
  v_add_u32 v166, 14336, v164
  v_mfma_f32_16x16x32_bf16 v[36:39], v[116:119], a[176:179], v[36:39]
  s_add_u32 s78, s90, 786432
  ds_read_b128 a[200:203], v161 offset:0
  buffer_load_dwordx4 v169, s[32:35], s79 offen offset:1024 lds
  v_add_u32 v167, 21504, v164
  v_mfma_f32_16x16x32_bf16 v[44:47], v[112:115], a[164:167], v[44:47]
  ds_read_b64_tr_b16 v[134:135], v172 offset:37376
  v_mfma_f32_16x16x32_bf16 v[44:47], v[116:119], a[180:183], v[44:47]
  ds_read_b128 a[216:219], v163 offset:0
  v_mfma_f32_16x16x32_bf16 v[52:55], v[112:115], a[168:171], v[52:55]
  ds_read_b64_tr_b16 v[136:137], v173 offset:32768
  v_mfma_f32_16x16x32_bf16 v[52:55], v[116:119], a[184:187], v[52:55]
  ds_read_b128 a[204:207], v161 offset:2048
  ds_read_b128 a[220:223], v163 offset:2048
  buffer_load_dwordx4 v170, s[32:35], s79 offen offset:2048 lds
  v_mfma_f32_16x16x32_bf16 v[60:63], v[112:115], a[172:175], v[60:63]
  ds_read_b64_tr_b16 v[138:139], v173 offset:33280
  v_mfma_f32_16x16x32_bf16 v[60:63], v[116:119], a[188:191], v[60:63]
  s_waitcnt lgkmcnt(5)
  v_mfma_f32_16x16x32_bf16 v[220:223], v[104:107], a[164:167], v[220:223]
  v_mfma_f32_16x16x32_bf16 v[220:223], v[108:111], a[180:183], v[220:223]
  buffer_load_dwordx4 v171, s[32:35], s79 offen offset:3072 lds
  v_mfma_f32_16x16x32_bf16 v[0:3], v[128:131], a[192:195], v[0:3]
  s_mul_i32 s79, s73, 196608
  ds_read_b64_tr_b16 v[140:141], v173 offset:36864
  v_mfma_f32_16x16x32_bf16 v[0:3], v[132:135], a[208:211], v[0:3]
  s_add_u32 m0, s77, 131072
  ds_read_b128 v[96:99], v174 offset:768
  ds_read_b128 v[100:103], v174 offset:832
  v_mfma_f32_16x16x32_bf16 v[8:11], v[128:131], a[196:199], v[8:11]
  ds_read_b64_tr_b16 v[142:143], v173 offset:37376
  v_mfma_f32_16x16x32_bf16 v[8:11], v[132:135], a[212:215], v[8:11]
  s_waitcnt lgkmcnt(5)
  buffer_load_dword v176, off, s[52:55], 0 sc1
  v_mfma_f32_16x16x32_bf16 v[16:19], v[128:131], a[200:203], v[16:19]
  ds_read_b64_tr_b16 v[112:113], v172 offset:40960
  v_mfma_f32_16x16x32_bf16 v[16:19], v[132:135], a[216:219], v[16:19]
  buffer_load_dwordx4 v164, s[40:43], s78 offen offset:0 lds
  v_mfma_f32_16x16x32_bf16 v[24:27], v[128:131], a[204:207], v[24:27]
  ds_read_b64_tr_b16 v[114:115], v172 offset:41472
  v_mfma_f32_16x16x32_bf16 v[24:27], v[132:135], a[220:223], v[24:27]
  s_waitcnt lgkmcnt(2)
  v_mfma_f32_16x16x32_bf16 v[4:7], v[136:139], a[192:195], v[4:7]
  ds_read_b64_tr_b16 v[116:117], v172 offset:45056
  v_mfma_f32_16x16x32_bf16 v[4:7], v[140:143], a[208:211], v[4:7]
  buffer_load_dwordx4 v165, s[40:43], s78 offen offset:1024 lds
  v_mfma_f32_16x16x32_bf16 v[12:15], v[136:139], a[196:199], v[12:15]
  ds_read_b64_tr_b16 v[118:119], v172 offset:45568
  v_mfma_f32_16x16x32_bf16 v[12:15], v[140:143], a[212:215], v[12:15]
  v_mfma_f32_16x16x32_bf16 v[20:23], v[136:139], a[200:203], v[20:23]
  ds_read_b64_tr_b16 v[128:129], v173 offset:40960
  v_mfma_f32_16x16x32_bf16 v[20:23], v[140:143], a[216:219], v[20:23]
  buffer_load_dwordx4 v166, s[40:43], s78 offen offset:2048 lds
  v_mfma_f32_16x16x32_bf16 v[28:31], v[136:139], a[204:207], v[28:31]
  ds_read_b64_tr_b16 v[130:131], v173 offset:41472
  v_mfma_f32_16x16x32_bf16 v[28:31], v[140:143], a[220:223], v[28:31]
  s_waitcnt lgkmcnt(2)
  v_mfma_f32_16x16x32_bf16 v[216:219], v[96:99], a[192:195], v[216:219]
  v_mfma_f32_16x16x32_bf16 v[216:219], v[100:103], a[208:211], v[216:219]
  buffer_load_dwordx4 v167, s[40:43], s78 offen offset:3072 lds
  v_mfma_f32_16x16x32_bf16 v[32:35], v[112:115], a[192:195], v[32:35]
  ds_read_b64_tr_b16 v[132:133], v173 offset:45056
  v_mfma_f32_16x16x32_bf16 v[32:35], v[116:119], a[208:211], v[32:35]
  v_mfma_f32_16x16x32_bf16 v[40:43], v[112:115], a[196:199], v[40:43]
  ds_read_b64_tr_b16 v[134:135], v173 offset:45568
  v_mfma_f32_16x16x32_bf16 v[40:43], v[116:119], a[212:215], v[40:43]
  global_load_dword v199, v89, s[18:19]
  v_mfma_f32_16x16x32_bf16 v[48:51], v[112:115], a[200:203], v[48:51]
  s_waitcnt vmcnt(10)
  s_barrier
  ds_read_b64_tr_b16 v[136:137], v172 offset:49152
  v_mfma_f32_16x16x32_bf16 v[48:51], v[116:119], a[216:219], v[48:51]
  s_add_u32 m0, s76, 16384
  ds_read_b128 a[224:227], v160 offset:16384
  ds_read_b128 a[240:243], v162 offset:16384
  v_mfma_f32_16x16x32_bf16 v[56:59], v[112:115], a[204:207], v[56:59]
  ds_read_b64_tr_b16 v[138:139], v172 offset:49664
  buffer_load_dwordx4 v168, s[32:35], s79 offen offset:0 lds
  v_mfma_f32_16x16x32_bf16 v[56:59], v[116:119], a[220:223], v[56:59]
  s_waitcnt lgkmcnt(4)
  ds_read_b128 a[228:231], v160 offset:18432
  ds_read_b128 a[244:247], v162 offset:18432
  v_mfma_f32_16x16x32_bf16 v[36:39], v[128:131], a[192:195], v[36:39]
  ds_read_b64_tr_b16 v[140:141], v172 offset:53248
  v_mfma_f32_16x16x32_bf16 v[36:39], v[132:135], a[208:211], v[36:39]
  ds_read_b128 a[232:235], v161 offset:16384
  v_mfma_f32_16x16x32_bf16 v[44:47], v[128:131], a[196:199], v[44:47]
  ds_read_b64_tr_b16 v[142:143], v172 offset:53760
  v_mfma_f32_16x16x32_bf16 v[44:47], v[132:135], a[212:215], v[44:47]
  ds_read_b128 a[248:251], v163 offset:16384
  buffer_load_dwordx4 v169, s[32:35], s79 offen offset:1024 lds
  v_mfma_f32_16x16x32_bf16 v[52:55], v[128:131], a[200:203], v[52:55]
  ds_read_b64_tr_b16 v[112:113], v173 offset:49152
  v_mfma_f32_16x16x32_bf16 v[52:55], v[132:135], a[216:219], v[52:55]
  ds_read_b128 a[236:239], v161 offset:18432
  ds_read_b128 a[252:255], v163 offset:18432
  v_mfma_f32_16x16x32_bf16 v[60:63], v[128:131], a[204:207], v[60:63]
  ds_read_b64_tr_b16 v[114:115], v173 offset:49664
  v_mfma_f32_16x16x32_bf16 v[60:63], v[132:135], a[220:223], v[60:63]
  s_waitcnt lgkmcnt(5)
  buffer_load_dwordx4 v170, s[32:35], s79 offen offset:2048 lds
  v_mfma_f32_16x16x32_bf16 v[220:223], v[96:99], a[196:199], v[220:223]
  v_mfma_f32_16x16x32_bf16 v[220:223], v[100:103], a[212:215], v[220:223]
  v_mfma_f32_16x16x32_bf16 v[0:3], v[136:139], a[224:227], v[0:3]
  ds_read_b64_tr_b16 v[116:117], v173 offset:53248
  v_mfma_f32_16x16x32_bf16 v[0:3], v[140:143], a[240:243], v[0:3]
  ds_read_b128 v[104:107], v174 offset:896
  ds_read_b128 v[108:111], v174 offset:960
  v_mfma_f32_16x16x32_bf16 v[8:11], v[136:139], a[228:231], v[8:11]
  ds_read_b64_tr_b16 v[118:119], v173 offset:53760
  buffer_load_dwordx4 v171, s[32:35], s79 offen offset:3072 lds
  v_mfma_f32_16x16x32_bf16 v[8:11], v[140:143], a[244:247], v[8:11]
  s_waitcnt lgkmcnt(5)
  v_mfma_f32_16x16x32_bf16 v[16:19], v[136:139], a[232:235], v[16:19]
  s_mul_i32 s79, s74, 196608
  ds_read_b64_tr_b16 v[128:129], v172 offset:57344
  v_add_u32 v160, 0xffff0000, v200
  v_mfma_f32_16x16x32_bf16 v[16:19], v[140:143], a[248:251], v[16:19]
  v_add_u32 v161, 0xffff0000, v201
  v_add_u32 v162, 0xffff0000, v202
  v_mfma_f32_16x16x32_bf16 v[24:27], v[136:139], a[236:239], v[24:27]
  ds_read_b64_tr_b16 v[130:131], v172 offset:57856
  v_add_u32 v163, 0xffff0000, v203
  v_mfma_f32_16x16x32_bf16 v[24:27], v[140:143], a[252:255], v[24:27]
  s_waitcnt lgkmcnt(2)
  v_mfma_f32_16x16x32_bf16 v[4:7], v[112:115], a[224:227], v[4:7]
  ds_read_b64_tr_b16 v[132:133], v172 offset:61440
  v_mfma_f32_16x16x32_bf16 v[4:7], v[116:119], a[240:243], v[4:7]
  v_mfma_f32_16x16x32_bf16 v[12:15], v[112:115], a[228:231], v[12:15]
  ds_read_b64_tr_b16 v[134:135], v172 offset:61952
  v_mfma_f32_16x16x32_bf16 v[12:15], v[116:119], a[244:247], v[12:15]
  v_mfma_f32_16x16x32_bf16 v[20:23], v[112:115], a[232:235], v[20:23]
  ds_read_b64_tr_b16 v[136:137], v173 offset:57344
  v_mfma_f32_16x16x32_bf16 v[20:23], v[116:119], a[248:251], v[20:23]
  v_mfma_f32_16x16x32_bf16 v[28:31], v[112:115], a[236:239], v[28:31]
  ds_read_b64_tr_b16 v[138:139], v173 offset:57856
  v_mfma_f32_16x16x32_bf16 v[28:31], v[116:119], a[252:255], v[28:31]
  s_waitcnt lgkmcnt(2)
  v_mfma_f32_16x16x32_bf16 v[216:219], v[104:107], a[224:227], v[216:219]
  v_mfma_f32_16x16x32_bf16 v[216:219], v[108:111], a[240:243], v[216:219]
  v_mfma_f32_16x16x32_bf16 v[32:35], v[128:131], a[224:227], v[32:35]
  ds_read_b64_tr_b16 v[140:141], v173 offset:61440
  v_mfma_f32_16x16x32_bf16 v[32:35], v[132:135], a[240:243], v[32:35]
  v_mfma_f32_16x16x32_bf16 v[40:43], v[128:131], a[228:231], v[40:43]
  ds_read_b64_tr_b16 v[142:143], v173 offset:61952
  v_mfma_f32_16x16x32_bf16 v[40:43], v[132:135], a[244:247], v[40:43]
  v_mfma_f32_16x16x32_bf16 v[48:51], v[128:131], a[232:235], v[48:51]
  s_waitcnt vmcnt(10)
  s_barrier
  ds_read_b64_tr_b16 v[112:113], v172 offset:0
  v_mfma_f32_16x16x32_bf16 v[48:51], v[132:135], a[248:251], v[48:51]
  s_add_u32 m0, s76, 32768
  s_nop 0
  buffer_load_dwordx4 v168, s[32:35], s79 offen offset:0 lds
  v_mfma_f32_16x16x32_bf16 v[56:59], v[128:131], a[236:239], v[56:59]
  ds_read_b64_tr_b16 v[114:115], v172 offset:512
  v_mfma_f32_16x16x32_bf16 v[56:59], v[132:135], a[252:255], v[56:59]
  s_waitcnt lgkmcnt(2)
  v_mfma_f32_16x16x32_bf16 v[36:39], v[136:139], a[224:227], v[36:39]
  ds_read_b64_tr_b16 v[116:117], v172 offset:4096
  s_waitcnt vmcnt(10)
  v_cmp_eq_u32 vcc, 0, v176
  s_cbranch_vccnz L_slow6
L_ret6:
  v_mfma_f32_16x16x32_bf16 v[36:39], v[140:143], a[240:243], v[36:39]
  buffer_load_dwordx4 v169, s[32:35], s79 offen offset:1024 lds
  v_mfma_f32_16x16x32_bf16 v[44:47], v[136:139], a[228:231], v[44:47]
  ds_read_b64_tr_b16 v[118:119], v172 offset:4608
  v_mfma_f32_16x16x32_bf16 v[44:47], v[140:143], a[244:247], v[44:47]
  v_mfma_f32_16x16x32_bf16 v[52:55], v[136:139], a[232:235], v[52:55]
  ds_read_b64_tr_b16 v[128:129], v173 offset:0
  v_mfma_f32_16x16x32_bf16 v[52:55], v[140:143], a[248:251], v[52:55]
  v_mfma_f32_16x16x32_bf16 v[60:63], v[136:139], a[236:239], v[60:63]
  ds_read_b64_tr_b16 v[130:131], v173 offset:512
  v_mfma_f32_16x16x32_bf16 v[60:63], v[140:143], a[252:255], v[60:63]
  s_waitcnt lgkmcnt(2)
  v_mfma_f32_16x16x32_bf16 v[220:223], v[104:107], a[228:231], v[220:223]
  v_mfma_f32_16x16x32_bf16 v[220:223], v[108:111], a[244:247], v[220:223]
  buffer_load_dwordx4 v170, s[32:35], s79 offen offset:2048 lds
  v_pk_mul_f32 v[208:209], v[0:1], v[0:1]
  v_pk_mul_f32 v[210:211], v[2:3], v[2:3]
  v_pk_mul_f32 v[212:213], v[4:5], v[4:5]
  v_pk_mul_f32 v[214:215], v[6:7], v[6:7]
  v_pk_fma_f32 v[208:209], v[208:209], s[24:25], v[206:207] op_sel_hi:[1,0,0]
  v_pk_fma_f32 v[210:211], v[210:211], s[24:25], v[206:207] op_sel_hi:[1,0,0]
  v_pk_fma_f32 v[212:213], v[212:213], s[24:25], v[206:207] op_sel_hi:[1,0,0]
  v_pk_fma_f32 v[214:215], v[214:215], s[24:25], v[206:207] op_sel_hi:[1,0,0]
  v_pk_mul_f32 v[208:209], v[208:209], v[0:1]
  v_pk_mul_f32 v[210:211], v[210:211], v[2:3]
  v_pk_mul_f32 v[212:213], v[212:213], v[4:5]
  v_pk_mul_f32 v[214:215], v[214:215], v[6:7]
  v_mul_f32 v184, v207, v216
  v_mul_f32 v185, v207, v220
  v_exp_f32 v192, -v184
  v_exp_f32 v193, -v185
  v_exp_f32 v184, v184
  v_exp_f32 v185, v185
  buffer_load_dwordx4 v171, s[32:35], s79 offen offset:3072 lds
  v_add_f32 v192, 1.0, v192
  v_add_f32 v193, 1.0, v193
  v_add_f32 v184, 1.0, v184
  v_add_f32 v185, 1.0, v185
  v_rcp_f32 v192, v192
  v_rcp_f32 v193, v193
  v_min_f32 v184, 0x71800000, v184
  v_min_f32 v185, 0x71800000, v185
  ds_write2_b32 v225, v216, v220 offset1:1
  v_xor_b32 v225, 512, v225
  v_exp_f32 v208, v208
  v_exp_f32 v209, v209
  v_exp_f32 v210, v210
  v_exp_f32 v211, v211
  v_exp_f32 v212, v212
  v_exp_f32 v213, v213
  v_exp_f32 v214, v214
  s_add_u32 s78, s90, 819200
  s_add_u32 m0, s77, 135168
  s_nop 0
  buffer_load_dwordx4 v164, s[40:43], s78 offen offset:0 lds
  v_exp_f32 v215, v215
  v_pk_mul_f32 v[32:33], v[0:1], v[32:33]
  v_pk_mul_f32 v[34:35], v[2:3], v[34:35]
  v_pk_mul_f32 v[36:37], v[4:5], v[36:37]
  v_pk_mul_f32 v[38:39], v[6:7], v[38:39]
  v_pk_fma_f32 v[208:209], v[208:209], v[184:185], v[184:185] op_sel_hi:[1,0,0]
  v_pk_fma_f32 v[210:211], v[210:211], v[184:185], v[184:185] op_sel_hi:[1,0,0]
  v_pk_fma_f32 v[212:213], v[212:213], v[184:185], v[184:185] op_sel_hi:[1,0,0]
  v_pk_fma_f32 v[214:215], v[214:215], v[184:185], v[184:185] op_sel_hi:[1,0,0]
  v_rcp_f32 v208, v208
  v_rcp_f32 v209, v209
  v_rcp_f32 v210, v210
  v_rcp_f32 v211, v211
  v_rcp_f32 v212, v212
  v_rcp_f32 v213, v213
  v_rcp_f32 v214, v214
  v_rcp_f32 v215, v215
  buffer_load_dwordx4 v165, s[40:43], s78 offen offset:1024 lds
  v_pk_mul_f32 v[32:33], v[32:33], v[208:209]
  v_pk_mul_f32 v[34:35], v[34:35], v[210:211]
  v_pk_mul_f32 v[36:37], v[36:37], v[212:213]
  v_pk_mul_f32 v[38:39], v[38:39], v[214:215]
  v_cvt_pk_bf16_f32 v144, v32, v33
  v_cvt_pk_bf16_f32 v145, v34, v35
  v_cvt_pk_bf16_f32 v146, v36, v37
  v_cvt_pk_bf16_f32 v147, v38, v39
  v_pk_mul_f32 v[208:209], v[8:9], v[8:9]
  v_pk_mul_f32 v[210:211], v[10:11], v[10:11]
  v_pk_mul_f32 v[212:213], v[12:13], v[12:13]
  v_pk_mul_f32 v[214:215], v[14:15], v[14:15]
  v_pk_fma_f32 v[208:209], v[208:209], s[24:25], v[206:207] op_sel_hi:[1,0,0]
  v_pk_fma_f32 v[210:211], v[210:211], s[24:25], v[206:207] op_sel_hi:[1,0,0]
  v_pk_fma_f32 v[212:213], v[212:213], s[24:25], v[206:207] op_sel_hi:[1,0,0]
  v_pk_fma_f32 v[214:215], v[214:215], s[24:25], v[206:207] op_sel_hi:[1,0,0]
  v_pk_mul_f32 v[208:209], v[208:209], v[8:9]
  buffer_load_dwordx4 v166, s[40:43], s78 offen offset:2048 lds
  v_pk_mul_f32 v[210:211], v[210:211], v[10:11]
  v_pk_mul_f32 v[212:213], v[212:213], v[12:13]
  v_pk_mul_f32 v[214:215], v[214:215], v[14:15]
  v_exp_f32 v208, v208
  v_exp_f32 v209, v209
  v_exp_f32 v210, v210
  v_exp_f32 v211, v211
  v_exp_f32 v212, v212
  v_exp_f32 v213, v213
  v_exp_f32 v214, v214
  v_exp_f32 v215, v215
  v_pk_mul_f32 v[40:41], v[8:9], v[40:41]
  v_pk_mul_f32 v[42:43], v[10:11], v[42:43]
  v_pk_mul_f32 v[44:45], v[12:13], v[44:45]
  v_pk_mul_f32 v[46:47], v[14:15], v[46:47]
  v_pk_fma_f32 v[208:209], v[208:209], v[184:185], v[184:185] op_sel:[0,1,1] op_sel_hi:[1,1,1]
  v_pk_fma_f32 v[210:211], v[210:211], v[184:185], v[184:185] op_sel:[0,1,1] op_sel_hi:[1,1,1]
  buffer_load_dwordx4 v167, s[40:43], s78 offen offset:3072 lds
  v_pk_fma_f32 v[212:213], v[212:213], v[184:185], v[184:185] op_sel:[0,1,1] op_sel_hi:[1,1,1]
  v_pk_fma_f32 v[214:215], v[214:215], v[184:185], v[184:185] op_sel:[0,1,1] op_sel_hi:[1,1,1]
  v_rcp_f32 v208, v208
  v_rcp_f32 v209, v209
  v_rcp_f32 v210, v210
  v_rcp_f32 v211, v211
  v_rcp_f32 v212, v212
  v_rcp_f32 v213, v213
  v_rcp_f32 v214, v214
  v_rcp_f32 v215, v215
  v_pk_mul_f32 v[40:41], v[40:41], v[208:209]
  v_pk_mul_f32 v[42:43], v[42:43], v[210:211]
  v_pk_mul_f32 v[44:45], v[44:45], v[212:213]
  v_pk_mul_f32 v[46:47], v[46:47], v[214:215]
  v_cvt_pk_bf16_f32 v148, v40, v41
  v_cvt_pk_bf16_f32 v149, v42, v43
  v_cvt_pk_bf16_f32 v150, v44, v45
  v_cvt_pk_bf16_f32 v151, v46, v47
  v_mfma_f32_16x16x32_bf16 v[64:67], v[112:115], a[0:3], 0
  s_mul_i32 s79, s75, 196608
  ds_read_b64_tr_b16 v[132:133], v173 offset:4096
  v_mul_f32 v208, v16, v16
  v_mfma_f32_16x16x32_bf16 v[64:67], v[116:119], a[16:19], v[64:67]
  v_mul_f32 v209, v17, v17
  v_mul_f32 v210, v18, v18
  v_mfma_f32_16x16x32_bf16 v[72:75], v[112:115], a[4:7], 0
  ds_read_b64_tr_b16 v[134:135], v173 offset:4608
  v_mul_f32 v211, v19, v19
  v_mul_f32 v212, v20, v20
  v_mfma_f32_16x16x32_bf16 v[72:75], v[116:119], a[20:23], v[72:75]
  v_mul_f32 v213, v21, v21
  v_mul_f32 v214, v22, v22
  v_mfma_f32_16x16x32_bf16 v[80:83], v[112:115], a[8:11], 0
  ds_read_b64_tr_b16 v[136:137], v172 offset:8192
  v_mul_f32 v215, v23, v23
  v_mfma_f32_16x16x32_bf16 v[80:83], v[116:119], a[24:27], v[80:83]
  v_fmamk_f32 v208, v208, 0xbdd2d3e8, v206
  v_fmamk_f32 v209, v209, 0xbdd2d3e8, v206
  v_fmamk_f32 v210, v210, 0xbdd2d3e8, v206
  v_mfma_f32_16x16x32_bf16 v[88:91], v[112:115], a[12:15], 0
  ds_read_b64_tr_b16 v[138:139], v172 offset:8704
  v_fmamk_f32 v211, v211, 0xbdd2d3e8, v206
  v_mfma_f32_16x16x32_bf16 v[88:91], v[116:119], a[28:31], v[88:91]
  s_waitcnt lgkmcnt(2)
  v_fmamk_f32 v212, v212, 0xbdd2d3e8, v206
  v_fmamk_f32 v213, v213, 0xbdd2d3e8, v206
  v_fmamk_f32 v214, v214, 0xbdd2d3e8, v206
  v_mfma_f32_16x16x32_bf16 v[68:71], v[128:131], a[0:3], 0
  ds_read_b64_tr_b16 v[140:141], v172 offset:12288
  v_fmamk_f32 v215, v215, 0xbdd2d3e8, v206
  v_mfma_f32_16x16x32_bf16 v[68:71], v[132:135], a[16:19], v[68:71]
  v_mul_f32 v208, v208, v16
  v_mul_f32 v209, v209, v17
  v_mfma_f32_16x16x32_bf16 v[76:79], v[128:131], a[4:7], 0
  ds_read_b64_tr_b16 v[142:143], v172 offset:12800
  v_exp_f32 v208, v208
  v_mfma_f32_16x16x32_bf16 v[76:79], v[132:135], a[20:23], v[76:79]
  v_exp_f32 v209, v209
  v_mfma_f32_16x16x32_bf16 v[84:87], v[128:131], a[8:11], 0
  ds_read_b64_tr_b16 v[112:113], v173 offset:8192
  v_mul_f32 v210, v210, v18
  v_mfma_f32_16x16x32_bf16 v[84:87], v[132:135], a[24:27], v[84:87]
  v_exp_f32 v210, v210
  v_mul_f32 v211, v211, v19
  v_mfma_f32_16x16x32_bf16 v[92:95], v[128:131], a[12:15], 0
  ds_read_b64_tr_b16 v[114:115], v173 offset:8704
  v_mul_f32 v212, v212, v20
  v_mfma_f32_16x16x32_bf16 v[92:95], v[132:135], a[28:31], v[92:95]
  s_waitcnt lgkmcnt(2)
  v_exp_f32 v211, v211
  v_mul_f32 v213, v213, v21
  v_mfma_f32_16x16x32_bf16 v[64:67], v[136:139], a[32:35], v[64:67]
  ds_read_b64_tr_b16 v[116:117], v173 offset:12288
  v_mul_f32 v214, v214, v22
  v_mfma_f32_16x16x32_bf16 v[64:67], v[140:143], a[48:51], v[64:67]
  v_exp_f32 v212, v212
  v_mfma_f32_16x16x32_bf16 v[72:75], v[136:139], a[36:39], v[72:75]
  ds_read_b64_tr_b16 v[118:119], v173 offset:12800
  v_exp_f32 v213, v213
  v_mfma_f32_16x16x32_bf16 v[72:75], v[140:143], a[52:55], v[72:75]
  v_exp_f32 v214, v214
  v_mfma_f32_16x16x32_bf16 v[80:83], v[136:139], a[40:43], v[80:83]
  s_waitcnt vmcnt(8)
  s_barrier
  ds_read_b64_tr_b16 v[128:129], v172 offset:16384
  v_mfma_f32_16x16x32_bf16 v[80:83], v[140:143], a[56:59], v[80:83]
  s_add_u32 m0, s76, 49152
  s_nop 0
  buffer_load_dwordx4 v168, s[32:35], s79 offen offset:0 lds
  v_mfma_f32_16x16x32_bf16 v[88:91], v[136:139], a[44:47], v[88:91]
  ds_read_b64_tr_b16 v[130:131], v172 offset:16896
  ds_read_b64 v[254:255], v225
  v_mfma_f32_16x16x32_bf16 v[88:91], v[140:143], a[60:63], v[88:91]
  s_waitcnt lgkmcnt(3)
  v_mul_f32 v215, v215, v23
  v_mul_f32 v48, v16, v48
  v_mfma_f32_16x16x32_bf16 v[68:71], v[112:115], a[32:35], v[68:71]
  ds_read_b64_tr_b16 v[132:133], v172 offset:20480
  v_mul_f32 v49, v17, v49
  v_mfma_f32_16x16x32_bf16 v[68:71], v[116:119], a[48:51], v[68:71]
  buffer_load_dwordx4 v169, s[32:35], s79 offen offset:1024 lds
  v_mfma_f32_16x16x32_bf16 v[76:79], v[112:115], a[36:39], v[76:79]
  ds_read_b64_tr_b16 v[134:135], v172 offset:20992
  v_lshrrev_b32 v169, 3, v175
  v_mul_f32 v50, v18, v50
  v_mfma_f32_16x16x32_bf16 v[76:79], v[116:119], a[52:55], v[76:79]
  v_exp_f32 v215, v215
  v_mfma_f32_16x16x32_bf16 v[84:87], v[112:115], a[40:43], v[84:87]
  ds_read_b64_tr_b16 v[136:137], v173 offset:16384
  s_waitcnt lgkmcnt(3)
  v_mul_f32 v186, v207, v254
  v_exp_f32 v194, -v186
  v_mfma_f32_16x16x32_bf16 v[84:87], v[116:119], a[56:59], v[84:87]
  buffer_load_dwordx4 v170, s[32:35], s79 offen offset:2048 lds
  v_mul_f32 v187, v207, v255
  v_mfma_f32_16x16x32_bf16 v[92:95], v[112:115], a[44:47], v[92:95]
  ds_read_b64_tr_b16 v[138:139], v173 offset:16896
  v_and_b32 v170, 2, v169
  v_add_f32 v194, 1.0, v194
  v_mfma_f32_16x16x32_bf16 v[92:95], v[116:119], a[60:63], v[92:95]
  s_waitcnt lgkmcnt(2)
  v_lshl_add_u32 v169, s60, 5, v169
  v_mul_u32_u24 v169, 3584, v169
  v_mfma_f32_16x16x32_bf16 v[64:67], v[128:131], a[64:67], v[64:67]
  ds_read_b64_tr_b16 v[140:141], v173 offset:20480
  v_exp_f32 v195, -v187
  v_mfma_f32_16x16x32_bf16 v[64:67], v[132:135], a[80:83], v[64:67]
  buffer_load_dwordx4 v171, s[32:35], s79 offen offset:3072 lds
  v_exp_f32 v186, v186
  v_mfma_f32_16x16x32_bf16 v[72:75], v[128:131], a[68:71], v[72:75]
  s_mov_b64 s[32:33], s[80:81]
  ds_read_b64_tr_b16 v[142:143], v173 offset:20992
  v_and_b32 v171, 7, v175
  v_add_f32 v195, 1.0, v195
  v_mfma_f32_16x16x32_bf16 v[72:75], v[132:135], a[84:87], v[72:75]
  s_mov_b32 s34, s82
  v_xor_b32 v170, v170, v171
  v_lshl_add_u32 v168, v170, 4, v169
  v_add_f32 v186, 1.0, v186
  v_mfma_f32_16x16x32_bf16 v[80:83], v[128:131], a[72:75], v[80:83]
  ds_read_b64_tr_b16 v[112:113], v172 offset:24576
  v_xor_b32 v169, 64, v168
  v_add_u32 v169, 27648, v169
  v_mfma_f32_16x16x32_bf16 v[80:83], v[132:135], a[88:91], v[80:83]
  s_mul_i32 s79, s64, 229376
  v_add_u32 v170, 55296, v168
  v_add_u32 v171, 55296, v169
  v_mfma_f32_16x16x32_bf16 v[88:91], v[128:131], a[76:79], v[88:91]
  s_add_u32 s78, s91, 786432
  ds_read_b64_tr_b16 v[114:115], v172 offset:25088
  s_add_u32 m0, s77, 65536
  v_min_f32 v186, 0x71800000, v186
  v_mfma_f32_16x16x32_bf16 v[88:91], v[132:135], a[92:95], v[88:91]
  s_waitcnt lgkmcnt(2)
  buffer_load_dwordx4 v164, s[40:43], s78 offen offset:0 lds
  v_mfma_f32_16x16x32_bf16 v[68:71], v[136:139], a[64:67], v[68:71]
  ds_read_b64_tr_b16 v[116:117], v172 offset:28672
  v_exp_f32 v187, v187
  v_mfma_f32_16x16x32_bf16 v[68:71], v[140:143], a[80:83], v[68:71]
  v_rcp_f32 v194, v194
  v_rcp_f32 v195, v195
  v_mfma_f32_16x16x32_bf16 v[76:79], v[136:139], a[68:71], v[76:79]
  ds_read_b64_tr_b16 v[118:119], v172 offset:29184
  v_add_f32 v187, 1.0, v187
  v_min_f32 v187, 0x71800000, v187
L_pgQ2:
  s_cbranch_execz L_back
  v_mfma_f32_16x16x32_bf16 v[76:79], v[140:143], a[84:87], v[76:79]
  buffer_load_dwordx4 v165, s[40:43], s78 offen offset:1024 lds
  v_mfma_f32_16x16x32_bf16 v[84:87], v[136:139], a[72:75], v[84:87]
  ds_read_b64_tr_b16 v[128:129], v173 offset:24576
  v_mfma_f32_16x16x32_bf16 v[84:87], v[140:143], a[88:91], v[84:87]
  v_mul_f32 v51, v19, v51
  v_mfma_f32_16x16x32_bf16 v[92:95], v[136:139], a[76:79], v[92:95]
  ds_read_b64_tr_b16 v[130:131], v173 offset:25088
  v_mfma_f32_16x16x32_bf16 v[92:95], v[140:143], a[92:95], v[92:95]
  s_waitcnt lgkmcnt(2)
  buffer_load_dwordx4 v166, s[40:43], s78 offen offset:2048 lds
  v_mfma_f32_16x16x32_bf16 v[64:67], v[112:115], a[96:99], v[64:67]
  ds_read_b64_tr_b16 v[132:133], v173 offset:28672
  v_mul_f32 v52, v20, v52
  v_mfma_f32_16x16x32_bf16 v[64:67], v[116:119], a[112:115], v[64:67]
  v_mul_f32 v53, v21, v53
  v_mul_f32 v54, v22, v54
  v_mfma_f32_16x16x32_bf16 v[72:75], v[112:115], a[100:103], v[72:75]
  ds_read_b64_tr_b16 v[134:135], v173 offset:29184
  v_mul_f32 v55, v23, v55
  v_fma_f32 v208, v208, v186, v186
  v_mfma_f32_16x16x32_bf16 v[72:75], v[116:119], a[116:119], v[72:75]
  buffer_load_dwordx4 v167, s[40:43], s78 offen offset:3072 lds
  v_mfma_f32_16x16x32_bf16 v[80:83], v[112:115], a[104:107], v[80:83]
  s_waitcnt vmcnt(12)
  s_barrier
  ds_read_b64_tr_b16 v[136:137], v172 offset:32768
  v_mfma_f32_16x16x32_bf16 v[80:83], v[116:119], a[120:123], v[80:83]
  s_add_u32 m0, s76, 0
  s_nop 0
  buffer_load_dwordx4 v168, s[32:35], s79 offen offset:0 lds
  v_mfma_f32_16x16x32_bf16 v[88:91], v[112:115], a[108:111], v[88:91]
  ds_read_b64_tr_b16 v[138:139], v172 offset:33280
  s_add_u32 s78, s91, 819200
  v_mfma_f32_16x16x32_bf16 v[88:91], v[116:119], a[124:127], v[88:91]
  s_waitcnt lgkmcnt(2)
  v_fma_f32 v209, v209, v186, v186
  v_mfma_f32_16x16x32_bf16 v[68:71], v[128:131], a[96:99], v[68:71]
  ds_read_b64_tr_b16 v[140:141], v172 offset:36864
  v_fma_f32 v210, v210, v186, v186
  v_mfma_f32_16x16x32_bf16 v[68:71], v[132:135], a[112:115], v[68:71]
  buffer_load_dwordx4 v169, s[32:35], s79 offen offset:1024 lds
  v_mfma_f32_16x16x32_bf16 v[76:79], v[128:131], a[100:103], v[76:79]
  ds_read_b64_tr_b16 v[142:143], v172 offset:37376
  v_rcp_f32 v208, v208
  v_mfma_f32_16x16x32_bf16 v[76:79], v[132:135], a[116:119], v[76:79]
  v_rcp_f32 v209, v209
  v_mfma_f32_16x16x32_bf16 v[84:87], v[128:131], a[104:107], v[84:87]
  ds_read_b64_tr_b16 v[112:113], v173 offset:32768
  v_fma_f32 v211, v211, v186, v186
  v_mfma_f32_16x16x32_bf16 v[84:87], v[132:135], a[120:123], v[84:87]
  buffer_load_dwordx4 v170, s[32:35], s79 offen offset:2048 lds
  v_fma_f32 v212, v212, v186, v186
  v_mfma_f32_16x16x32_bf16 v[92:95], v[128:131], a[108:111], v[92:95]
  ds_read_b64_tr_b16 v[114:115], v173 offset:33280
  v_fma_f32 v213, v213, v186, v186
  v_mfma_f32_16x16x32_bf16 v[92:95], v[132:135], a[124:127], v[92:95]
  s_waitcnt lgkmcnt(2)
  v_rcp_f32 v210, v210
  v_mfma_f32_16x16x32_bf16 v[64:67], v[136:139], a[128:131], v[64:67]
  ds_read_b64_tr_b16 v[116:117], v173 offset:36864
  v_rcp_f32 v211, v211
  v_mfma_f32_16x16x32_bf16 v[64:67], v[140:143], a[144:147], v[64:67]
  buffer_load_dwordx4 v171, s[32:35], s79 offen offset:3072 lds
  v_mfma_f32_16x16x32_bf16 v[72:75], v[136:139], a[132:135], v[72:75]
  s_mul_i32 s79, s65, 229376
  ds_read_b64_tr_b16 v[118:119], v173 offset:37376
  v_rcp_f32 v212, v212
  v_mfma_f32_16x16x32_bf16 v[72:75], v[140:143], a[148:151], v[72:75]
  s_add_u32 m0, s77, 69632
  v_rcp_f32 v213, v213
  v_mfma_f32_16x16x32_bf16 v[80:83], v[136:139], a[136:139], v[80:83]
  ds_read_b64_tr_b16 v[128:129], v172 offset:40960
  v_fma_f32 v214, v214, v186, v186
  v_mfma_f32_16x16x32_bf16 v[80:83], v[140:143], a[152:155], v[80:83]
  buffer_load_dwordx4 v164, s[40:43], s78 offen offset:0 lds
  v_fma_f32 v215, v215, v186, v186
  v_mfma_f32_16x16x32_bf16 v[88:91], v[136:139], a[140:143], v[88:91]
  ds_read_b64_tr_b16 v[130:131], v172 offset:41472
  v_mul_f32 v48, v48, v208
  v_mfma_f32_16x16x32_bf16 v[88:91], v[140:143], a[156:159], v[88:91]
  s_waitcnt lgkmcnt(2)
  v_rcp_f32 v214, v214
  v_mfma_f32_16x16x32_bf16 v[68:71], v[112:115], a[128:131], v[68:71]
  ds_read_b64_tr_b16 v[132:133], v172 offset:45056
  v_rcp_f32 v215, v215
  v_mfma_f32_16x16x32_bf16 v[68:71], v[116:119], a[144:147], v[68:71]
  buffer_load_dwordx4 v165, s[40:43], s78 offen offset:1024 lds
  v_mfma_f32_16x16x32_bf16 v[76:79], v[112:115], a[132:135], v[76:79]
  ds_read_b64_tr_b16 v[134:135], v172 offset:45568
  v_mul_f32 v49, v49, v209
  v_mul_f32 v50, v50, v210
  v_mfma_f32_16x16x32_bf16 v[76:79], v[116:119], a[148:151], v[76:79]
  v_mul_f32 v51, v51, v211
  v_mul_f32 v52, v52, v212
  v_mfma_f32_16x16x32_bf16 v[84:87], v[112:115], a[136:139], v[84:87]
  ds_read_b64_tr_b16 v[136:137], v173 offset:40960
  v_mul_f32 v53, v53, v213
  v_mfma_f32_16x16x32_bf16 v[84:87], v[116:119], a[152:155], v[84:87]
  buffer_load_dwordx4 v166, s[40:43], s78 offen offset:2048 lds
  v_mul_f32 v54, v54, v214
  v_mfma_f32_16x16x32_bf16 v[92:95], v[112:115], a[140:143], v[92:95]
  ds_read_b64_tr_b16 v[138:139], v173 offset:41472
  v_mul_f32 v55, v55, v215
  v_mfma_f32_16x16x32_bf16 v[92:95], v[116:119], a[156:159], v[92:95]
  s_waitcnt lgkmcnt(2)
  v_cvt_pk_bf16_f32 v152, v48, v49
  v_cvt_pk_bf16_f32 v153, v50, v51
  v_mfma_f32_16x16x32_bf16 v[64:67], v[128:131], a[160:163], v[64:67]
  ds_read_b64_tr_b16 v[140:141], v173 offset:45056
  v_cvt_pk_bf16_f32 v154, v52, v53
  v_cvt_pk_bf16_f32 v155, v54, v55
  v_mfma_f32_16x16x32_bf16 v[64:67], v[132:135], a[176:179], v[64:67]
  buffer_load_dwordx4 v167, s[40:43], s78 offen offset:3072 lds
  v_mfma_f32_16x16x32_bf16 v[72:75], v[128:131], a[164:167], v[72:75]
  ds_read_b64_tr_b16 v[142:143], v173 offset:45568
  v_mul_f32 v208, v24, v24
  v_mul_f32 v209, v25, v25
  v_mfma_f32_16x16x32_bf16 v[72:75], v[132:135], a[180:183], v[72:75]
  v_mul_f32 v210, v26, v26
  v_mul_f32 v211, v27, v27
  v_mfma_f32_16x16x32_bf16 v[80:83], v[128:131], a[168:171], v[80:83]
  s_waitcnt vmcnt(12)
  s_barrier
  ds_read_b64_tr_b16 v[112:113], v172 offset:49152
  v_mfma_f32_16x16x32_bf16 v[80:83], v[132:135], a[184:187], v[80:83]
  s_add_u32 m0, s76, 16384
  s_nop 0
  buffer_load_dwordx4 v168, s[32:35], s79 offen offset:0 lds
  v_mfma_f32_16x16x32_bf16 v[88:91], v[128:131], a[172:175], v[88:91]
  ds_read_b64_tr_b16 v[114:115], v172 offset:49664
  s_add_u32 s78, s92, 524288
  v_mfma_f32_16x16x32_bf16 v[88:91], v[132:135], a[188:191], v[88:91]
  s_waitcnt lgkmcnt(2)
  v_mul_f32 v212, v28, v28
  v_mfma_f32_16x16x32_bf16 v[68:71], v[136:139], a[160:163], v[68:71]
  ds_read_b64_tr_b16 v[116:117], v172 offset:53248
  v_mul_f32 v213, v29, v29
  v_mfma_f32_16x16x32_bf16 v[68:71], v[140:143], a[176:179], v[68:71]
  buffer_load_dwordx4 v169, s[32:35], s79 offen offset:1024 lds
  v_mfma_f32_16x16x32_bf16 v[76:79], v[136:139], a[164:167], v[76:79]
  ds_read_b64_tr_b16 v[118:119], v172 offset:53760
  v_mul_f32 v214, v30, v30
  v_mul_f32 v215, v31, v31
  v_mfma_f32_16x16x32_bf16 v[76:79], v[140:143], a[180:183], v[76:79]
  v_fmamk_f32 v208, v208, 0xbdd2d3e8, v206
  v_fmamk_f32 v209, v209, 0xbdd2d3e8, v206
  v_mfma_f32_16x16x32_bf16 v[84:87], v[136:139], a[168:171], v[84:87]
  ds_read_b64_tr_b16 v[128:129], v173 offset:49152
  v_fmamk_f32 v210, v210, 0xbdd2d3e8, v206
  v_mfma_f32_16x16x32_bf16 v[84:87], v[140:143], a[184:187], v[84:87]
  buffer_load_dwordx4 v170, s[32:35], s79 offen offset:2048 lds
  v_fmamk_f32 v211, v211, 0xbdd2d3e8, v206
  v_mfma_f32_16x16x32_bf16 v[92:95], v[136:139], a[172:175], v[92:95]
  ds_read_b64_tr_b16 v[130:131], v173 offset:49664
  v_fmamk_f32 v212, v212, 0xbdd2d3e8, v206
  v_mfma_f32_16x16x32_bf16 v[92:95], v[140:143], a[188:191], v[92:95]
  s_waitcnt lgkmcnt(2)
  v_fmamk_f32 v213, v213, 0xbdd2d3e8, v206
  v_fmamk_f32 v214, v214, 0xbdd2d3e8, v206
  v_mfma_f32_16x16x32_bf16 v[64:67], v[112:115], a[192:195], v[64:67]
  ds_read_b64_tr_b16 v[132:133], v173 offset:53248
  v_fmamk_f32 v215, v215, 0xbdd2d3e8, v206
  v_mul_f32 v208, v208, v24
  v_mfma_f32_16x16x32_bf16 v[64:67], v[116:119], a[208:211], v[64:67]
  buffer_load_dwordx4 v171, s[32:35], s79 offen offset:3072 lds
  v_mfma_f32_16x16x32_bf16 v[72:75], v[112:115], a[196:199], v[72:75]
  s_mul_i32 s79, s66, 229376
  ds_read_b64_tr_b16 v[134:135], v173 offset:53760
  v_exp_f32 v208, v208
  v_mfma_f32_16x16x32_bf16 v[72:75], v[116:119], a[212:215], v[72:75]
  s_add_u32 m0, s77, 98304
  v_mul_f32 v209, v209, v25
  v_mul_f32 v210, v210, v26
  v_mfma_f32_16x16x32_bf16 v[80:83], v[112:115], a[200:203], v[80:83]
  ds_read_b64_tr_b16 v[136:137], v172 offset:57344
  v_mul_f32 v211, v211, v27
  v_mfma_f32_16x16x32_bf16 v[80:83], v[116:119], a[216:219], v[80:83]
  buffer_load_dwordx4 v164, s[40:43], s78 offen offset:0 lds
  v_mul_f32 v212, v212, v28
  v_mfma_f32_16x16x32_bf16 v[88:91], v[112:115], a[204:207], v[88:91]
  ds_read_b64_tr_b16 v[138:139], v172 offset:57856
  v_mul_f32 v213, v213, v29
  v_mfma_f32_16x16x32_bf16 v[88:91], v[116:119], a[220:223], v[88:91]
  s_waitcnt lgkmcnt(2)
  v_exp_f32 v209, v209
  v_mfma_f32_16x16x32_bf16 v[68:71], v[128:131], a[192:195], v[68:71]
  ds_read_b64_tr_b16 v[140:141], v172 offset:61440
  v_exp_f32 v210, v210
  v_mfma_f32_16x16x32_bf16 v[68:71], v[132:135], a[208:211], v[68:71]
  buffer_load_dwordx4 v165, s[40:43], s78 offen offset:1024 lds
  v_mfma_f32_16x16x32_bf16 v[76:79], v[128:131], a[196:199], v[76:79]
  ds_read_b64_tr_b16 v[142:143], v172 offset:61952
  v_exp_f32 v211, v211
  v_mfma_f32_16x16x32_bf16 v[76:79], v[132:135], a[212:215], v[76:79]
  v_exp_f32 v212, v212
  v_mfma_f32_16x16x32_bf16 v[84:87], v[128:131], a[200:203], v[84:87]
  ds_read_b64_tr_b16 v[112:113], v173 offset:57344
  v_mul_f32 v214, v214, v30
  v_mfma_f32_16x16x32_bf16 v[84:87], v[132:135], a[216:219], v[84:87]
  buffer_load_dwordx4 v166, s[40:43], s78 offen offset:2048 lds
  v_mul_f32 v215, v215, v31
  v_mfma_f32_16x16x32_bf16 v[92:95], v[128:131], a[204:207], v[92:95]
  ds_read_b64_tr_b16 v[114:115], v173 offset:57856
  v_mul_f32 v56, v24, v56
  v_mfma_f32_16x16x32_bf16 v[92:95], v[132:135], a[220:223], v[92:95]
  s_waitcnt lgkmcnt(2)
  v_exp_f32 v213, v213
  v_mfma_f32_16x16x32_bf16 v[64:67], v[136:139], a[224:227], v[64:67]
  ds_read_b64_tr_b16 v[116:117], v173 offset:61440
  v_exp_f32 v214, v214
  v_mfma_f32_16x16x32_bf16 v[64:67], v[140:143], a[240:243], v[64:67]
  buffer_load_dwordx4 v167, s[40:43], s78 offen offset:3072 lds
  v_mfma_f32_16x16x32_bf16 v[72:75], v[136:139], a[228:231], v[72:75]
  ds_read_b64_tr_b16 v[118:119], v173 offset:61952
  v_exp_f32 v215, v215
  v_mfma_f32_16x16x32_bf16 v[72:75], v[140:143], a[244:247], v[72:75]
  v_mul_f32 v57, v25, v57
  v_mul_f32 v58, v26, v58
  v_mfma_f32_16x16x32_bf16 v[80:83], v[136:139], a[232:235], v[80:83]
  s_waitcnt vmcnt(12)
  s_barrier
  ds_read_b64_tr_b16 v[128:129], v172 offset:0
  v_mfma_f32_16x16x32_bf16 v[80:83], v[140:143], a[248:251], v[80:83]
  s_add_u32 m0, s76, 32768
  s_nop 0
  buffer_load_dwordx4 v168, s[32:35], s79 offen offset:0 lds
  v_mfma_f32_16x16x32_bf16 v[88:91], v[136:139], a[236:239], v[88:91]
  ds_read_b64_tr_b16 v[130:131], v172 offset:512
  s_add_u32 s78, s92, 557056
  v_mfma_f32_16x16x32_bf16 v[88:91], v[140:143], a[252:255], v[88:91]
  s_waitcnt lgkmcnt(2)
  v_mul_f32 v59, v27, v59
  v_mfma_f32_16x16x32_bf16 v[68:71], v[112:115], a[224:227], v[68:71]
  ds_read_b64_tr_b16 v[132:133], v172 offset:4096
  v_mul_f32 v60, v28, v60
  v_mfma_f32_16x16x32_bf16 v[68:71], v[116:119], a[240:243], v[68:71]
  buffer_load_dwordx4 v169, s[32:35], s79 offen offset:1024 lds
  v_mfma_f32_16x16x32_bf16 v[76:79], v[112:115], a[228:231], v[76:79]
  ds_read_b64_tr_b16 v[134:135], v172 offset:4608
  v_mul_f32 v61, v29, v61
  v_mul_f32 v62, v30, v62
  v_mfma_f32_16x16x32_bf16 v[76:79], v[116:119], a[244:247], v[76:79]
  v_mul_f32 v63, v31, v63
  v_fma_f32 v208, v208, v187, v187
  v_mfma_f32_16x16x32_bf16 v[84:87], v[112:115], a[232:235], v[84:87]
  ds_read_b64_tr_b16 v[136:137], v173 offset:0
  v_fma_f32 v209, v209, v187, v187
  v_mfma_f32_16x16x32_bf16 v[84:87], v[116:119], a[248:251], v[84:87]
  buffer_load_dwordx4 v170, s[32:35], s79 offen offset:2048 lds
  v_fma_f32 v210, v210, v187, v187
  v_mfma_f32_16x16x32_bf16 v[92:95], v[112:115], a[236:239], v[92:95]
  ds_read_b64_tr_b16 v[138:139], v173 offset:512
  v_fma_f32 v211, v211, v187, v187
  v_mfma_f32_16x16x32_bf16 v[92:95], v[116:119], a[252:255], v[92:95]
  s_waitcnt lgkmcnt(2)
  v_rcp_f32 v208, v208
  v_mfma_f32_16x16x32_bf16 v[0:3], v[128:131], a[0:3], 0
  ds_read_b64_tr_b16 v[140:141], v173 offset:4096
  v_rcp_f32 v209, v209
  v_mfma_f32_16x16x32_bf16 v[0:3], v[132:135], a[16:19], v[0:3]
  buffer_load_dwordx4 v171, s[32:35], s79 offen offset:3072 lds
  v_mfma_f32_16x16x32_bf16 v[8:11], v[128:131], a[4:7], 0
  s_mul_i32 s79, s67, 229376
  ds_read_b64_tr_b16 v[142:143], v173 offset:4608
  v_rcp_f32 v210, v210
  v_mfma_f32_16x16x32_bf16 v[8:11], v[132:135], a[20:23], v[8:11]
  s_add_u32 m0, s77, 102400
  v_rcp_f32 v211, v211
  v_mfma_f32_16x16x32_bf16 v[96:99], v[128:131], a[8:11], 0
  ds_read_b64_tr_b16 v[216:217], v172 offset:8192
  v_fma_f32 v212, v212, v187, v187
  v_mfma_f32_16x16x32_bf16 v[96:99], v[132:135], a[24:27], v[96:99]
  buffer_load_dwordx4 v164, s[40:43], s78 offen offset:0 lds
  v_fma_f32 v213, v213, v187, v187
  v_mfma_f32_16x16x32_bf16 v[104:107], v[128:131], a[12:15], 0
  ds_read_b64_tr_b16 v[218:219], v172 offset:8704
  v_fma_f32 v214, v214, v187, v187
  v_mfma_f32_16x16x32_bf16 v[104:107], v[132:135], a[28:31], v[104:107]
  s_waitcnt lgkmcnt(2)
  v_rcp_f32 v212, v212
  v_mfma_f32_16x16x32_bf16 v[4:7], v[136:139], a[0:3], 0
  ds_read_b64_tr_b16 v[220:221], v172 offset:12288
  v_rcp_f32 v213, v213
  v_mfma_f32_16x16x32_bf16 v[4:7], v[140:143], a[16:19], v[4:7]
  buffer_load_dwordx4 v165, s[40:43], s78 offen offset:1024 lds
  v_mfma_f32_16x16x32_bf16 v[12:15], v[136:139], a[4:7], 0
  ds_read_b64_tr_b16 v[222:223], v172 offset:12800
  v_rcp_f32 v214, v214
  v_mfma_f32_16x16x32_bf16 v[12:15], v[140:143], a[20:23], v[12:15]
  v_fma_f32 v215, v215, v187, v187
  v_mul_f32 v56, v56, v208
  v_mfma_f32_16x16x32_bf16 v[100:103], v[136:139], a[8:11], 0
  ds_read_b64_tr_b16 v[128:129], v173 offset:8192
  v_mul_f32 v57, v57, v209
  v_mfma_f32_16x16x32_bf16 v[100:103], v[140:143], a[24:27], v[100:103]
  buffer_load_dwordx4 v166, s[40:43], s78 offen offset:2048 lds
  v_mul_f32 v58, v58, v210
  v_mfma_f32_16x16x32_bf16 v[108:111], v[136:139], a[12:15], 0
  ds_read_b64_tr_b16 v[130:131], v173 offset:8704
  v_mul_f32 v59, v59, v211
  v_mfma_f32_16x16x32_bf16 v[108:111], v[140:143], a[28:31], v[108:111]
  s_waitcnt lgkmcnt(2)
  v_rcp_f32 v215, v215
  v_mfma_f32_16x16x32_bf16 v[32:35], v[216:219], a[0:3], 0
  ds_read_b64_tr_b16 v[132:133], v173 offset:12288
  v_mul_f32 v60, v60, v212
  v_mul_f32 v61, v61, v213
  v_mfma_f32_16x16x32_bf16 v[32:35], v[220:223], a[16:19], v[32:35]
  buffer_load_dwordx4 v167, s[40:43], s78 offen offset:3072 lds
  v_mfma_f32_16x16x32_bf16 v[40:43], v[216:219], a[4:7], 0
  ds_read_b64_tr_b16 v[134:135], v173 offset:12800
  v_mul_f32 v62, v62, v214
  v_mul_f32_e64 v63, v63, v215
  v_mfma_f32_16x16x32_bf16 v[40:43], v[220:223], a[20:23], v[40:43]
  v_cvt_pk_bf16_f32 v156, v56, v57
  v_cvt_pk_bf16_f32 v157, v58, v59
  v_mfma_f32_16x16x32_bf16 v[112:115], v[216:219], a[8:11], 0
  s_waitcnt vmcnt(12)
  s_barrier
  ds_read_b64_tr_b16 v[136:137], v172 offset:16384
  v_mfma_f32_16x16x32_bf16 v[112:115], v[220:223], a[24:27], v[112:115]
  s_add_u32 m0, s76, 49152
  s_nop 0
  buffer_load_dwordx4 v168, s[32:35], s79 offen offset:0 lds
  v_mfma_f32_16x16x32_bf16 v[120:123], v[216:219], a[12:15], 0
  ds_read_b64_tr_b16 v[138:139], v172 offset:16896
  v_mfma_f32_16x16x32_bf16 v[120:123], v[220:223], a[28:31], v[120:123]
  s_waitcnt lgkmcnt(2)
  v_cvt_pk_bf16_f32 v158, v60, v61
  v_mfma_f32_16x16x32_bf16 v[36:39], v[128:131], a[0:3], 0
  ds_read_b64_tr_b16 v[140:141], v172 offset:20480
  v_cvt_pk_bf16_f32 v159, v62, v63
  v_mfma_f32_16x16x32_bf16 v[36:39], v[132:135], a[16:19], v[36:39]
  buffer_load_dwordx4 v169, s[32:35], s79 offen offset:1024 lds
  v_mfma_f32_16x16x32_bf16 v[44:47], v[128:131], a[4:7], 0
  ds_read_b64_tr_b16 v[142:143], v172 offset:20992
  buffer_store_dwordx4 v[144:147], v188, s[36:39], s87 offen offset:0 sc1
  v_mfma_f32_16x16x32_bf16 v[44:47], v[132:135], a[20:23], v[44:47]
  buffer_store_dwordx4 v[148:151], v188, s[36:39], s87 offen offset:1024 sc1
  v_mfma_f32_16x16x32_bf16 v[116:119], v[128:131], a[8:11], 0
  ds_read_b64_tr_b16 v[216:217], v173 offset:16384
  buffer_store_dwordx4 v[152:155], v189, s[36:39], s87 offen offset:0 sc1
  v_mfma_f32_16x16x32_bf16 v[116:119], v[132:135], a[24:27], v[116:119]
  buffer_load_dwordx4 v170, s[32:35], s79 offen offset:2048 lds
  v_mfma_f32_16x16x32_bf16 v[124:127], v[128:131], a[12:15], 0
  ds_read_b64_tr_b16 v[218:219], v173 offset:16896
  buffer_store_dwordx4 v[156:159], v189, s[36:39], s87 offen offset:1024 sc1
  v_mfma_f32_16x16x32_bf16 v[124:127], v[132:135], a[28:31], v[124:127]
  s_waitcnt lgkmcnt(2)
  v_mfma_f32_16x16x32_bf16 v[0:3], v[136:139], a[32:35], v[0:3]
  ds_read_b64_tr_b16 v[220:221], v173 offset:20480
  ds_read_b64_tr_b16 a[0:1], v200 offset:0
  v_mfma_f32_16x16x32_bf16 v[0:3], v[140:143], a[48:51], v[0:3]
  buffer_load_dwordx4 v171, s[32:35], s79 offen offset:3072 lds
  v_mfma_f32_16x16x32_bf16 v[8:11], v[136:139], a[36:39], v[8:11]
  s_mul_i32 s79, s68, 229376
  ds_read_b64_tr_b16 v[222:223], v173 offset:20992
  ds_read_b64_tr_b16 a[2:3], v200 offset:2048
  v_mfma_f32_16x16x32_bf16 v[8:11], v[140:143], a[52:55], v[8:11]
  ds_read_b64_tr_b16 a[4:5], v201 offset:0
  v_mfma_f32_16x16x32_bf16 v[96:99], v[136:139], a[40:43], v[96:99]
  ds_read_b64_tr_b16 v[128:129], v172 offset:24576
  ds_read_b64_tr_b16 a[6:7], v201 offset:2048
  v_mfma_f32_16x16x32_bf16 v[96:99], v[140:143], a[56:59], v[96:99]
  ds_read_b64_tr_b16 a[8:9], v202 offset:0
  v_mfma_f32_16x16x32_bf16 v[104:107], v[136:139], a[44:47], v[104:107]
  ds_read_b64_tr_b16 v[130:131], v172 offset:25088
  ds_read_b64_tr_b16 a[10:11], v202 offset:2048
  v_mfma_f32_16x16x32_bf16 v[104:107], v[140:143], a[60:63], v[104:107]
  s_waitcnt lgkmcnt(7)
  ds_read_b64_tr_b16 a[12:13], v203 offset:0
  v_mfma_f32_16x16x32_bf16 v[4:7], v[216:219], a[32:35], v[4:7]
  ds_read_b64_tr_b16 v[132:133], v172 offset:28672
  ds_read_b64_tr_b16 a[14:15], v203 offset:2048
  v_mfma_f32_16x16x32_bf16 v[4:7], v[220:223], a[48:51], v[4:7]
  ds_read_b64_tr_b16 a[16:17], v200 offset:4096
  v_mfma_f32_16x16x32_bf16 v[12:15], v[216:219], a[36:39], v[12:15]
  ds_read_b64_tr_b16 v[134:135], v172 offset:29184
  ds_read_b64_tr_b16 a[18:19], v200 offset:6144
  v_mfma_f32_16x16x32_bf16 v[12:15], v[220:223], a[52:55], v[12:15]
  ds_read_b64_tr_b16 a[20:21], v201 offset:4096
  v_mfma_f32_16x16x32_bf16 v[100:103], v[216:219], a[40:43], v[100:103]
  ds_read_b64_tr_b16 v[136:137], v173 offset:24576
  ds_read_b64_tr_b16 a[22:23], v201 offset:6144
  v_mfma_f32_16x16x32_bf16 v[100:103], v[220:223], a[56:59], v[100:103]
  ds_read_b64_tr_b16 a[24:25], v202 offset:4096
  v_mfma_f32_16x16x32_bf16 v[108:111], v[216:219], a[44:47], v[108:111]
  ds_read_b64_tr_b16 v[138:139], v173 offset:25088
  ds_read_b64_tr_b16 a[26:27], v202 offset:6144
  v_mfma_f32_16x16x32_bf16 v[108:111], v[220:223], a[60:63], v[108:111]
  s_waitcnt lgkmcnt(7)
  ds_read_b64_tr_b16 a[28:29], v203 offset:4096
  v_mfma_f32_16x16x32_bf16 v[32:35], v[128:131], a[32:35], v[32:35]
  ds_read_b64_tr_b16 v[140:141], v173 offset:28672
  ds_read_b64_tr_b16 a[30:31], v203 offset:6144
  v_mfma_f32_16x16x32_bf16 v[32:35], v[132:135], a[48:51], v[32:35]
  v_cvt_pk_bf16_f32 v144, v64, v65
  v_cvt_pk_bf16_f32 v145, v66, v67
  v_mfma_f32_16x16x32_bf16 v[40:43], v[128:131], a[36:39], v[40:43]
  ds_read_b64_tr_b16 v[142:143], v173 offset:29184
  v_cvt_pk_bf16_f32 v146, v68, v69
  v_mfma_f32_16x16x32_bf16 v[40:43], v[132:135], a[52:55], v[40:43]
  v_cvt_pk_bf16_f32 v147, v70, v71
  v_cvt_pk_bf16_f32 v148, v72, v73
  v_cvt_pk_bf16_f32 v149, v74, v75
  v_mfma_f32_16x16x32_bf16 v[112:115], v[128:131], a[40:43], v[112:115]
  s_waitcnt vmcnt(12)
  s_barrier
  ds_read_b64_tr_b16 v[216:217], v172 offset:32768
  v_mfma_f32_16x16x32_bf16 v[64:67], v[236:239], v[144:147], 0
  v_mfma_f32_16x16x32_bf16 v[68:71], v[244:247], v[144:147], 0
  v_mfma_f32_16x16x32_bf16 v[72:75], v[240:243], v[144:147], 0
  v_cvt_pk_bf16_f32 v150, v76, v77
  v_mfma_f32_16x16x32_bf16 v[112:115], v[132:135], a[56:59], v[112:115]
  s_add_u32 m0, s76, 0
  s_nop 0
  buffer_load_dwordx4 v168, s[32:35], s79 offen offset:0 lds
  v_mfma_f32_16x16x32_bf16 v[120:123], v[128:131], a[44:47], v[120:123]
  ds_read_b64_tr_b16 v[218:219], v172 offset:33280
  v_mfma_f32_16x16x32_bf16 v[120:123], v[132:135], a[60:63], v[120:123]
  s_waitcnt lgkmcnt(2)
  v_cvt_pk_bf16_f32 v151, v78, v79
  v_mfma_f32_16x16x32_bf16 v[76:79], v[248:251], v[144:147], 0
  v_cvt_pk_bf16_f32 v152, v80, v81
  v_cvt_pk_bf16_f32 v153, v82, v83
  v_mfma_f32_16x16x32_bf16 v[80:83], v[236:239], v[148:151], 0
  v_cvt_pk_bf16_f32 v154, v84, v85
  v_cvt_pk_bf16_f32 v155, v86, v87
  v_mfma_f32_16x16x32_bf16 v[84:87], v[244:247], v[148:151], 0
  v_cvt_pk_bf16_f32 v156, v88, v89
  v_cvt_pk_bf16_f32 v157, v90, v91
  v_mfma_f32_16x16x32_bf16 v[88:91], v[240:243], v[148:151], 0
  v_cvt_pk_bf16_f32 v158, v92, v93
  v_cvt_pk_bf16_f32 v159, v94, v95
  v_mfma_f32_16x16x32_bf16 v[92:95], v[248:251], v[148:151], 0
  v_max3_f32 v208, v64, v65, v66
  v_max3_f32 v208, v208, v67, v68
  v_max3_f32 v208, v208, v69, v70
  v_mfma_f32_16x16x32_bf16 v[36:39], v[136:139], a[32:35], v[36:39]
  ds_read_b64_tr_b16 v[220:221], v172 offset:36864
  v_max3_f32 v208, v208, v71, v72
  v_mfma_f32_16x16x32_bf16 v[36:39], v[140:143], a[48:51], v[36:39]
  buffer_load_dwordx4 v169, s[32:35], s79 offen offset:1024 lds
  v_mfma_f32_16x16x32_bf16 v[44:47], v[136:139], a[36:39], v[44:47]
  ds_read_b64_tr_b16 v[222:223], v172 offset:37376
  v_max3_f32 v208, v208, v73, v74
  v_mfma_f32_16x16x32_bf16 v[44:47], v[140:143], a[52:55], v[44:47]
  v_max3_f32 v208, v208, v75, v76
  v_max3_f32 v208, v208, v77, v78
  v_max_f32 v208, v208, v79
  v_mfma_f32_16x16x32_bf16 v[116:119], v[136:139], a[40:43], v[116:119]
  ds_read_b64_tr_b16 v[128:129], v173 offset:32768
  v_mul_f32 v208, 0xbfb8aa3b, v208
  v_mfma_f32_16x16x32_bf16 v[116:119], v[140:143], a[56:59], v[116:119]
  buffer_load_dwordx4 v170, s[32:35], s79 offen offset:2048 lds
  v_mfma_f32_16x16x32_bf16 v[124:127], v[136:139], a[44:47], v[124:127]
  ds_read_b64_tr_b16 v[130:131], v173 offset:33280
  v_fma_f32 v64, v64, v207, v208
  v_mfma_f32_16x16x32_bf16 v[124:127], v[140:143], a[60:63], v[124:127]
  s_waitcnt lgkmcnt(2)
  v_exp_f32 v64, v64
  v_fma_f32 v65, v65, v207, v208
  v_mfma_f32_16x16x32_bf16 v[0:3], v[216:219], a[64:67], v[0:3]
  ds_read_b64_tr_b16 v[132:133], v173 offset:36864
  ds_read_b64_tr_b16 a[32:33], v160 offset:0
  v_mfma_f32_16x16x32_bf16 v[0:3], v[220:223], a[80:83], v[0:3]
  buffer_load_dwordx4 v171, s[32:35], s79 offen offset:3072 lds
  v_mfma_f32_16x16x32_bf16 v[8:11], v[216:219], a[68:71], v[8:11]
  s_mul_i32 s79, s69, 229376
  ds_read_b64_tr_b16 v[134:135], v173 offset:37376
  ds_read_b64_tr_b16 a[34:35], v160 offset:2048
  v_mfma_f32_16x16x32_bf16 v[8:11], v[220:223], a[84:87], v[8:11]
  ds_read_b64_tr_b16 a[36:37], v161 offset:0
  s_add_u32 m0, s77, 131072
  v_fma_f32 v66, v66, v207, v208
  v_mfma_f32_16x16x32_bf16 v[96:99], v[216:219], a[72:75], v[96:99]
  s_add_u32 s78, s90, 0
  ds_read_b64_tr_b16 v[136:137], v172 offset:40960
  ds_read_b64_tr_b16 a[38:39], v161 offset:2048
  v_mfma_f32_16x16x32_bf16 v[96:99], v[220:223], a[88:91], v[96:99]
  buffer_load_dwordx4 v164, s[40:43], s78 offen offset:0 lds
  v_mfma_f32_16x16x32_bf16 v[104:107], v[216:219], a[76:79], v[104:107]
  ds_read_b64_tr_b16 v[138:139], v172 offset:41472
  ds_read_b64_tr_b16 a[40:41], v162 offset:0
  v_mfma_f32_16x16x32_bf16 v[104:107], v[220:223], a[92:95], v[104:107]
  s_waitcnt lgkmcnt(6)
  ds_read_b64_tr_b16 a[42:43], v162 offset:2048
  v_exp_f32 v65, v65
  v_mfma_f32_16x16x32_bf16 v[4:7], v[128:131], a[64:67], v[4:7]
  ds_read_b64_tr_b16 v[140:141], v172 offset:45056
  ds_read_b64_tr_b16 a[44:45], v163 offset:0
  v_mfma_f32_16x16x32_bf16 v[4:7], v[132:135], a[80:83], v[4:7]
  buffer_load_dwordx4 v165, s[40:43], s78 offen offset:1024 lds
  v_mfma_f32_16x16x32_bf16 v[12:15], v[128:131], a[68:71], v[12:15]
  ds_read_b64_tr_b16 v[142:143], v172 offset:45568
  ds_read_b64_tr_b16 a[46:47], v163 offset:2048
  v_mfma_f32_16x16x32_bf16 v[12:15], v[132:135], a[84:87], v[12:15]
  ds_read_b64_tr_b16 a[48:49], v160 offset:4096
  v_exp_f32 v66, v66
  v_mfma_f32_16x16x32_bf16 v[100:103], v[128:131], a[72:75], v[100:103]
  ds_read_b64_tr_b16 v[216:217], v173 offset:40960
  ds_read_b64_tr_b16 a[50:51], v160 offset:6144
  v_mfma_f32_16x16x32_bf16 v[100:103], v[132:135], a[88:91], v[100:103]
  buffer_load_dwordx4 v166, s[40:43], s78 offen offset:2048 lds
  v_mfma_f32_16x16x32_bf16 v[108:111], v[128:131], a[76:79], v[108:111]
  ds_read_b64_tr_b16 v[218:219], v173 offset:41472
  ds_read_b64_tr_b16 a[52:53], v161 offset:4096
  v_mfma_f32_16x16x32_bf16 v[108:111], v[132:135], a[92:95], v[108:111]
  s_waitcnt lgkmcnt(6)
  ds_read_b64_tr_b16 a[54:55], v161 offset:6144
  v_fma_f32 v67, v67, v207, v208
  v_add_f32 v210, v64, v65
  v_mfma_f32_16x16x32_bf16 v[32:35], v[136:139], a[64:67], v[32:35]
  ds_read_b64_tr_b16 v[220:221], v173 offset:45056
  ds_read_b64_tr_b16 a[56:57], v162 offset:4096
  v_mfma_f32_16x16x32_bf16 v[32:35], v[140:143], a[80:83], v[32:35]
  buffer_load_dwordx4 v167, s[40:43], s78 offen offset:3072 lds
  v_mfma_f32_16x16x32_bf16 v[40:43], v[136:139], a[68:71], v[40:43]
  ds_read_b64_tr_b16 v[222:223], v173 offset:45568
  ds_read_b64_tr_b16 a[58:59], v162 offset:6144
  v_mfma_f32_16x16x32_bf16 v[40:43], v[140:143], a[84:87], v[40:43]
  ds_read_b64_tr_b16 a[60:61], v163 offset:4096
  v_exp_f32 v67, v67
  v_mfma_f32_16x16x32_bf16 v[112:115], v[136:139], a[72:75], v[112:115]
  s_waitcnt vmcnt(8)
  s_barrier
  buffer_store_dword v176, v182, s[36:39], 0 offen offset:0 sc1
  ds_read_b64_tr_b16 v[128:129], v172 offset:49152
  v_mfma_f32_16x16x32_bf16 v[112:115], v[140:143], a[88:91], v[112:115]
  s_add_u32 m0, s76, 16384
  s_nop 0
  buffer_load_dwordx4 v168, s[32:35], s79 offen offset:0 lds
  v_mfma_f32_16x16x32_bf16 v[120:123], v[136:139], a[76:79], v[120:123]
  ds_read_b64_tr_b16 v[130:131], v172 offset:49664
  s_add_u32 s78, s90, 32768
  v_mfma_f32_16x16x32_bf16 v[120:123], v[140:143], a[92:95], v[120:123]
  s_waitcnt lgkmcnt(4)
  ds_read_b64_tr_b16 a[62:63], v163 offset:6144
  v_mfma_f32_16x16x32_bf16 v[36:39], v[216:219], a[64:67], v[36:39]
  ds_read_b64_tr_b16 v[132:133], v172 offset:53248
  v_mfma_f32_16x16x32_bf16 v[36:39], v[220:223], a[80:83], v[36:39]
  buffer_load_dwordx4 v169, s[32:35], s79 offen offset:1024 lds
  v_mfma_f32_16x16x32_bf16 v[44:47], v[216:219], a[68:71], v[44:47]
  ds_read_b64_tr_b16 v[134:135], v172 offset:53760
  v_mfma_f32_16x16x32_bf16 v[44:47], v[220:223], a[84:87], v[44:47]
  v_fma_f32 v68, v68, v207, v208
  v_mfma_f32_16x16x32_bf16 v[116:119], v[216:219], a[72:75], v[116:119]
  ds_read_b64_tr_b16 v[136:137], v173 offset:49152
  v_add_f32 v210, v210, v66
  v_mfma_f32_16x16x32_bf16 v[116:119], v[220:223], a[88:91], v[116:119]
  buffer_load_dwordx4 v170, s[32:35], s79 offen offset:2048 lds
  v_mfma_f32_16x16x32_bf16 v[124:127], v[216:219], a[76:79], v[124:127]
  ds_read_b64_tr_b16 v[138:139], v173 offset:49664
  v_fma_f32 v69, v69, v207, v208
  v_mfma_f32_16x16x32_bf16 v[124:127], v[220:223], a[92:95], v[124:127]
  s_waitcnt lgkmcnt(2)
  v_exp_f32 v68, v68
  v_mfma_f32_16x16x32_bf16 v[0:3], v[128:131], a[96:99], v[0:3]
  ds_read_b64_tr_b16 v[140:141], v173 offset:53248
  v_exp_f32 v69, v69
  v_mfma_f32_16x16x32_bf16 v[0:3], v[132:135], a[112:115], v[0:3]
  buffer_load_dwordx4 v171, s[32:35], s79 offen offset:3072 lds
  v_mfma_f32_16x16x32_bf16 v[8:11], v[128:131], a[100:103], v[8:11]
  s_mul_i32 s79, s70, 229376
  ds_read_b64_tr_b16 v[142:143], v173 offset:53760
  v_add_f32 v210, v210, v67
  v_mfma_f32_16x16x32_bf16 v[8:11], v[132:135], a[116:119], v[8:11]
  s_add_u32 m0, s77, 135168
  v_fma_f32 v70, v70, v207, v208
  v_add_f32 v210, v210, v68
  v_mfma_f32_16x16x32_bf16 v[96:99], v[128:131], a[104:107], v[96:99]
  ds_read_b64_tr_b16 v[216:217], v172 offset:57344
L_pgQ3:
  s_cbranch_execz L_back
  v_exp_f32 v70, v70
  v_mfma_f32_16x16x32_bf16 v[96:99], v[132:135], a[120:123], v[96:99]
  buffer_load_dwordx4 v164, s[40:43], s78 offen offset:0 lds
  v_mfma_f32_16x16x32_bf16 v[104:107], v[128:131], a[108:111], v[104:107]
  ds_read_b64_tr_b16 v[218:219], v172 offset:57856
  v_fma_f32 v71, v71, v207, v208
  v_mfma_f32_16x16x32_bf16 v[104:107], v[132:135], a[124:127], v[104:107]
  s_waitcnt lgkmcnt(2)
  v_exp_f32 v71, v71
  v_mfma_f32_16x16x32_bf16 v[4:7], v[136:139], a[96:99], v[4:7]
  ds_read_b64_tr_b16 v[220:221], v172 offset:61440
  v_add_f32 v210, v210, v69
  v_fma_f32 v72, v72, v207, v208
  v_mfma_f32_16x16x32_bf16 v[4:7], v[140:143], a[112:115], v[4:7]
  buffer_load_dwordx4 v165, s[40:43], s78 offen offset:1024 lds
  v_mfma_f32_16x16x32_bf16 v[12:15], v[136:139], a[100:103], v[12:15]
  ds_read_b64_tr_b16 v[222:223], v172 offset:61952
  v_add_f32 v210, v210, v70
  v_mfma_f32_16x16x32_bf16 v[12:15], v[140:143], a[116:119], v[12:15]
  v_exp_f32 v72, v72
  v_mfma_f32_16x16x32_bf16 v[100:103], v[136:139], a[104:107], v[100:103]
  ds_read_b64_tr_b16 v[128:129], v173 offset:57344
  v_fma_f32 v73, v73, v207, v208
  v_add_f32 v210, v210, v71
  v_mfma_f32_16x16x32_bf16 v[100:103], v[140:143], a[120:123], v[100:103]
  buffer_load_dwordx4 v166, s[40:43], s78 offen offset:2048 lds
  v_mfma_f32_16x16x32_bf16 v[108:111], v[136:139], a[108:111], v[108:111]
  ds_read_b64_tr_b16 v[130:131], v173 offset:57856
  v_fma_f32 v74, v74, v207, v208
  v_mfma_f32_16x16x32_bf16 v[108:111], v[140:143], a[124:127], v[108:111]
  s_waitcnt lgkmcnt(2)
  v_exp_f32 v73, v73
  v_mfma_f32_16x16x32_bf16 v[32:35], v[216:219], a[96:99], v[32:35]
  ds_read_b64_tr_b16 v[132:133], v173 offset:61440
  v_exp_f32 v74, v74
  v_mfma_f32_16x16x32_bf16 v[32:35], v[220:223], a[112:115], v[32:35]
  buffer_load_dwordx4 v167, s[40:43], s78 offen offset:3072 lds
  v_mfma_f32_16x16x32_bf16 v[40:43], v[216:219], a[100:103], v[40:43]
  ds_read_b64_tr_b16 v[134:135], v173 offset:61952
  v_add_f32 v210, v210, v72
  v_mfma_f32_16x16x32_bf16 v[40:43], v[220:223], a[116:119], v[40:43]
  v_fma_f32 v75, v75, v207, v208
  v_add_f32 v210, v210, v73
  v_mfma_f32_16x16x32_bf16 v[112:115], v[216:219], a[104:107], v[112:115]
  s_waitcnt vmcnt(13)
  s_barrier
  ds_read_b64_tr_b16 v[136:137], v172 offset:0
  v_mfma_f32_16x16x32_bf16 v[112:115], v[220:223], a[120:123], v[112:115]
  s_add_u32 m0, s76, 32768
  s_nop 0
  buffer_load_dwordx4 v168, s[32:35], s79 offen offset:0 lds
  v_mfma_f32_16x16x32_bf16 v[120:123], v[216:219], a[108:111], v[120:123]
  ds_read_b64_tr_b16 v[138:139], v172 offset:512
  s_add_u32 s78, s91, 0
  v_mfma_f32_16x16x32_bf16 v[120:123], v[220:223], a[124:127], v[120:123]
  s_waitcnt lgkmcnt(2)
  v_fma_f32 v76, v76, v207, v208
  v_mfma_f32_16x16x32_bf16 v[36:39], v[128:131], a[96:99], v[36:39]
  ds_read_b64_tr_b16 v[140:141], v172 offset:4096
  v_add_f32 v210, v210, v74
  v_mfma_f32_16x16x32_bf16 v[36:39], v[132:135], a[112:115], v[36:39]
  buffer_load_dwordx4 v169, s[32:35], s79 offen offset:1024 lds
  v_mfma_f32_16x16x32_bf16 v[44:47], v[128:131], a[100:103], v[44:47]
  ds_read_b64_tr_b16 v[142:143], v172 offset:4608
  v_fma_f32 v77, v77, v207, v208
  v_mfma_f32_16x16x32_bf16 v[44:47], v[132:135], a[116:119], v[44:47]
  v_exp_f32 v75, v75
  v_mfma_f32_16x16x32_bf16 v[116:119], v[128:131], a[104:107], v[116:119]
  ds_read_b64_tr_b16 v[216:217], v173 offset:0
  v_exp_f32 v76, v76
  v_mfma_f32_16x16x32_bf16 v[116:119], v[132:135], a[120:123], v[116:119]
  buffer_load_dwordx4 v170, s[32:35], s79 offen offset:2048 lds
  v_mfma_f32_16x16x32_bf16 v[124:127], v[128:131], a[108:111], v[124:127]
  ds_read_b64_tr_b16 v[218:219], v173 offset:512
  v_add_f32 v210, v210, v75
  v_mfma_f32_16x16x32_bf16 v[124:127], v[132:135], a[124:127], v[124:127]
  s_waitcnt lgkmcnt(2)
  v_exp_f32 v77, v77
  v_mfma_f32_16x16x32_bf16 v[0:3], v[136:139], a[128:131], v[0:3]
  ds_read_b64_tr_b16 v[220:221], v173 offset:4096
  v_fma_f32 v78, v78, v207, v208
  v_add_f32 v210, v210, v76
  v_mfma_f32_16x16x32_bf16 v[0:3], v[140:143], a[144:147], v[0:3]
  buffer_load_dwordx4 v171, s[32:35], s79 offen offset:3072 lds
  v_mfma_f32_16x16x32_bf16 v[8:11], v[136:139], a[132:135], v[8:11]
  s_mul_i32 s79, s71, 229376
  ds_read_b64_tr_b16 v[222:223], v173 offset:4608
  v_fma_f32 v79, v79, v207, v208
  v_mfma_f32_16x16x32_bf16 v[8:11], v[140:143], a[148:151], v[8:11]
  s_add_u32 m0, s77, 65536
  v_exp_f32 v78, v78
  v_mfma_f32_16x16x32_bf16 v[96:99], v[136:139], a[136:139], v[96:99]
  ds_read_b64_tr_b16 v[128:129], v172 offset:8192
  v_exp_f32 v79, v79
  v_mfma_f32_16x16x32_bf16 v[96:99], v[140:143], a[152:155], v[96:99]
  buffer_load_dwordx4 v164, s[40:43], s78 offen offset:0 lds
  v_mfma_f32_16x16x32_bf16 v[104:107], v[136:139], a[140:143], v[104:107]
  ds_read_b64_tr_b16 v[130:131], v172 offset:8704
  v_add_f32 v210, v210, v77
  v_mfma_f32_16x16x32_bf16 v[104:107], v[140:143], a[156:159], v[104:107]
  s_waitcnt lgkmcnt(2)
  v_add_f32 v210, v210, v78
  v_add_f32 v210, v210, v79
  v_mfma_f32_16x16x32_bf16 v[4:7], v[216:219], a[128:131], v[4:7]
  ds_read_b64_tr_b16 v[132:133], v172 offset:12288
  v_rcp_f32 v210, v210
  v_mfma_f32_16x16x32_bf16 v[4:7], v[220:223], a[144:147], v[4:7]
  buffer_load_dwordx4 v165, s[40:43], s78 offen offset:1024 lds
  v_mfma_f32_16x16x32_bf16 v[12:15], v[216:219], a[132:135], v[12:15]
  ds_read_b64_tr_b16 v[134:135], v172 offset:12800
  v_mul_f32 v64, v64, v210
  v_mfma_f32_16x16x32_bf16 v[12:15], v[220:223], a[148:151], v[12:15]
  v_mul_f32 v65, v65, v210
  v_mul_f32 v66, v66, v210
  v_mfma_f32_16x16x32_bf16 v[100:103], v[216:219], a[136:139], v[100:103]
  ds_read_b64_tr_b16 v[136:137], v173 offset:8192
  v_mul_f32 v67, v67, v210
  v_mul_f32 v68, v68, v210
  v_mfma_f32_16x16x32_bf16 v[100:103], v[220:223], a[152:155], v[100:103]
  buffer_load_dwordx4 v166, s[40:43], s78 offen offset:2048 lds
  v_mfma_f32_16x16x32_bf16 v[108:111], v[216:219], a[140:143], v[108:111]
  ds_read_b64_tr_b16 v[138:139], v173 offset:8704
  v_mul_f32 v69, v69, v210
  v_mfma_f32_16x16x32_bf16 v[108:111], v[220:223], a[156:159], v[108:111]
  s_waitcnt lgkmcnt(2)
  v_mul_f32 v70, v70, v210
  v_mul_f32 v71, v71, v210
  v_mfma_f32_16x16x32_bf16 v[32:35], v[128:131], a[128:131], v[32:35]
  ds_read_b64_tr_b16 v[140:141], v173 offset:12288
  v_mul_f32 v72, v72, v210
  v_mul_f32 v73, v73, v210
  v_mfma_f32_16x16x32_bf16 v[32:35], v[132:135], a[144:147], v[32:35]
  buffer_load_dwordx4 v167, s[40:43], s78 offen offset:3072 lds
  v_mfma_f32_16x16x32_bf16 v[40:43], v[128:131], a[132:135], v[40:43]
  ds_read_b64_tr_b16 v[142:143], v173 offset:12800
  v_mul_f32 v74, v74, v210
  v_mfma_f32_16x16x32_bf16 v[40:43], v[132:135], a[148:151], v[40:43]
  v_mul_f32 v75, v75, v210
  v_mul_f32 v76, v76, v210
  v_mfma_f32_16x16x32_bf16 v[112:115], v[128:131], a[136:139], v[112:115]
  s_waitcnt vmcnt(12)
  s_barrier
  ds_read_b64_tr_b16 v[216:217], v172 offset:16384
  v_mfma_f32_16x16x32_bf16 v[112:115], v[132:135], a[152:155], v[112:115]
  s_add_u32 m0, s76, 49152
  buffer_load_dword v177, v226, s[36:39], s27 offen offset:0 sc1
  v_mfma_f32_16x16x32_bf16 v[120:123], v[128:131], a[140:143], v[120:123]
  ds_read_b64_tr_b16 v[218:219], v172 offset:16896
  s_add_u32 s78, s91, 32768
  v_mfma_f32_16x16x32_bf16 v[120:123], v[132:135], a[156:159], v[120:123]
  s_waitcnt lgkmcnt(2)
  buffer_load_dwordx4 v168, s[32:35], s79 offen offset:0 lds
  v_mfma_f32_16x16x32_bf16 v[36:39], v[136:139], a[128:131], v[36:39]
  ds_read_b64_tr_b16 v[220:221], v172 offset:20480
  v_mul_f32 v77, v77, v210
  v_mfma_f32_16x16x32_bf16 v[36:39], v[140:143], a[144:147], v[36:39]
  v_mul_f32 v78, v78, v210
  v_mul_f32 v79, v79, v210
  v_mfma_f32_16x16x32_bf16 v[44:47], v[136:139], a[132:135], v[44:47]
  ds_read_b64_tr_b16 v[222:223], v172 offset:20992
  v_cvt_pk_bf16_f32 v16, v64, v65
  v_mfma_f32_16x16x32_bf16 v[44:47], v[140:143], a[148:151], v[44:47]
  buffer_load_dwordx4 v169, s[32:35], s79 offen offset:1024 lds
  v_mfma_f32_16x16x32_bf16 v[116:119], v[136:139], a[136:139], v[116:119]
  ds_read_b64_tr_b16 v[128:129], v173 offset:16384
  v_cvt_pk_bf16_f32 v17, v66, v67
  v_cvt_pk_bf16_f32 v18, v68, v69
  v_mfma_f32_16x16x32_bf16 v[64:67], v[236:239], v[152:155], 0
  v_cvt_pk_bf16_f32 v19, v70, v71
  v_cvt_pk_bf16_f32 v20, v72, v73
  v_mfma_f32_16x16x32_bf16 v[68:71], v[244:247], v[152:155], 0
  v_cvt_pk_bf16_f32 v21, v74, v75
  v_cvt_pk_bf16_f32 v22, v76, v77
  v_mfma_f32_16x16x32_bf16 v[72:75], v[240:243], v[152:155], 0
  v_cvt_pk_bf16_f32 v23, v78, v79
  v_permlane32_swap_b32 v16, v20
  v_mfma_f32_16x16x32_bf16 v[76:79], v[248:251], v[152:155], 0
  v_permlane32_swap_b32 v17, v21
  v_permlane32_swap_b32 v18, v22
  v_permlane32_swap_b32 v19, v23
  v_mfma_f32_16x16x32_bf16 v[116:119], v[140:143], a[152:155], v[116:119]
  v_max3_f32 v208, v80, v81, v82
  v_max3_f32 v208, v208, v83, v84
  v_mfma_f32_16x16x32_bf16 v[124:127], v[136:139], a[140:143], v[124:127]
  ds_read_b64_tr_b16 v[130:131], v173 offset:16896
  v_max3_f32 v208, v208, v85, v86
  v_mfma_f32_16x16x32_bf16 v[124:127], v[140:143], a[156:159], v[124:127]
  s_waitcnt lgkmcnt(2)
  buffer_load_dwordx4 v170, s[32:35], s79 offen offset:2048 lds
  v_mfma_f32_16x16x32_bf16 v[0:3], v[216:219], a[160:163], v[0:3]
  ds_read_b64_tr_b16 v[132:133], v173 offset:20480
  v_max3_f32 v208, v208, v87, v88
  v_max3_f32 v208, v208, v89, v90
  v_mfma_f32_16x16x32_bf16 v[0:3], v[220:223], a[176:179], v[0:3]
  v_max3_f32 v208, v208, v91, v92
  v_max3_f32 v208, v208, v93, v94
  v_mfma_f32_16x16x32_bf16 v[8:11], v[216:219], a[164:167], v[8:11]
  ds_read_b64_tr_b16 v[134:135], v173 offset:20992
  v_max_f32 v208, v208, v95
  v_mfma_f32_16x16x32_bf16 v[8:11], v[220:223], a[180:183], v[8:11]
  buffer_load_dwordx4 v171, s[32:35], s79 offen offset:3072 lds
  v_mfma_f32_16x16x32_bf16 v[96:99], v[216:219], a[168:171], v[96:99]
  s_add_u32 m0, s77, 69632
  ds_read_b64_tr_b16 v[136:137], v172 offset:24576
  v_mul_f32 v208, 0xbfb8aa3b, v208
  v_fma_f32 v80, v80, v207, v208
  v_mfma_f32_16x16x32_bf16 v[96:99], v[220:223], a[184:187], v[96:99]
  v_exp_f32 v80, v80
  v_mfma_f32_16x16x32_bf16 v[104:107], v[216:219], a[172:175], v[104:107]
  ds_read_b64_tr_b16 v[138:139], v172 offset:25088
  v_fma_f32 v81, v81, v207, v208
  v_mfma_f32_16x16x32_bf16 v[104:107], v[220:223], a[188:191], v[104:107]
  s_waitcnt lgkmcnt(2)
  buffer_load_dwordx4 v164, s[40:43], s78 offen offset:0 lds
  v_mfma_f32_16x16x32_bf16 v[4:7], v[128:131], a[160:163], v[4:7]
  ds_read_b64_tr_b16 v[140:141], v172 offset:28672
  v_exp_f32 v81, v81
  v_mfma_f32_16x16x32_bf16 v[4:7], v[132:135], a[176:179], v[4:7]
  v_fma_f32 v82, v82, v207, v208
  v_fma_f32 v83, v83, v207, v208
  v_mfma_f32_16x16x32_bf16 v[12:15], v[128:131], a[164:167], v[12:15]
  ds_read_b64_tr_b16 v[142:143], v172 offset:29184
  v_add_f32 v210, v80, v81
  v_mfma_f32_16x16x32_bf16 v[12:15], v[132:135], a[180:183], v[12:15]
  buffer_load_dwordx4 v165, s[40:43], s78 offen offset:1024 lds
  v_mfma_f32_16x16x32_bf16 v[100:103], v[128:131], a[168:171], v[100:103]
  ds_read_b64_tr_b16 v[216:217], v173 offset:24576
  v_exp_f32 v82, v82
  v_mfma_f32_16x16x32_bf16 v[100:103], v[132:135], a[184:187], v[100:103]
  v_exp_f32 v83, v83
  v_mfma_f32_16x16x32_bf16 v[108:111], v[128:131], a[172:175], v[108:111]
  ds_read_b64_tr_b16 v[218:219], v173 offset:25088
  v_fma_f32 v84, v84, v207, v208
  v_mfma_f32_16x16x32_bf16 v[108:111], v[132:135], a[188:191], v[108:111]
  s_waitcnt lgkmcnt(2)
  buffer_load_dwordx4 v166, s[40:43], s78 offen offset:2048 lds
  v_mfma_f32_16x16x32_bf16 v[32:35], v[136:139], a[160:163], v[32:35]
  ds_read_b64_tr_b16 v[220:221], v173 offset:28672
  v_exp_f32 v84, v84
  v_mfma_f32_16x16x32_bf16 v[32:35], v[140:143], a[176:179], v[32:35]
  v_add_f32 v210, v210, v82
  v_fma_f32 v85, v85, v207, v208
  v_mfma_f32_16x16x32_bf16 v[40:43], v[136:139], a[164:167], v[40:43]
  ds_read_b64_tr_b16 v[222:223], v173 offset:29184
  v_add_f32 v210, v210, v83
  v_mfma_f32_16x16x32_bf16 v[40:43], v[140:143], a[180:183], v[40:43]
  buffer_load_dwordx4 v167, s[40:43], s78 offen offset:3072 lds
  v_mfma_f32_16x16x32_bf16 v[112:115], v[136:139], a[168:171], v[112:115]
  s_waitcnt vmcnt(13)
  s_barrier
  ds_read_b64_tr_b16 v[128:129], v172 offset:32768
  v_mfma_f32_16x16x32_bf16 v[112:115], v[140:143], a[184:187], v[112:115]
  v_fma_f32 v86, v86, v207, v208
  v_mfma_f32_16x16x32_bf16 v[120:123], v[136:139], a[172:175], v[120:123]
  ds_read_b64_tr_b16 v[130:131], v172 offset:33280
  v_mfma_f32_16x16x32_bf16 v[120:123], v[140:143], a[188:191], v[120:123]
  s_waitcnt lgkmcnt(2)
  v_add_f32 v210, v210, v84
  v_mfma_f32_16x16x32_bf16 v[36:39], v[216:219], a[160:163], v[36:39]
  ds_read_b64_tr_b16 v[132:133], v172 offset:36864
  s_waitcnt vmcnt(8)
  v_cmp_ne_u32 vcc, v177, v176
  s_cbranch_vccnz L_slow5
L_ret5:
  v_mfma_f32_16x16x32_bf16 v[36:39], v[220:223], a[176:179], v[36:39]
  buffer_load_dwordx4 v[232:235], v183, s[36:39], s26 offen sc1
  v_mfma_f32_16x16x32_bf16 v[44:47], v[216:219], a[164:167], v[44:47]
  ds_read_b64_tr_b16 v[134:135], v172 offset:37376
  v_mfma_f32_16x16x32_bf16 v[44:47], v[220:223], a[180:183], v[44:47]
  v_fma_f32 v87, v87, v207, v208
  v_mfma_f32_16x16x32_bf16 v[116:119], v[216:219], a[168:171], v[116:119]
  ds_read_b64_tr_b16 v[136:137], v173 offset:32768
  v_fma_f32 v88, v88, v207, v208
  v_mfma_f32_16x16x32_bf16 v[116:119], v[220:223], a[184:187], v[116:119]
  buffer_load_dwordx4 a[64:67], v183, s[36:39], s25 offen offset:0 sc1
  v_mfma_f32_16x16x32_bf16 v[124:127], v[216:219], a[172:175], v[124:127]
  ds_read_b64_tr_b16 v[138:139], v173 offset:33280
  v_fma_f32 v89, v89, v207, v208
  v_mfma_f32_16x16x32_bf16 v[124:127], v[220:223], a[188:191], v[124:127]
  s_waitcnt lgkmcnt(2)
  v_exp_f32 v85, v85
  v_mfma_f32_16x16x32_bf16 v[0:3], v[128:131], a[192:195], v[0:3]
  ds_read_b64_tr_b16 v[140:141], v173 offset:36864
  v_add_u32 v168, 0xfffe0000, v200
  v_add_f32 v210, v210, v85
  v_mfma_f32_16x16x32_bf16 v[0:3], v[132:135], a[208:211], v[0:3]
  buffer_load_dwordx4 a[68:71], v183, s[36:39], s25 offen offset:1024 sc1
  v_mfma_f32_16x16x32_bf16 v[8:11], v[128:131], a[196:199], v[8:11]
  ds_read_b64_tr_b16 v[142:143], v173 offset:37376
  v_add_u32 v169, 0xfffe0000, v201
  v_mfma_f32_16x16x32_bf16 v[8:11], v[132:135], a[212:215], v[8:11]
  v_add_u32 v170, 0xfffe0000, v202
  v_add_u32 v171, 0xfffe0000, v203
  v_mfma_f32_16x16x32_bf16 v[96:99], v[128:131], a[200:203], v[96:99]
  ds_read_b64_tr_b16 v[216:217], v172 offset:40960
  v_exp_f32 v86, v86
  v_mfma_f32_16x16x32_bf16 v[96:99], v[132:135], a[216:219], v[96:99]
  buffer_load_dwordx4 a[72:75], v183, s[36:39], s25 offen offset:2048 sc1
  v_mfma_f32_16x16x32_bf16 v[104:107], v[128:131], a[204:207], v[104:107]
  ds_read_b64_tr_b16 v[218:219], v172 offset:41472
  v_add_f32 v210, v210, v86
  v_mfma_f32_16x16x32_bf16 v[104:107], v[132:135], a[220:223], v[104:107]
  s_waitcnt lgkmcnt(2)
  v_exp_f32 v87, v87
  v_mfma_f32_16x16x32_bf16 v[4:7], v[136:139], a[192:195], v[4:7]
  ds_read_b64_tr_b16 v[220:221], v172 offset:45056
  v_exp_f32 v88, v88
  v_mfma_f32_16x16x32_bf16 v[4:7], v[140:143], a[208:211], v[4:7]
  buffer_load_dwordx4 a[76:79], v183, s[36:39], s25 offen offset:3072 sc1
  v_mfma_f32_16x16x32_bf16 v[12:15], v[136:139], a[196:199], v[12:15]
  s_add_u32 s25, s25, 4096
  ds_read_b64_tr_b16 v[222:223], v172 offset:45568
  v_add_f32 v210, v210, v87
  v_mfma_f32_16x16x32_bf16 v[12:15], v[140:143], a[212:215], v[12:15]
  v_exp_f32 v89, v89
  v_mfma_f32_16x16x32_bf16 v[100:103], v[136:139], a[200:203], v[100:103]
  ds_read_b64_tr_b16 v[128:129], v173 offset:40960
  v_fma_f32 v90, v90, v207, v208
  v_add_f32 v210, v210, v88
  v_mfma_f32_16x16x32_bf16 v[100:103], v[140:143], a[216:219], v[100:103]
  buffer_load_dwordx4 a[80:83], v183, s[36:39], s25 offen offset:0 sc1
  v_mfma_f32_16x16x32_bf16 v[108:111], v[136:139], a[204:207], v[108:111]
  ds_read_b64_tr_b16 v[130:131], v173 offset:41472
  v_fma_f32 v91, v91, v207, v208
  v_mfma_f32_16x16x32_bf16 v[108:111], v[140:143], a[220:223], v[108:111]
  s_waitcnt lgkmcnt(2)
  v_exp_f32 v90, v90
  v_mfma_f32_16x16x32_bf16 v[32:35], v[216:219], a[192:195], v[32:35]
  ds_read_b64_tr_b16 v[132:133], v173 offset:45056
  v_exp_f32 v91, v91
  v_mfma_f32_16x16x32_bf16 v[32:35], v[220:223], a[208:211], v[32:35]
  buffer_load_dwordx4 a[84:87], v183, s[36:39], s25 offen offset:1024 sc1
  v_mfma_f32_16x16x32_bf16 v[40:43], v[216:219], a[196:199], v[40:43]
  ds_read_b64_tr_b16 v[134:135], v173 offset:45568
  v_add_f32 v210, v210, v89
  v_mfma_f32_16x16x32_bf16 v[40:43], v[220:223], a[212:215], v[40:43]
  v_fma_f32 v92, v92, v207, v208
  v_add_f32 v210, v210, v90
  v_mfma_f32_16x16x32_bf16 v[112:115], v[216:219], a[200:203], v[112:115]
  s_waitcnt vmcnt(11)
  s_barrier
  ds_read_b64_tr_b16 v[136:137], v172 offset:49152
  v_mfma_f32_16x16x32_bf16 v[112:115], v[220:223], a[216:219], v[112:115]
  buffer_load_dwordx4 a[88:91], v183, s[36:39], s25 offen offset:2048 sc1
  v_mfma_f32_16x16x32_bf16 v[120:123], v[216:219], a[204:207], v[120:123]
  ds_read_b64_tr_b16 v[138:139], v172 offset:49664
  v_mfma_f32_16x16x32_bf16 v[120:123], v[220:223], a[220:223], v[120:123]
  s_waitcnt lgkmcnt(2)
  v_fma_f32 v93, v93, v207, v208
  v_mfma_f32_16x16x32_bf16 v[36:39], v[128:131], a[192:195], v[36:39]
  ds_read_b64_tr_b16 v[140:141], v172 offset:53248
  v_add_f32 v210, v210, v91
  v_mfma_f32_16x16x32_bf16 v[36:39], v[132:135], a[208:211], v[36:39]
  buffer_load_dwordx4 a[92:95], v183, s[36:39], s25 offen offset:3072 sc1
  v_mfma_f32_16x16x32_bf16 v[44:47], v[128:131], a[196:199], v[44:47]
  s_add_u32 s25, s25, 4096
  ds_read_b64_tr_b16 v[142:143], v172 offset:53760
  v_fma_f32 v94, v94, v207, v208
  v_mfma_f32_16x16x32_bf16 v[44:47], v[132:135], a[212:215], v[44:47]
  v_exp_f32 v92, v92
  v_mfma_f32_16x16x32_bf16 v[116:119], v[128:131], a[200:203], v[116:119]
  ds_read_b64_tr_b16 v[216:217], v173 offset:49152
  v_exp_f32 v93, v93
  v_mfma_f32_16x16x32_bf16 v[116:119], v[132:135], a[216:219], v[116:119]
  buffer_load_dword v178, v180, s[36:39], s96 offen offset:1024 sc1
  v_mfma_f32_16x16x32_bf16 v[124:127], v[128:131], a[204:207], v[124:127]
  ds_read_b64_tr_b16 v[218:219], v173 offset:49664
  v_add_f32 v210, v210, v92
  v_mfma_f32_16x16x32_bf16 v[124:127], v[132:135], a[220:223], v[124:127]
  s_waitcnt lgkmcnt(2)
  buffer_load_dwordx4 a[96:99], v183, s[36:39], s25 offen offset:0 sc1
  v_mfma_f32_16x16x32_bf16 v[0:3], v[136:139], a[224:227], v[0:3]
  ds_read_b64_tr_b16 v[220:221], v173 offset:53248
  v_exp_f32 v94, v94
  v_mfma_f32_16x16x32_bf16 v[0:3], v[140:143], a[240:243], v[0:3]
  v_fma_f32 v95, v95, v207, v208
  v_add_f32 v210, v210, v93
  v_mfma_f32_16x16x32_bf16 v[8:11], v[136:139], a[228:231], v[8:11]
  ds_read_b64_tr_b16 v[222:223], v173 offset:53760
  v_add_f32 v210, v210, v94
  v_mfma_f32_16x16x32_bf16 v[8:11], v[140:143], a[244:247], v[8:11]
  buffer_load_dwordx4 a[100:103], v183, s[36:39], s25 offen offset:1024 sc1
  v_mfma_f32_16x16x32_bf16 v[96:99], v[136:139], a[232:235], v[96:99]
  ds_read_b64_tr_b16 v[128:129], v172 offset:57344
  v_exp_f32 v95, v95
  v_mfma_f32_16x16x32_bf16 v[96:99], v[140:143], a[248:251], v[96:99]
  v_add_f32 v210, v210, v95
  v_mfma_f32_16x16x32_bf16 v[104:107], v[136:139], a[236:239], v[104:107]
  ds_read_b64_tr_b16 v[130:131], v172 offset:57856
  v_mfma_f32_16x16x32_bf16 v[104:107], v[140:143], a[252:255], v[104:107]
  s_waitcnt lgkmcnt(2)
  buffer_load_dwordx4 a[104:107], v183, s[36:39], s25 offen offset:2048 sc1
  v_mfma_f32_16x16x32_bf16 v[4:7], v[216:219], a[224:227], v[4:7]
  ds_read_b64_tr_b16 v[132:133], v172 offset:61440
  v_rcp_f32 v210, v210
  v_mfma_f32_16x16x32_bf16 v[4:7], v[220:223], a[240:243], v[4:7]
  v_mul_f32 v80, v80, v210
  v_mul_f32 v81, v81, v210
  v_mfma_f32_16x16x32_bf16 v[12:15], v[216:219], a[228:231], v[12:15]
  ds_read_b64_tr_b16 v[134:135], v172 offset:61952
  v_mul_f32 v82, v82, v210
  v_mfma_f32_16x16x32_bf16 v[12:15], v[220:223], a[244:247], v[12:15]
  buffer_load_dwordx4 a[108:111], v183, s[36:39], s25 offen offset:3072 sc1
  v_mfma_f32_16x16x32_bf16 v[100:103], v[216:219], a[232:235], v[100:103]
  s_add_u32 s25, s25, 4096
  ds_read_b64_tr_b16 v[136:137], v173 offset:57344
  v_mul_f32 v83, v83, v210
  v_mul_f32 v84, v84, v210
  v_mfma_f32_16x16x32_bf16 v[100:103], v[220:223], a[248:251], v[100:103]
  v_mul_f32 v85, v85, v210
  v_mul_f32 v86, v86, v210
  v_mfma_f32_16x16x32_bf16 v[108:111], v[216:219], a[236:239], v[108:111]
  ds_read_b64_tr_b16 v[138:139], v173 offset:57856
  v_mul_f32 v87, v87, v210
  v_mfma_f32_16x16x32_bf16 v[108:111], v[220:223], a[252:255], v[108:111]
  s_waitcnt lgkmcnt(2)
  buffer_load_dwordx4 a[112:115], v183, s[36:39], s25 offen offset:0 sc1
  v_mfma_f32_16x16x32_bf16 v[32:35], v[128:131], a[224:227], v[32:35]
  ds_read_b64_tr_b16 v[140:141], v173 offset:61440
  v_mul_f32 v88, v88, v210
  v_mul_f32 v89, v89, v210
  v_mfma_f32_16x16x32_bf16 v[32:35], v[132:135], a[240:243], v[32:35]
  v_mul_f32 v90, v90, v210
  v_mul_f32 v91, v91, v210
  v_mfma_f32_16x16x32_bf16 v[40:43], v[128:131], a[228:231], v[40:43]
  ds_read_b64_tr_b16 v[142:143], v173 offset:61952
  v_mul_f32 v92, v92, v210
  v_mfma_f32_16x16x32_bf16 v[40:43], v[132:135], a[244:247], v[40:43]
  buffer_load_dwordx4 a[116:119], v183, s[36:39], s25 offen offset:1024 sc1
  v_mfma_f32_16x16x32_bf16 v[112:115], v[128:131], a[232:235], v[112:115]
  v_mul_f32 v93, v93, v210
  v_mul_f32 v94, v94, v210
  v_mul_f32 v95, v95, v210
  v_mfma_f32_16x16x32_bf16 v[112:115], v[132:135], a[248:251], v[112:115]
  v_cvt_pk_bf16_f32 v24, v80, v81
  v_cvt_pk_bf16_f32 v25, v82, v83
  v_mfma_f32_16x16x32_bf16 v[80:83], v[236:239], v[156:159], 0
  v_cvt_pk_bf16_f32 v26, v84, v85
  v_cvt_pk_bf16_f32 v27, v86, v87
  v_mfma_f32_16x16x32_bf16 v[84:87], v[244:247], v[156:159], 0
  v_cvt_pk_bf16_f32 v28, v88, v89
  v_cvt_pk_bf16_f32 v29, v90, v91
  v_mfma_f32_16x16x32_bf16 v[88:91], v[240:243], v[156:159], 0
  v_cvt_pk_bf16_f32 v30, v92, v93
  v_cvt_pk_bf16_f32 v31, v94, v95
  v_permlane32_swap_b32 v24, v28
  v_mfma_f32_16x16x32_bf16 v[92:95], v[248:251], v[156:159], 0
  v_permlane32_swap_b32 v25, v29
  v_permlane32_swap_b32 v26, v30
  v_mfma_f32_16x16x32_bf16 v[120:123], v[128:131], a[236:239], v[120:123]
  v_permlane32_swap_b32 v27, v31
  v_mfma_f32_16x16x32_bf16 v[120:123], v[132:135], a[252:255], v[120:123]
  s_waitcnt lgkmcnt(0)
  buffer_load_dwordx4 a[120:123], v183, s[36:39], s25 offen offset:2048 sc1
  v_mfma_f32_16x16x32_bf16 v[36:39], v[136:139], a[224:227], v[36:39]
  s_barrier
  v_mfma_f32_16x16x32_bf16 v[36:39], v[140:143], a[240:243], v[36:39]
  v_mfma_f32_16x16x32_bf16 v[44:47], v[136:139], a[228:231], v[44:47]
  v_mfma_f32_16x16x32_bf16 v[44:47], v[140:143], a[244:247], v[44:47]
  buffer_load_dwordx4 a[124:127], v183, s[36:39], s25 offen offset:3072 sc1
  v_mfma_f32_16x16x32_bf16 v[116:119], v[136:139], a[232:235], v[116:119]
  v_mfma_f32_16x16x32_bf16 v[116:119], v[140:143], a[248:251], v[116:119]
  v_mfma_f32_16x16x32_bf16 v[124:127], v[136:139], a[236:239], v[124:127]
  v_mfma_f32_16x16x32_bf16 v[124:127], v[140:143], a[252:255], v[124:127]
  v_pk_mul_f32 v[208:209], v[0:1], v[0:1]
  v_pk_mul_f32 v[210:211], v[2:3], v[2:3]
  v_pk_mul_f32 v[212:213], v[4:5], v[4:5]
  v_pk_mul_f32 v[214:215], v[6:7], v[6:7]
  s_waitcnt vmcnt(8)
  v_cmp_ne_u32 vcc, v178, v176
  s_cbranch_vccnz L_slow7
L_ret7:
  s_add_u32 s97, s93, 98304
  buffer_load_dwordx4 a[128:131], v190, s[36:39], s97 offen sc1
  v_pk_fma_f32 v[208:209], v[208:209], s[24:25], v[206:207] op_sel_hi:[1,0,0]
  v_pk_fma_f32 v[210:211], v[210:211], s[24:25], v[206:207] op_sel_hi:[1,0,0]
  v_pk_fma_f32 v[212:213], v[212:213], s[24:25], v[206:207] op_sel_hi:[1,0,0]
  v_pk_fma_f32 v[214:215], v[214:215], s[24:25], v[206:207] op_sel_hi:[1,0,0]
  v_pk_mul_f32 v[208:209], v[208:209], v[0:1]
  v_pk_mul_f32 v[210:211], v[210:211], v[2:3]
  v_pk_mul_f32 v[212:213], v[212:213], v[4:5]
  v_pk_mul_f32 v[214:215], v[214:215], v[6:7]
  v_exp_f32 v208, v208
  v_exp_f32 v209, v209
  v_exp_f32 v210, v210
  s_add_u32 s98, s93, 102400
  buffer_load_dwordx4 a[144:147], v190, s[36:39], s98 offen sc1
  v_exp_f32 v211, v211
  v_exp_f32 v212, v212
  v_exp_f32 v213, v213
  v_exp_f32 v214, v214
  v_exp_f32_e64 v215, v215
  v_pk_mul_f32 v[32:33], v[0:1], v[32:33]
  v_pk_mul_f32 v[34:35], v[2:3], v[34:35]
  v_pk_mul_f32 v[36:37], v[4:5], v[36:37]
  v_pk_mul_f32 v[38:39], v[6:7], v[38:39]
  v_pk_fma_f32 v[208:209], v[208:209], v[184:185], v[184:185] op_sel_hi:[1,0,0]
  v_pk_fma_f32 v[210:211], v[210:211], v[184:185], v[184:185] op_sel_hi:[1,0,0]
  buffer_load_dwordx4 a[132:135], v191, s[36:39], s97 offen sc1
  v_pk_fma_f32 v[212:213], v[212:213], v[184:185], v[184:185] op_sel_hi:[1,0,0]
  v_pk_fma_f32 v[214:215], v[214:215], v[184:185], v[184:185] op_sel_hi:[1,0,0]
  v_rcp_f32 v208, v208
  v_rcp_f32 v209, v209
  v_rcp_f32 v210, v210
  v_rcp_f32 v211, v211
  v_rcp_f32 v212, v212
  v_rcp_f32 v213, v213
  v_rcp_f32 v214, v214
  v_rcp_f32 v215, v215
  v_pk_mul_f32 v[32:33], v[32:33], v[208:209]
  buffer_load_dwordx4 a[148:151], v191, s[36:39], s98 offen sc1
  v_pk_mul_f32 v[34:35], v[34:35], v[210:211]
  v_pk_mul_f32 v[36:37], v[36:37], v[212:213]
  v_pk_mul_f32 v[38:39], v[38:39], v[214:215]
  v_cvt_pk_bf16_f32 v144, v32, v33
  v_cvt_pk_bf16_f32 v145, v34, v35
  v_cvt_pk_bf16_f32 v146, v36, v37
  v_cvt_pk_bf16_f32 v147, v38, v39
  buffer_store_dwordx4 v[144:147], v188, s[36:39], s88 offen offset:0 sc1
  v_pk_mul_f32 v[208:209], v[8:9], v[8:9]
  v_pk_mul_f32 v[210:211], v[10:11], v[10:11]
  v_pk_mul_f32 v[212:213], v[12:13], v[12:13]
  buffer_load_dwordx4 a[136:139], v204, s[36:39], s97 offen sc1
  v_pk_mul_f32 v[214:215], v[14:15], v[14:15]
  v_pk_fma_f32 v[208:209], v[208:209], s[24:25], v[206:207] op_sel_hi:[1,0,0]
  v_pk_fma_f32 v[210:211], v[210:211], s[24:25], v[206:207] op_sel_hi:[1,0,0]
  v_pk_fma_f32 v[212:213], v[212:213], s[24:25], v[206:207] op_sel_hi:[1,0,0]
  v_pk_fma_f32 v[214:215], v[214:215], s[24:25], v[206:207] op_sel_hi:[1,0,0]
  v_pk_mul_f32 v[208:209], v[208:209], v[8:9]
  v_pk_mul_f32 v[210:211], v[210:211], v[10:11]
  v_pk_mul_f32 v[212:213], v[212:213], v[12:13]
  v_pk_mul_f32 v[214:215], v[214:215], v[14:15]
  v_exp_f32 v208, v208
  v_exp_f32 v209, v209
  buffer_load_dwordx4 a[152:155], v204, s[36:39], s98 offen sc1
  v_exp_f32 v210, v210
  v_exp_f32 v211, v211
  v_exp_f32 v212, v212
  v_exp_f32 v213, v213
  v_exp_f32 v214, v214
  v_exp_f32 v215, v215
  v_pk_mul_f32 v[40:41], v[8:9], v[40:41]
  v_pk_mul_f32 v[42:43], v[10:11], v[42:43]
  v_pk_mul_f32 v[44:45], v[12:13], v[44:45]
  v_pk_mul_f32 v[46:47], v[14:15], v[46:47]
  v_pk_fma_f32 v[208:209], v[208:209], v[184:185], v[184:185] op_sel:[0,1,1] op_sel_hi:[1,1,1]
  buffer_load_dwordx4 a[140:143], v205, s[36:39], s97 offen sc1
  v_pk_fma_f32 v[210:211], v[210:211], v[184:185], v[184:185] op_sel:[0,1,1] op_sel_hi:[1,1,1]
  v_pk_fma_f32 v[212:213], v[212:213], v[184:185], v[184:185] op_sel:[0,1,1] op_sel_hi:[1,1,1]
  v_pk_fma_f32 v[214:215], v[214:215], v[184:185], v[184:185] op_sel:[0,1,1] op_sel_hi:[1,1,1]
  v_rcp_f32 v208, v208
  v_rcp_f32 v209, v209
  v_rcp_f32 v210, v210
  v_rcp_f32 v211, v211
  v_rcp_f32 v212, v212
  v_rcp_f32 v213, v213
  v_rcp_f32 v214, v214
  v_rcp_f32 v215, v215
  buffer_load_dwordx4 a[156:159], v205, s[36:39], s98 offen sc1
  v_pk_mul_f32 v[40:41], v[40:41], v[208:209]
  v_pk_mul_f32 v[42:43], v[42:43], v[210:211]
  v_pk_mul_f32 v[44:45], v[44:45], v[212:213]
  v_pk_mul_f32 v[46:47], v[46:47], v[214:215]
  v_cvt_pk_bf16_f32 v148, v40, v41
  v_cvt_pk_bf16_f32 v149, v42, v43
  v_cvt_pk_bf16_f32 v150, v44, v45
  v_cvt_pk_bf16_f32 v151, v46, v47
  buffer_store_dwordx4 v[148:151], v188, s[36:39], s88 offen offset:1024 sc1
  v_pk_mul_f32 v[208:209], v[96:97], v[96:97]
  v_pk_mul_f32 v[210:211], v[98:99], v[98:99]
  s_add_u32 s97, s94, 98304
  buffer_load_dwordx4 a[160:163], v190, s[36:39], s97 offen sc1
  v_pk_mul_f32 v[212:213], v[100:101], v[100:101]
  v_pk_mul_f32 v[214:215], v[102:103], v[102:103]
  v_pk_fma_f32 v[208:209], v[208:209], s[24:25], v[206:207] op_sel_hi:[1,0,0]
  v_pk_fma_f32 v[210:211], v[210:211], s[24:25], v[206:207] op_sel_hi:[1,0,0]
  v_pk_fma_f32 v[212:213], v[212:213], s[24:25], v[206:207] op_sel_hi:[1,0,0]
  v_pk_fma_f32 v[214:215], v[214:215], s[24:25], v[206:207] op_sel_hi:[1,0,0]
  v_pk_mul_f32 v[208:209], v[208:209], v[96:97]
  v_pk_mul_f32 v[210:211], v[210:211], v[98:99]
  v_pk_mul_f32 v[212:213], v[212:213], v[100:101]
  v_pk_mul_f32 v[214:215], v[214:215], v[102:103]
  v_exp_f32 v208, v208
  s_add_u32 s98, s94, 102400
  buffer_load_dwordx4 a[176:179], v190, s[36:39], s98 offen sc1
  v_exp_f32 v209, v209
  v_exp_f32 v210, v210
  v_exp_f32 v211, v211
  v_exp_f32 v212, v212
  v_exp_f32 v213, v213
  v_exp_f32 v214, v214
  v_exp_f32 v215, v215
  v_pk_mul_f32 v[112:113], v[96:97], v[112:113]
  v_pk_mul_f32 v[114:115], v[98:99], v[114:115]
  v_pk_mul_f32 v[116:117], v[100:101], v[116:117]
  v_pk_mul_f32 v[118:119], v[102:103], v[118:119]
  buffer_load_dwordx4 a[164:167], v191, s[36:39], s97 offen sc1
  v_pk_fma_f32 v[208:209], v[208:209], v[186:187], v[186:187] op_sel_hi:[1,0,0]
L_pgQ4:
  s_cbranch_execz L_back
  v_pk_fma_f32 v[210:211], v[210:211], v[186:187], v[186:187] op_sel_hi:[1,0,0]
  v_pk_fma_f32 v[212:213], v[212:213], v[186:187], v[186:187] op_sel_hi:[1,0,0]
  v_pk_fma_f32 v[214:215], v[214:215], v[186:187], v[186:187] op_sel_hi:[1,0,0]
  v_rcp_f32 v208, v208
  v_rcp_f32 v209, v209
  v_rcp_f32 v210, v210
  v_rcp_f32 v211, v211
  v_rcp_f32 v212, v212
  v_rcp_f32 v213, v213
  v_rcp_f32 v214, v214
  buffer_load_dwordx4 a[180:183], v191, s[36:39], s98 offen sc1
  v_rcp_f32_e64 v215, v215
  v_pk_mul_f32 v[112:113], v[112:113], v[208:209]
  v_pk_mul_f32 v[114:115], v[114:115], v[210:211]
  v_pk_mul_f32 v[116:117], v[116:117], v[212:213]
  v_pk_mul_f32 v[118:119], v[118:119], v[214:215]
  v_cvt_pk_bf16_f32 v152, v112, v113
  v_cvt_pk_bf16_f32 v153, v114, v115
  v_cvt_pk_bf16_f32 v154, v116, v117
  v_cvt_pk_bf16_f32 v155, v118, v119
  buffer_store_dwordx4 v[152:155], v189, s[36:39], s88 offen offset:0 sc1
  v_pk_mul_f32 v[208:209], v[104:105], v[104:105]
  buffer_load_dwordx4 a[168:171], v204, s[36:39], s97 offen sc1
  v_pk_mul_f32 v[210:211], v[106:107], v[106:107]
  v_pk_mul_f32 v[212:213], v[108:109], v[108:109]
  v_pk_mul_f32 v[214:215], v[110:111], v[110:111]
  v_pk_fma_f32 v[208:209], v[208:209], s[24:25], v[206:207] op_sel_hi:[1,0,0]
  v_pk_fma_f32 v[210:211], v[210:211], s[24:25], v[206:207] op_sel_hi:[1,0,0]
  v_pk_fma_f32 v[212:213], v[212:213], s[24:25], v[206:207] op_sel_hi:[1,0,0]
  v_pk_fma_f32 v[214:215], v[214:215], s[24:25], v[206:207] op_sel_hi:[1,0,0]
  v_pk_mul_f32 v[208:209], v[208:209], v[104:105]
  v_pk_mul_f32 v[210:211], v[210:211], v[106:107]
  v_pk_mul_f32 v[212:213], v[212:213], v[108:109]
  v_pk_mul_f32 v[214:215], v[214:215], v[110:111]
  buffer_load_dwordx4 a[184:187], v204, s[36:39], s98 offen sc1
  v_exp_f32 v208, v208
  v_exp_f32 v209, v209
  v_exp_f32 v210, v210
  v_exp_f32 v211, v211
  v_exp_f32 v212, v212
  v_exp_f32 v213, v213
  v_exp_f32 v214, v214
  v_exp_f32 v215, v215
  v_pk_mul_f32 v[120:121], v[104:105], v[120:121]
  v_pk_mul_f32 v[122:123], v[106:107], v[122:123]
  v_pk_mul_f32 v[124:125], v[108:109], v[124:125]
  buffer_load_dwordx4 a[172:175], v205, s[36:39], s97 offen sc1
  v_pk_mul_f32 v[126:127], v[110:111], v[126:127]
  v_pk_fma_f32 v[208:209], v[208:209], v[186:187], v[186:187] op_sel:[0,1,1] op_sel_hi:[1,1,1]
  v_pk_fma_f32 v[210:211], v[210:211], v[186:187], v[186:187] op_sel:[0,1,1] op_sel_hi:[1,1,1]
  v_pk_fma_f32 v[212:213], v[212:213], v[186:187], v[186:187] op_sel:[0,1,1] op_sel_hi:[1,1,1]
  v_pk_fma_f32 v[214:215], v[214:215], v[186:187], v[186:187] op_sel:[0,1,1] op_sel_hi:[1,1,1]
  v_rcp_f32 v208, v208
  v_rcp_f32 v209, v209
  v_rcp_f32 v210, v210
  v_rcp_f32 v211, v211
  v_rcp_f32 v212, v212
  v_rcp_f32 v213, v213
  buffer_load_dwordx4 a[188:191], v205, s[36:39], s98 offen sc1
  v_rcp_f32 v214, v214
  v_rcp_f32 v215, v215
  v_pk_mul_f32 v[120:121], v[120:121], v[208:209]
  v_pk_mul_f32 v[122:123], v[122:123], v[210:211]
  v_pk_mul_f32 v[124:125], v[124:125], v[212:213]
  v_pk_mul_f32 v[126:127], v[126:127], v[214:215]
  v_cvt_pk_bf16_f32 v156, v120, v121
  v_cvt_pk_bf16_f32 v157, v122, v123
  v_cvt_pk_bf16_f32 v158, v124, v125
  v_cvt_pk_bf16_f32 v159, v126, v127
  buffer_store_dwordx4 v[156:159], v189, s[36:39], s88 offen offset:1024 sc1
  v_max3_f32 v208, v64, v65, v66
  v_max3_f32 v208, v208, v67, v68
  v_max3_f32 v208, v208, v69, v70
  v_max3_f32 v208, v208, v71, v72
  v_max3_f32 v208, v208, v73, v74
  v_max3_f32 v208, v208, v75, v76
  v_max3_f32 v208, v208, v77, v78
  v_max_f32_e64 v208, v208, v79
  v_mul_f32 v208, 0xbfb8aa3b, v208
  v_pk_fma_f32 v[64:65], v[64:65], v[206:207], v[208:209] op_sel:[0,1,0] op_sel_hi:[1,1,0]
  v_pk_fma_f32 v[66:67], v[66:67], v[206:207], v[208:209] op_sel:[0,1,0] op_sel_hi:[1,1,0]
  v_pk_fma_f32 v[68:69], v[68:69], v[206:207], v[208:209] op_sel:[0,1,0] op_sel_hi:[1,1,0]
  v_pk_fma_f32 v[70:71], v[70:71], v[206:207], v[208:209] op_sel:[0,1,0] op_sel_hi:[1,1,0]
  v_pk_fma_f32 v[72:73], v[72:73], v[206:207], v[208:209] op_sel:[0,1,0] op_sel_hi:[1,1,0]
  v_pk_fma_f32 v[74:75], v[74:75], v[206:207], v[208:209] op_sel:[0,1,0] op_sel_hi:[1,1,0]
  v_pk_fma_f32 v[76:77], v[76:77], v[206:207], v[208:209] op_sel:[0,1,0] op_sel_hi:[1,1,0]
  v_pk_fma_f32 v[78:79], v[78:79], v[206:207], v[208:209] op_sel:[0,1,0] op_sel_hi:[1,1,0]
  v_exp_f32 v64, v64
  v_exp_f32 v65, v65
  v_exp_f32 v66, v66
  v_exp_f32 v67, v67
  v_exp_f32 v68, v68
  v_exp_f32 v69, v69
  v_exp_f32 v70, v70
  v_exp_f32 v71, v71
  v_exp_f32 v72, v72
  v_exp_f32 v73, v73
  v_exp_f32 v74, v74
  v_exp_f32 v75, v75
  v_exp_f32 v76, v76
  v_exp_f32 v77, v77
  v_exp_f32 v78, v78
  v_exp_f32 v79, v79
  v_pk_add_f32 v[210:211], v[64:65], v[66:67]
  v_pk_add_f32 v[210:211], v[210:211], v[68:69]
  v_pk_add_f32 v[210:211], v[210:211], v[70:71]
  v_pk_add_f32 v[210:211], v[210:211], v[72:73]
  v_pk_add_f32 v[210:211], v[210:211], v[74:75]
  v_pk_add_f32 v[210:211], v[210:211], v[76:77]
  v_pk_add_f32 v[210:211], v[210:211], v[78:79]
  v_add_f32 v210, v210, v211
  v_rcp_f32_e64 v210, v210
  s_nop 0
  v_pk_mul_f32 v[64:65], v[64:65], v[210:211] op_sel_hi:[1,0]
  v_pk_mul_f32 v[66:67], v[66:67], v[210:211] op_sel_hi:[1,0]
  v_pk_mul_f32 v[68:69], v[68:69], v[210:211] op_sel_hi:[1,0]
  v_pk_mul_f32 v[70:71], v[70:71], v[210:211] op_sel_hi:[1,0]
  v_pk_mul_f32 v[72:73], v[72:73], v[210:211] op_sel_hi:[1,0]
  v_pk_mul_f32 v[74:75], v[74:75], v[210:211] op_sel_hi:[1,0]
  v_pk_mul_f32 v[76:77], v[76:77], v[210:211] op_sel_hi:[1,0]
  v_pk_mul_f32 v[78:79], v[78:79], v[210:211] op_sel_hi:[1,0]
  v_cvt_pk_bf16_f32 v48, v64, v65
  v_cvt_pk_bf16_f32 v49, v66, v67
  v_cvt_pk_bf16_f32 v50, v68, v69
  v_cvt_pk_bf16_f32 v51, v70, v71
  v_cvt_pk_bf16_f32 v52, v72, v73
  v_cvt_pk_bf16_f32 v53, v74, v75
  v_cvt_pk_bf16_f32 v54, v76, v77
  v_cvt_pk_bf16_f32 v55, v78, v79
  v_permlane32_swap_b32 v48, v52
  v_permlane32_swap_b32 v49, v53
  v_permlane32_swap_b32 v50, v54
  v_permlane32_swap_b32 v51, v55
  v_max3_f32 v208, v80, v81, v82
  v_max3_f32 v208, v208, v83, v84
  v_max3_f32 v208, v208, v85, v86
  v_max3_f32 v208, v208, v87, v88
  v_max3_f32 v208, v208, v89, v90
  v_max3_f32 v208, v208, v91, v92
  v_max3_f32 v208, v208, v93, v94
  v_max_f32_e64 v208, v208, v95
  v_mul_f32 v208, 0xbfb8aa3b, v208
  v_pk_fma_f32 v[80:81], v[80:81], v[206:207], v[208:209] op_sel:[0,1,0] op_sel_hi:[1,1,0]
  v_pk_fma_f32 v[82:83], v[82:83], v[206:207], v[208:209] op_sel:[0,1,0] op_sel_hi:[1,1,0]
  v_pk_fma_f32 v[84:85], v[84:85], v[206:207], v[208:209] op_sel:[0,1,0] op_sel_hi:[1,1,0]
  v_pk_fma_f32 v[86:87], v[86:87], v[206:207], v[208:209] op_sel:[0,1,0] op_sel_hi:[1,1,0]
  v_pk_fma_f32 v[88:89], v[88:89], v[206:207], v[208:209] op_sel:[0,1,0] op_sel_hi:[1,1,0]
  v_pk_fma_f32 v[90:91], v[90:91], v[206:207], v[208:209] op_sel:[0,1,0] op_sel_hi:[1,1,0]
  v_pk_fma_f32 v[92:93], v[92:93], v[206:207], v[208:209] op_sel:[0,1,0] op_sel_hi:[1,1,0]
  v_pk_fma_f32 v[94:95], v[94:95], v[206:207], v[208:209] op_sel:[0,1,0] op_sel_hi:[1,1,0]
  v_exp_f32 v80, v80
  v_exp_f32 v81, v81
  v_exp_f32 v82, v82
  v_exp_f32 v83, v83
  v_exp_f32 v84, v84
  v_exp_f32 v85, v85
  v_exp_f32 v86, v86
  v_exp_f32 v87, v87
  v_exp_f32 v88, v88
  v_exp_f32 v89, v89
  v_exp_f32 v90, v90
  v_exp_f32 v91, v91
  v_exp_f32 v92, v92
  v_exp_f32 v93, v93
  v_exp_f32 v94, v94
  v_exp_f32 v95, v95
  v_pk_add_f32 v[210:211], v[80:81], v[82:83]
  v_pk_add_f32 v[210:211], v[210:211], v[84:85]
  v_pk_add_f32 v[210:211], v[210:211], v[86:87]
  v_pk_add_f32 v[210:211], v[210:211], v[88:89]
  v_pk_add_f32 v[210:211], v[210:211], v[90:91]
  v_pk_add_f32 v[210:211], v[210:211], v[92:93]
  v_pk_add_f32 v[210:211], v[210:211], v[94:95]
  v_add_f32 v210, v210, v211
  v_rcp_f32_e64 v210, v210
  s_nop 0
  v_pk_mul_f32 v[80:81], v[80:81], v[210:211] op_sel_hi:[1,0]
  v_pk_mul_f32 v[82:83], v[82:83], v[210:211] op_sel_hi:[1,0]
  v_pk_mul_f32 v[84:85], v[84:85], v[210:211] op_sel_hi:[1,0]
  v_pk_mul_f32 v[86:87], v[86:87], v[210:211] op_sel_hi:[1,0]
  v_pk_mul_f32 v[88:89], v[88:89], v[210:211] op_sel_hi:[1,0]
  v_pk_mul_f32 v[90:91], v[90:91], v[210:211] op_sel_hi:[1,0]
  v_pk_mul_f32 v[92:93], v[92:93], v[210:211] op_sel_hi:[1,0]
  v_pk_mul_f32 v[94:95], v[94:95], v[210:211] op_sel_hi:[1,0]
  v_cvt_pk_bf16_f32 v56, v80, v81
  v_cvt_pk_bf16_f32 v57, v82, v83
  v_cvt_pk_bf16_f32 v58, v84, v85
  v_cvt_pk_bf16_f32 v59, v86, v87
  v_cvt_pk_bf16_f32 v60, v88, v89
  v_cvt_pk_bf16_f32 v61, v90, v91
  v_cvt_pk_bf16_f32 v62, v92, v93
  v_cvt_pk_bf16_f32 v63, v94, v95
  v_permlane32_swap_b32 v56, v60
  v_permlane32_swap_b32 v57, v61
  v_permlane32_swap_b32 v58, v62
  v_permlane32_swap_b32 v59, v63
  v_mfma_f32_32x32x16_bf16 v[64:79], v[228:231], a[64:67], 0
  ds_read_b64_tr_b16 a[224:225], v160 offset:32768
  ds_read_b64_tr_b16 a[226:227], v160 offset:34816
  s_add_u32 m0, s77, 0
  v_lshlrev_b32 v236, 16, v232
  v_and_b32 v237, 0xffff0000, v232
  v_lshlrev_b32 v238, 16, v233
  v_mfma_f32_32x32x16_bf16 v[64:79], v[228:231], a[68:71], v[64:79]
  s_add_u32 s78, s90, 1310720
  ds_read_b64_tr_b16 a[228:229], v161 offset:32768
  ds_read_b64_tr_b16 a[230:231], v161 offset:34816
  buffer_load_dwordx4 v164, s[40:43], s78 offen offset:0 lds
  v_and_b32 v239, 0xffff0000, v233
  v_lshlrev_b32 v240, 16, v234
  v_mfma_f32_32x32x16_bf16 v[64:79], v[228:231], a[72:75], v[64:79]
  ds_read_b64_tr_b16 a[232:233], v162 offset:32768
  ds_read_b64_tr_b16 a[234:235], v162 offset:34816
  v_and_b32 v241, 0xffff0000, v234
  v_lshlrev_b32_e64 v242, 16, v235
  v_and_b32 v243, 0xffff0000, v235
  v_add_f32 v236, v236, v236 row_ror:8 row_mask:0xf bank_mask:0xf
  v_mfma_f32_32x32x16_bf16 v[64:79], v[228:231], a[76:79], v[64:79]
  ds_read_b64_tr_b16 a[236:237], v163 offset:32768
  ds_read_b64_tr_b16 a[238:239], v163 offset:34816
  buffer_load_dwordx4 v165, s[40:43], s78 offen offset:1024 lds
  v_add_f32 v237, v237, v237 row_ror:8 row_mask:0xf bank_mask:0xf
  v_add_f32 v238, v238, v238 row_ror:8 row_mask:0xf bank_mask:0xf
  v_mfma_f32_32x32x16_bf16 v[64:79], v[228:231], a[80:83], v[64:79]
  ds_read_b64_tr_b16 a[240:241], v160 offset:36864
  ds_read_b64_tr_b16 a[242:243], v160 offset:38912
  v_add_f32 v239, v239, v239 row_ror:8 row_mask:0xf bank_mask:0xf
  v_add_f32 v240, v240, v240 row_ror:8 row_mask:0xf bank_mask:0xf
  v_add_f32 v241, v241, v241 row_ror:8 row_mask:0xf bank_mask:0xf
  v_add_f32 v242, v242, v242 row_ror:8 row_mask:0xf bank_mask:0xf
  v_mfma_f32_32x32x16_bf16 v[64:79], v[228:231], a[84:87], v[64:79]
  ds_read_b64_tr_b16 a[244:245], v161 offset:36864
  ds_read_b64_tr_b16 a[246:247], v161 offset:38912
  buffer_load_dwordx4 v166, s[40:43], s78 offen offset:2048 lds
  v_add_f32 v243, v243, v243 row_ror:8 row_mask:0xf bank_mask:0xf
  v_add_f32 v236, v236, v236 row_ror:4 row_mask:0xf bank_mask:0xf
  v_mfma_f32_32x32x16_bf16 v[64:79], v[228:231], a[88:91], v[64:79]
  ds_read_b64_tr_b16 a[248:249], v162 offset:36864
  ds_read_b64_tr_b16 a[250:251], v162 offset:38912
  v_add_f32 v237, v237, v237 row_ror:4 row_mask:0xf bank_mask:0xf
  v_add_f32 v238, v238, v238 row_ror:4 row_mask:0xf bank_mask:0xf
  v_add_f32 v239, v239, v239 row_ror:4 row_mask:0xf bank_mask:0xf
  v_add_f32 v240, v240, v240 row_ror:4 row_mask:0xf bank_mask:0xf
  v_mfma_f32_32x32x16_bf16 v[64:79], v[228:231], a[92:95], v[64:79]
  s_waitcnt vmcnt(27)
  ds_read_b64_tr_b16 a[252:253], v163 offset:36864
  ds_read_b64_tr_b16 a[254:255], v163 offset:38912
  buffer_load_dwordx4 v167, s[40:43], s78 offen offset:3072 lds
  v_add_f32 v241, v241, v241 row_ror:4 row_mask:0xf bank_mask:0xf
  v_add_f32 v242, v242, v242 row_ror:4 row_mask:0xf bank_mask:0xf
  v_mfma_f32_32x32x16_bf16 v[64:79], v[228:231], a[96:99], v[64:79]
  s_add_u32 s78, s90, 1343488
  v_add_f32 v243, v243, v243 row_ror:4 row_mask:0xf bank_mask:0xf
  v_add_f32 v236, v236, v236 row_ror:2 row_mask:0xf bank_mask:0xf
  v_add_f32 v237, v237, v237 row_ror:2 row_mask:0xf bank_mask:0xf
  v_add_f32 v238, v238, v238 row_ror:2 row_mask:0xf bank_mask:0xf
  v_add_f32 v239, v239, v239 row_ror:2 row_mask:0xf bank_mask:0xf
  v_add_f32 v240, v240, v240 row_ror:2 row_mask:0xf bank_mask:0xf
  v_mfma_f32_32x32x16_bf16 v[64:79], v[228:231], a[100:103], v[64:79]
  s_add_u32 m0, s77, 4096
  s_nop 0
  buffer_load_dwordx4 v164, s[40:43], s78 offen offset:0 lds
  v_add_f32 v241, v241, v241 row_ror:2 row_mask:0xf bank_mask:0xf
  v_add_f32 v242, v242, v242 row_ror:2 row_mask:0xf bank_mask:0xf
  v_add_f32 v243, v243, v243 row_ror:2 row_mask:0xf bank_mask:0xf
  v_mfma_f32_32x32x16_bf16 v[64:79], v[228:231], a[104:107], v[64:79]
  v_add_f32 v236, v236, v236 row_ror:1 row_mask:0xf bank_mask:0xf
  v_add_f32 v237, v237, v237 row_ror:1 row_mask:0xf bank_mask:0xf
  v_add_f32 v238, v238, v238 row_ror:1 row_mask:0xf bank_mask:0xf
  v_add_f32 v239, v239, v239 row_ror:1 row_mask:0xf bank_mask:0xf
  v_add_f32 v240, v240, v240 row_ror:1 row_mask:0xf bank_mask:0xf
  v_add_f32 v241, v241, v241 row_ror:1 row_mask:0xf bank_mask:0xf
  v_mfma_f32_32x32x16_bf16 v[64:79], v[228:231], a[108:111], v[64:79]
  s_waitcnt vmcnt(25)
  buffer_load_dwordx4 v165, s[40:43], s78 offen offset:1024 lds
  v_add_f32 v242, v242, v242 row_ror:1 row_mask:0xf bank_mask:0xf
  v_add_f32 v243, v243, v243 row_ror:1 row_mask:0xf bank_mask:0xf
  v_cvt_pk_bf16_f32 v248, v236, v237
  v_mfma_f32_32x32x16_bf16 v[64:79], v[228:231], a[112:115], v[64:79]
  v_cvt_pk_bf16_f32 v249, v238, v239
  v_cvt_pk_bf16_f32 v250, v240, v241
  v_cvt_pk_bf16_f32 v251, v242, v243
  v_mfma_f32_32x32x16_bf16 v[64:79], v[228:231], a[116:119], v[64:79]
  s_waitcnt lgkmcnt(0)
  buffer_load_dwordx4 v166, s[40:43], s78 offen offset:2048 lds
  v_mfma_f32_32x32x16_bf16 v[64:79], v[228:231], a[120:123], v[64:79]
  ds_write_b128 v252, v[248:251] offset:1024
  v_mfma_f32_32x32x16_bf16 v[64:79], v[228:231], a[124:127], v[64:79]
  buffer_load_dwordx4 v167, s[40:43], s78 offen offset:3072 lds
  s_nop 10
  v_cvt_pk_bf16_f32 v244, v64, v65
  v_cvt_pk_bf16_f32 v245, v66, v67
  v_cvt_pk_bf16_f32 v246, v68, v69
  v_cvt_pk_bf16_f32 v247, v70, v71
  ds_write_b128 v252, v[244:247]
  s_waitcnt lgkmcnt(0)
  s_barrier
  ds_read_b128 v[84:87], v253 offset:1024
  ds_read_b128 v[92:95], v253 offset:17408
  ds_read_b128 v[80:83], v253 offset:0
  ds_read_b128 v[88:91], v253 offset:16384
  buffer_load_dword v179, v181, s[36:39], s96 offen offset:8 sc1
  s_waitcnt lgkmcnt(3)
  v_mfma_f32_16x16x32_bf16 v[8:11], v[84:87], v[16:19], 0
  s_waitcnt lgkmcnt(2)
  v_mfma_f32_16x16x32_bf16 v[12:15], v[92:95], v[20:23], 0
  s_waitcnt lgkmcnt(1)
  v_mfma_f32_16x16x32_bf16 v[0:3], v[80:83], v[16:19], 0
  s_waitcnt lgkmcnt(0)
  v_mfma_f32_16x16x32_bf16 v[4:7], v[88:91], v[20:23], 0
  v_mfma_f32_16x16x32_bf16 v[40:43], v[84:87], v[24:27], 0
  s_barrier
  v_mfma_f32_16x16x32_bf16 v[44:47], v[92:95], v[28:31], 0
  v_add_f32 v8, 0x358637bd, v8
  v_add_f32 v12, 0x358637bd, v12
  v_mfma_f32_16x16x32_bf16 v[32:35], v[80:83], v[24:27], 0
  v_rcp_f32 v8, v8
  v_mfma_f32_16x16x32_bf16 v[36:39], v[88:91], v[28:31], 0
  v_rcp_f32 v12, v12
  v_mfma_f32_16x16x32_bf16 v[104:107], v[84:87], v[48:51], 0
  v_mul_f32 v8, v8, v192
  v_mul_f32 v12, v12, v192
  v_mfma_f32_16x16x32_bf16 v[108:111], v[92:95], v[52:55], 0
  v_add_f32 v40, 0x358637bd, v40
  v_add_f32 v44, 0x358637bd, v44
  v_mfma_f32_16x16x32_bf16 v[96:99], v[80:83], v[48:51], 0
  v_rcp_f32 v40, v40
  v_mfma_f32_16x16x32_bf16 v[100:103], v[88:91], v[52:55], 0
  v_rcp_f32 v44, v44
  v_mfma_f32_16x16x32_bf16 v[72:75], v[84:87], v[56:59], 0
  v_mul_f32 v40, v40, v193
  v_mul_f32 v44, v44, v193
  v_mfma_f32_16x16x32_bf16 v[76:79], v[92:95], v[60:63], 0
  v_mfma_f32_16x16x32_bf16 v[64:67], v[80:83], v[56:59], 0
  v_mfma_f32_16x16x32_bf16 v[68:71], v[88:91], v[60:63], 0
  v_pk_mul_f32 v[0:1], v[0:1], v[8:9] op_sel_hi:[1,0]
  v_pk_mul_f32 v[2:3], v[2:3], v[8:9] op_sel_hi:[1,0]
  v_pk_mul_f32 v[4:5], v[4:5], v[12:13] op_sel_hi:[1,0]
  v_pk_mul_f32 v[6:7], v[6:7], v[12:13] op_sel_hi:[1,0]
  v_cvt_pk_bf16_f32 v208, v0, v1
  v_cvt_pk_bf16_f32 v209, v2, v3
  v_cvt_pk_bf16_f32 v210, v4, v5
  v_cvt_pk_bf16_f32 v211, v6, v7
  v_pk_mul_f32 v[32:33], v[32:33], v[40:41] op_sel_hi:[1,0]
  v_pk_mul_f32 v[34:35], v[34:35], v[40:41] op_sel_hi:[1,0]
  v_pk_mul_f32 v[36:37], v[36:37], v[44:45] op_sel_hi:[1,0]
  v_pk_mul_f32 v[38:39], v[38:39], v[44:45] op_sel_hi:[1,0]
  v_cvt_pk_bf16_f32 v212, v32, v33
  v_cvt_pk_bf16_f32 v213, v34, v35
  v_cvt_pk_bf16_f32 v214, v36, v37
  v_cvt_pk_bf16_f32 v215, v38, v39
  v_add_f32 v104, 0x358637bd, v104
  v_add_f32 v108, 0x358637bd, v108
  v_rcp_f32 v104, v104
  v_rcp_f32 v108, v108
  v_mul_f32 v104, v104, v194
  v_mul_f32 v108, v108, v194
  v_pk_mul_f32 v[96:97], v[96:97], v[104:105] op_sel_hi:[1,0]
  v_pk_mul_f32 v[98:99], v[98:99], v[104:105] op_sel_hi:[1,0]
  v_pk_mul_f32 v[100:101], v[100:101], v[108:109] op_sel_hi:[1,0]
  v_pk_mul_f32 v[102:103], v[102:103], v[108:109] op_sel_hi:[1,0]
  v_cvt_pk_bf16_f32 v216, v96, v97
  v_cvt_pk_bf16_f32 v217, v98, v99
  v_cvt_pk_bf16_f32 v218, v100, v101
  v_cvt_pk_bf16_f32 v219, v102, v103
  v_add_f32 v72, 0x358637bd, v72
  v_add_f32 v76, 0x358637bd, v76
  v_rcp_f32 v72, v72
  v_rcp_f32 v76, v76
  v_mul_f32 v72, v72, v195
  v_mul_f32 v76, v76, v195
  v_pk_mul_f32 v[64:65], v[64:65], v[72:73] op_sel_hi:[1,0]
  v_pk_mul_f32 v[66:67], v[66:67], v[72:73] op_sel_hi:[1,0]
  v_pk_mul_f32 v[68:69], v[68:69], v[76:77] op_sel_hi:[1,0]
  v_pk_mul_f32 v[70:71], v[70:71], v[76:77] op_sel_hi:[1,0]
  v_cvt_pk_bf16_f32 v220, v64, v65
  v_cvt_pk_bf16_f32 v221, v66, v67
  v_cvt_pk_bf16_f32 v222, v68, v69
  v_cvt_pk_bf16_f32 v223, v70, v71
  buffer_store_dwordx4 v[208:211], v188, s[36:39], s89 offen offset:0 sc1
  buffer_store_dwordx4 v[212:215], v188, s[36:39], s89 offen offset:1024 sc1
  buffer_store_dwordx4 v[216:219], v189, s[36:39], s89 offen offset:0 sc1
  buffer_store_dwordx4 v[220:223], v189, s[36:39], s89 offen offset:1024 sc1
  s_waitcnt vmcnt(31)
  v_mfma_f32_16x16x32_bf16 v[112:115], a[0:3], a[128:131], 0
  v_mfma_f32_16x16x32_bf16 v[112:115], a[16:19], a[144:147], v[112:115]
  v_mfma_f32_16x16x32_bf16 v[116:119], a[4:7], a[128:131], 0
  v_mfma_f32_16x16x32_bf16 v[116:119], a[20:23], a[144:147], v[116:119]
  v_mfma_f32_16x16x32_bf16 v[120:123], a[8:11], a[128:131], 0
  v_mfma_f32_16x16x32_bf16 v[120:123], a[24:27], a[144:147], v[120:123]
  v_mfma_f32_16x16x32_bf16 v[124:127], a[12:15], a[128:131], 0
  v_mfma_f32_16x16x32_bf16 v[124:127], a[28:31], a[144:147], v[124:127]
  s_waitcnt vmcnt(29)
  v_mfma_f32_16x16x32_bf16 a[64:67], a[0:3], a[132:135], 0
  v_mfma_f32_16x16x32_bf16 a[64:67], a[16:19], a[148:151], a[64:67]
  v_mfma_f32_16x16x32_bf16 a[68:71], a[4:7], a[132:135], 0
  v_mfma_f32_16x16x32_bf16 a[68:71], a[20:23], a[148:151], a[68:71]
  v_mfma_f32_16x16x32_bf16 a[72:75], a[8:11], a[132:135], 0
  v_mfma_f32_16x16x32_bf16 a[72:75], a[24:27], a[148:151], a[72:75]
  v_mfma_f32_16x16x32_bf16 a[76:79], a[12:15], a[132:135], 0
  v_mfma_f32_16x16x32_bf16 a[76:79], a[28:31], a[148:151], a[76:79]
  s_waitcnt vmcnt(26)
  v_mfma_f32_16x16x32_bf16 a[80:83], a[0:3], a[136:139], 0
  s_waitcnt vmcnt(4)
  v_cmp_ne_u32 vcc, v179, v176
  s_cbranch_vccnz L_slow8
L_ret8:
  v_mfma_f32_16x16x32_bf16 a[80:83], a[16:19], a[152:155], a[80:83]
  s_add_u32 s97, s95, 65536
  buffer_load_dwordx4 a[192:195], v190, s[36:39], s97 offen sc1
  v_mfma_f32_16x16x32_bf16 a[84:87], a[4:7], a[136:139], 0
  s_add_u32 s98, s95, 69632
  v_mfma_f32_16x16x32_bf16 a[84:87], a[20:23], a[152:155], a[84:87]
  v_mfma_f32_16x16x32_bf16 a[88:91], a[8:11], a[136:139], 0
  v_mfma_f32_16x16x32_bf16 a[88:91], a[24:27], a[152:155], a[88:91]
  buffer_load_dwordx4 a[208:211], v190, s[36:39], s98 offen sc1
  v_mfma_f32_16x16x32_bf16 a[92:95], a[12:15], a[136:139], 0
  v_mfma_f32_16x16x32_bf16 a[92:95], a[28:31], a[152:155], a[92:95]
  v_mfma_f32_16x16x32_bf16 a[96:99], a[0:3], a[140:143], 0
  v_mfma_f32_16x16x32_bf16 a[96:99], a[16:19], a[156:159], a[96:99]
  buffer_load_dwordx4 a[196:199], v191, s[36:39], s97 offen sc1
  v_mfma_f32_16x16x32_bf16 a[100:103], a[4:7], a[140:143], 0
  v_mfma_f32_16x16x32_bf16 a[100:103], a[20:23], a[156:159], a[100:103]
  v_mfma_f32_16x16x32_bf16 a[104:107], a[8:11], a[140:143], 0
  v_mfma_f32_16x16x32_bf16 a[104:107], a[24:27], a[156:159], a[104:107]
  buffer_load_dwordx4 a[212:215], v191, s[36:39], s98 offen sc1
  v_mfma_f32_16x16x32_bf16 a[108:111], a[12:15], a[140:143], 0
  v_mfma_f32_16x16x32_bf16 a[108:111], a[28:31], a[156:159], a[108:111]
  v_mfma_f32_16x16x32_bf16 v[112:115], a[32:35], a[160:163], v[112:115]
  ds_read_b64_tr_b16 a[0:1], v200 offset:0
  v_mfma_f32_16x16x32_bf16 v[112:115], a[48:51], a[176:179], v[112:115]
  buffer_load_dwordx4 a[200:203], v204, s[36:39], s97 offen sc1
  v_mfma_f32_16x16x32_bf16 v[116:119], a[36:39], a[160:163], v[116:119]
  ds_read_b64_tr_b16 a[2:3], v200 offset:2048
  v_mfma_f32_16x16x32_bf16 v[116:119], a[52:55], a[176:179], v[116:119]
  ds_read_b64_tr_b16 a[4:5], v201 offset:0
  v_mfma_f32_16x16x32_bf16 v[120:123], a[40:43], a[160:163], v[120:123]
  ds_read_b64_tr_b16 a[6:7], v201 offset:2048
  v_mfma_f32_16x16x32_bf16 v[120:123], a[56:59], a[176:179], v[120:123]
  buffer_load_dwordx4 a[216:219], v204, s[36:39], s98 offen sc1
  v_mfma_f32_16x16x32_bf16 v[124:127], a[44:47], a[160:163], v[124:127]
  ds_read_b64_tr_b16 a[8:9], v202 offset:0
  v_mfma_f32_16x16x32_bf16 v[124:127], a[60:63], a[176:179], v[124:127]
  ds_read_b64_tr_b16 a[10:11], v202 offset:2048
  v_mfma_f32_16x16x32_bf16 a[64:67], a[32:35], a[164:167], a[64:67]
  ds_read_b64_tr_b16 a[12:13], v203 offset:0
  v_mfma_f32_16x16x32_bf16 a[64:67], a[48:51], a[180:183], a[64:67]
  buffer_load_dwordx4 a[204:207], v205, s[36:39], s97 offen sc1
  v_mfma_f32_16x16x32_bf16 a[68:71], a[36:39], a[164:167], a[68:71]
  ds_read_b64_tr_b16 a[14:15], v203 offset:2048
  v_mfma_f32_16x16x32_bf16 a[68:71], a[52:55], a[180:183], a[68:71]
  ds_read_b64_tr_b16 a[16:17], v200 offset:4096
  v_mfma_f32_16x16x32_bf16 a[72:75], a[40:43], a[164:167], a[72:75]
  ds_read_b64_tr_b16 a[18:19], v200 offset:6144
  v_mfma_f32_16x16x32_bf16 a[72:75], a[56:59], a[180:183], a[72:75]
  buffer_load_dwordx4 a[220:223], v205, s[36:39], s98 offen sc1
  v_mfma_f32_16x16x32_bf16 a[76:79], a[44:47], a[164:167], a[76:79]
  ds_read_b64_tr_b16 a[20:21], v201 offset:4096
  v_mfma_f32_16x16x32_bf16 a[76:79], a[60:63], a[180:183], a[76:79]
  ds_read_b64_tr_b16 a[22:23], v201 offset:6144
  v_mfma_f32_16x16x32_bf16 a[80:83], a[32:35], a[168:171], a[80:83]
  ds_read_b64_tr_b16 a[24:25], v202 offset:4096
  v_add_u32 v208, s77, v183
  v_mfma_f32_16x16x32_bf16 a[80:83], a[48:51], a[184:187], a[80:83]
  ds_read_b64_tr_b16 a[26:27], v202 offset:6144
  v_xor_b32 v209, 8192, v208
  v_mfma_f32_16x16x32_bf16 a[84:87], a[36:39], a[168:171], a[84:87]
  ds_read_b64_tr_b16 a[28:29], v203 offset:4096
  v_xor_b32 v210, 16384, v208
  v_mfma_f32_16x16x32_bf16 a[84:87], a[52:55], a[184:187], a[84:87]
  ds_read_b64_tr_b16 a[30:31], v203 offset:6144
  v_xor_b32 v211, 24576, v208
  v_mfma_f32_16x16x32_bf16 a[88:91], a[40:43], a[168:171], a[88:91]
  v_and_b32 v212, 15, v175
  v_lshl_add_u32 v212, s58, 4, v212
  v_mfma_f32_16x16x32_bf16 a[88:91], a[56:59], a[184:187], a[88:91]
  v_lshlrev_b32 v212, 10, v212
  v_lshrrev_b32 v213, 5, v175
  v_mfma_f32_16x16x32_bf16 a[92:95], a[44:47], a[168:171], a[92:95]
  v_lshl_add_u32 v212, v213, 4, v212
  v_bfe_u32 v213, v175, 4, 1
  v_mfma_f32_16x16x32_bf16 a[92:95], a[60:63], a[184:187], a[92:95]
  v_lshl_add_u32 v212, v213, 5, v212
  v_mfma_f32_16x16x32_bf16 a[96:99], a[32:35], a[172:175], a[96:99]
  v_mfma_f32_16x16x32_bf16 a[96:99], a[48:51], a[188:191], a[96:99]
  v_mfma_f32_16x16x32_bf16 a[100:103], a[36:39], a[172:175], a[100:103]
  v_mfma_f32_16x16x32_bf16 a[100:103], a[52:55], a[188:191], a[100:103]
  v_mfma_f32_16x16x32_bf16 a[104:107], a[40:43], a[172:175], a[104:107]
  s_waitcnt vmcnt(8)
  s_barrier
  buffer_store_dword v176, v182, s[36:39], 0 offen offset:4 sc1
  v_mfma_f32_16x16x32_bf16 a[104:107], a[56:59], a[188:191], a[104:107]
  v_mfma_f32_16x16x32_bf16 a[108:111], a[44:47], a[172:175], a[108:111]
  v_mfma_f32_16x16x32_bf16 a[108:111], a[60:63], a[188:191], a[108:111]
  s_waitcnt vmcnt(7)
  v_mfma_f32_16x16x32_bf16 v[112:115], a[224:227], a[192:195], v[112:115]
  s_add_u32 s78, s91, 1310720
  v_mfma_f32_16x16x32_bf16 v[112:115], a[240:243], a[208:211], v[112:115]
  s_add_u32 m0, s77, 32768
  s_nop 0
  buffer_load_dwordx4 v164, s[40:43], s78 offen offset:0 lds
  v_mfma_f32_16x16x32_bf16 v[116:119], a[228:231], a[192:195], v[116:119]
  v_mfma_f32_16x16x32_bf16 v[116:119], a[244:247], a[208:211], v[116:119]
  v_mfma_f32_16x16x32_bf16 v[120:123], a[232:235], a[192:195], v[120:123]
  v_mfma_f32_16x16x32_bf16 v[120:123], a[248:251], a[208:211], v[120:123]
  buffer_load_dwordx4 v165, s[40:43], s78 offen offset:1024 lds
  v_mfma_f32_16x16x32_bf16 v[124:127], a[236:239], a[192:195], v[124:127]
  v_mfma_f32_16x16x32_bf16 v[124:127], a[252:255], a[208:211], v[124:127]
  s_waitcnt vmcnt(7)
  v_mfma_f32_16x16x32_bf16 a[64:67], a[224:227], a[196:199], a[64:67]
  v_mfma_f32_16x16x32_bf16 a[64:67], a[240:243], a[212:215], a[64:67]
  buffer_load_dwordx4 v166, s[40:43], s78 offen offset:2048 lds
  v_mfma_f32_16x16x32_bf16 a[68:71], a[228:231], a[196:199], a[68:71]
  v_mfma_f32_16x16x32_bf16 a[68:71], a[244:247], a[212:215], a[68:71]
  v_mfma_f32_16x16x32_bf16 a[72:75], a[232:235], a[196:199], a[72:75]
  v_mfma_f32_16x16x32_bf16 a[72:75], a[248:251], a[212:215], a[72:75]
  buffer_load_dwordx4 v167, s[40:43], s78 offen offset:3072 lds
  v_mfma_f32_16x16x32_bf16 a[76:79], a[236:239], a[196:199], a[76:79]
  s_add_u32 s78, s91, 1343488
  s_add_u32 m0, s77, 36864
  v_mfma_f32_16x16x32_bf16 a[76:79], a[252:255], a[212:215], a[76:79]
  s_waitcnt vmcnt(7)
  v_mfma_f32_16x16x32_bf16 a[80:83], a[224:227], a[200:203], a[80:83]
  v_mfma_f32_16x16x32_bf16 a[80:83], a[240:243], a[216:219], a[80:83]
  buffer_load_dwordx4 v164, s[40:43], s78 offen offset:0 lds
  v_mfma_f32_16x16x32_bf16 a[84:87], a[228:231], a[200:203], a[84:87]
  v_mfma_f32_16x16x32_bf16 a[84:87], a[244:247], a[216:219], a[84:87]
  v_mfma_f32_16x16x32_bf16 a[88:91], a[232:235], a[200:203], a[88:91]
  v_mfma_f32_16x16x32_bf16 a[88:91], a[248:251], a[216:219], a[88:91]
  buffer_load_dwordx4 v165, s[40:43], s78 offen offset:1024 lds
  v_mfma_f32_16x16x32_bf16 a[92:95], a[236:239], a[200:203], a[92:95]
  v_mfma_f32_16x16x32_bf16 a[92:95], a[252:255], a[216:219], a[92:95]
  s_waitcnt vmcnt(7)
  v_mfma_f32_16x16x32_bf16 a[96:99], a[224:227], a[204:207], a[96:99]
  v_mfma_f32_16x16x32_bf16 a[96:99], a[240:243], a[220:223], a[96:99]
  buffer_load_dwordx4 v166, s[40:43], s78 offen offset:2048 lds
  v_mfma_f32_16x16x32_bf16 a[100:103], a[228:231], a[204:207], a[100:103]
  v_mfma_f32_16x16x32_bf16 a[100:103], a[244:247], a[220:223], a[100:103]
  v_mfma_f32_16x16x32_bf16 a[104:107], a[232:235], a[204:207], a[104:107]
  v_mfma_f32_16x16x32_bf16 a[104:107], a[248:251], a[220:223], a[104:107]
  buffer_load_dwordx4 v167, s[40:43], s78 offen offset:3072 lds
  v_mfma_f32_16x16x32_bf16 a[108:111], a[236:239], a[204:207], a[108:111]
  v_mfma_f32_16x16x32_bf16 a[108:111], a[252:255], a[220:223], a[108:111]
  s_add_u32 s78, s90, 0
  s_add_u32 m0, s77, 98304
  s_nop 0
  buffer_load_dwordx4 v164, s[44:47], s78 offen offset:0 lds
  buffer_load_dwordx4 v165, s[44:47], s78 offen offset:1024 lds
  buffer_load_dwordx4 v166, s[44:47], s78 offen offset:2048 lds
  buffer_load_dwordx4 v167, s[44:47], s78 offen offset:3072 lds
  s_add_u32 s78, s90, 32768
  s_add_u32 m0, s77, 102400
  s_nop 0
  buffer_load_dwordx4 v164, s[44:47], s78 offen offset:0 lds
  buffer_load_dwordx4 v165, s[44:47], s78 offen offset:1024 lds
  buffer_load_dword v178, v180, s[36:39], s96 offen offset:4 sc1
  buffer_load_dwordx4 v166, s[44:47], s78 offen offset:2048 lds
  buffer_load_dwordx4 v167, s[44:47], s78 offen offset:3072 lds
  s_waitcnt lgkmcnt(0)
  s_add_u32 s78, s91, 0
  s_add_u32 m0, s77, 131072
  s_nop 0
  buffer_load_dwordx4 v164, s[44:47], s78 offen offset:0 lds
  buffer_load_dwordx4 v165, s[44:47], s78 offen offset:1024 lds
  buffer_load_dwordx4 v166, s[44:47], s78 offen offset:2048 lds
  buffer_load_dwordx4 v167, s[44:47], s78 offen offset:3072 lds
  s_add_u32 s78, s91, 32768
  s_add_u32 m0, s77, 135168
  s_nop 0
  buffer_load_dwordx4 v164, s[44:47], s78 offen offset:0 lds
  buffer_load_dwordx4 v165, s[44:47], s78 offen offset:1024 lds
  buffer_load_dwordx4 v166, s[44:47], s78 offen offset:2048 lds
  buffer_load_dwordx4 v167, s[44:47], s78 offen offset:3072 lds
  s_waitcnt vmcnt(10)
  v_cmp_ne_u32 vcc, v178, v176
L_pgQ5:
  s_cbranch_execz L_back
  s_cbranch_vccnz L_slow9
L_ret9:
  s_add_u32 s97, s93, 0
  buffer_load_dwordx4 a[32:35], v190, s[36:39], s97 offen sc1
  s_add_u32 s98, s93, 4096
  buffer_load_dwordx4 a[48:51], v190, s[36:39], s98 offen sc1
  buffer_load_dwordx4 a[36:39], v191, s[36:39], s97 offen sc1
  buffer_load_dwordx4 a[52:55], v191, s[36:39], s98 offen sc1
  buffer_load_dword v179, v180, s[36:39], s96 offen offset:1028 sc1
  buffer_load_dwordx4 a[40:43], v204, s[36:39], s97 offen sc1
  buffer_load_dwordx4 a[56:59], v204, s[36:39], s98 offen sc1
  buffer_load_dwordx4 a[44:47], v205, s[36:39], s97 offen sc1
  buffer_load_dwordx4 a[60:63], v205, s[36:39], s98 offen sc1
  s_add_u32 s97, s94, 0
  buffer_load_dwordx4 a[128:131], v190, s[36:39], s97 offen sc1
  s_add_u32 s98, s94, 4096
  buffer_load_dwordx4 a[144:147], v190, s[36:39], s98 offen sc1
  s_waitcnt vmcnt(9)
  v_mfma_f32_16x16x32_bf16 v[112:115], a[0:3], a[32:35], v[112:115]
  buffer_load_dwordx4 a[132:135], v191, s[36:39], s97 offen sc1
  v_mfma_f32_16x16x32_bf16 v[112:115], a[16:19], a[48:51], v[112:115]
  ds_read_b64_tr_b16 v[128:129], v160 offset:0
  v_mfma_f32_16x16x32_bf16 v[116:119], a[4:7], a[32:35], v[116:119]
  ds_read_b64_tr_b16 v[130:131], v160 offset:2048
  v_mfma_f32_16x16x32_bf16 v[116:119], a[20:23], a[48:51], v[116:119]
  ds_read_b64_tr_b16 v[132:133], v161 offset:0
  v_mfma_f32_16x16x32_bf16 v[120:123], a[8:11], a[32:35], v[120:123]
  buffer_load_dwordx4 a[148:151], v191, s[36:39], s98 offen sc1
  v_mfma_f32_16x16x32_bf16 v[120:123], a[24:27], a[48:51], v[120:123]
  ds_read_b64_tr_b16 v[134:135], v161 offset:2048
  v_mfma_f32_16x16x32_bf16 v[124:127], a[12:15], a[32:35], v[124:127]
  ds_read_b64_tr_b16 v[136:137], v162 offset:0
  v_mfma_f32_16x16x32_bf16 v[124:127], a[28:31], a[48:51], v[124:127]
  s_waitcnt vmcnt(9)
  ds_read_b64_tr_b16 v[138:139], v162 offset:2048
  v_mfma_f32_16x16x32_bf16 a[64:67], a[0:3], a[36:39], a[64:67]
  buffer_load_dwordx4 a[136:139], v204, s[36:39], s97 offen sc1
  v_mfma_f32_16x16x32_bf16 a[64:67], a[16:19], a[52:55], a[64:67]
  ds_read_b64_tr_b16 v[140:141], v163 offset:0
  v_mfma_f32_16x16x32_bf16 a[68:71], a[4:7], a[36:39], a[68:71]
  ds_read_b64_tr_b16 v[142:143], v163 offset:2048
  v_mfma_f32_16x16x32_bf16 a[68:71], a[20:23], a[52:55], a[68:71]
  ds_read_b64_tr_b16 v[144:145], v160 offset:4096
  v_mfma_f32_16x16x32_bf16 a[72:75], a[8:11], a[36:39], a[72:75]
  buffer_load_dwordx4 a[152:155], v204, s[36:39], s98 offen sc1
  v_mfma_f32_16x16x32_bf16 a[72:75], a[24:27], a[52:55], a[72:75]
  ds_read_b64_tr_b16 v[146:147], v160 offset:6144
  v_mfma_f32_16x16x32_bf16 a[76:79], a[12:15], a[36:39], a[76:79]
  ds_read_b64_tr_b16 v[148:149], v161 offset:4096
  v_mfma_f32_16x16x32_bf16 a[76:79], a[28:31], a[52:55], a[76:79]
  s_waitcnt vmcnt(8)
  ds_read_b64_tr_b16 v[150:151], v161 offset:6144
  v_mfma_f32_16x16x32_bf16 a[80:83], a[0:3], a[40:43], a[80:83]
  buffer_load_dwordx4 a[140:143], v205, s[36:39], s97 offen sc1
  v_mfma_f32_16x16x32_bf16 a[80:83], a[16:19], a[56:59], a[80:83]
  ds_read_b64_tr_b16 v[152:153], v162 offset:4096
  v_mfma_f32_16x16x32_bf16 a[84:87], a[4:7], a[40:43], a[84:87]
  ds_read_b64_tr_b16 v[154:155], v162 offset:6144
  v_mfma_f32_16x16x32_bf16 a[84:87], a[20:23], a[56:59], a[84:87]
  ds_read_b64_tr_b16 v[156:157], v163 offset:4096
  v_mfma_f32_16x16x32_bf16 a[88:91], a[8:11], a[40:43], a[88:91]
  buffer_load_dwordx4 a[156:159], v205, s[36:39], s98 offen sc1
  v_mfma_f32_16x16x32_bf16 a[88:91], a[24:27], a[56:59], a[88:91]
  v_cmp_ne_u32 vcc, v179, v176
  s_cbranch_vccnz L_slow10
L_ret10:
  v_mfma_f32_16x16x32_bf16 a[92:95], a[12:15], a[40:43], a[92:95]
  s_add_u32 s97, s93, 163840
  ds_read_b64_tr_b16 v[158:159], v163 offset:6144
  v_mfma_f32_16x16x32_bf16 a[92:95], a[28:31], a[56:59], a[92:95]
  s_waitcnt vmcnt(8)
  v_mfma_f32_16x16x32_bf16 a[96:99], a[0:3], a[44:47], a[96:99]
  buffer_load_dwordx4 a[160:163], v190, s[36:39], s97 offen sc1
  v_mfma_f32_16x16x32_bf16 a[96:99], a[16:19], a[60:63], a[96:99]
  v_mfma_f32_16x16x32_bf16 a[100:103], a[4:7], a[44:47], a[100:103]
  v_mfma_f32_16x16x32_bf16 a[100:103], a[20:23], a[60:63], a[100:103]
  v_mfma_f32_16x16x32_bf16 a[104:107], a[8:11], a[44:47], a[104:107]
  v_mfma_f32_16x16x32_bf16 a[104:107], a[24:27], a[60:63], a[104:107]
  v_mfma_f32_16x16x32_bf16 a[108:111], a[12:15], a[44:47], a[108:111]
  v_mfma_f32_16x16x32_bf16 a[108:111], a[28:31], a[60:63], a[108:111]
  s_waitcnt vmcnt(7) lgkmcnt(0)
  v_mfma_f32_16x16x32_bf16 v[112:115], v[128:131], a[128:131], v[112:115]
  s_add_u32 s98, s93, 167936
  buffer_load_dwordx4 a[176:179], v190, s[36:39], s98 offen sc1
  v_mfma_f32_16x16x32_bf16 v[112:115], v[144:147], a[144:147], v[112:115]
  ds_read_b64_tr_b16 v[64:65], v168 offset:0
  v_mfma_f32_16x16x32_bf16 v[116:119], v[132:135], a[128:131], v[116:119]
  ds_read_b64_tr_b16 v[66:67], v168 offset:2048
  v_mfma_f32_16x16x32_bf16 v[116:119], v[148:151], a[144:147], v[116:119]
  ds_read_b64_tr_b16 v[68:69], v169 offset:0
  v_mfma_f32_16x16x32_bf16 v[120:123], v[136:139], a[128:131], v[120:123]
  buffer_load_dwordx4 a[164:167], v191, s[36:39], s97 offen sc1
  v_mfma_f32_16x16x32_bf16 v[120:123], v[152:155], a[144:147], v[120:123]
  ds_read_b64_tr_b16 v[70:71], v169 offset:2048
  v_mfma_f32_16x16x32_bf16 v[124:127], v[140:143], a[128:131], v[124:127]
  ds_read_b64_tr_b16 v[72:73], v170 offset:0
  v_mfma_f32_16x16x32_bf16 v[124:127], v[156:159], a[144:147], v[124:127]
  s_waitcnt vmcnt(7)
  ds_read_b64_tr_b16 v[74:75], v170 offset:2048
  v_mfma_f32_16x16x32_bf16 a[64:67], v[128:131], a[132:135], a[64:67]
  buffer_load_dwordx4 a[180:183], v191, s[36:39], s98 offen sc1
  v_mfma_f32_16x16x32_bf16 a[64:67], v[144:147], a[148:151], a[64:67]
  ds_read_b64_tr_b16 v[76:77], v171 offset:0
  v_mfma_f32_16x16x32_bf16 a[68:71], v[132:135], a[132:135], a[68:71]
  ds_read_b64_tr_b16 v[78:79], v171 offset:2048
  v_mfma_f32_16x16x32_bf16 a[68:71], v[148:151], a[148:151], a[68:71]
  ds_read_b64_tr_b16 v[80:81], v168 offset:4096
  v_mfma_f32_16x16x32_bf16 a[72:75], v[136:139], a[132:135], a[72:75]
  buffer_load_dwordx4 a[168:171], v204, s[36:39], s97 offen sc1
  v_mfma_f32_16x16x32_bf16 a[72:75], v[152:155], a[148:151], a[72:75]
  ds_read_b64_tr_b16 v[82:83], v168 offset:6144
  v_mfma_f32_16x16x32_bf16 a[76:79], v[140:143], a[132:135], a[76:79]
  ds_read_b64_tr_b16 v[84:85], v169 offset:4096
  v_mfma_f32_16x16x32_bf16 a[76:79], v[156:159], a[148:151], a[76:79]
  s_waitcnt vmcnt(7)
  ds_read_b64_tr_b16 v[86:87], v169 offset:6144
  v_mfma_f32_16x16x32_bf16 a[80:83], v[128:131], a[136:139], a[80:83]
  buffer_load_dwordx4 a[184:187], v204, s[36:39], s98 offen sc1
  v_mfma_f32_16x16x32_bf16 a[80:83], v[144:147], a[152:155], a[80:83]
  ds_read_b64_tr_b16 v[88:89], v170 offset:4096
  v_mfma_f32_16x16x32_bf16 a[84:87], v[132:135], a[136:139], a[84:87]
  ds_read_b64_tr_b16 v[90:91], v170 offset:6144
  v_mfma_f32_16x16x32_bf16 a[84:87], v[148:151], a[152:155], a[84:87]
  ds_read_b64_tr_b16 v[92:93], v171 offset:4096
  v_mfma_f32_16x16x32_bf16 a[88:91], v[136:139], a[136:139], a[88:91]
  buffer_load_dwordx4 a[172:175], v205, s[36:39], s97 offen sc1
  v_mfma_f32_16x16x32_bf16 a[88:91], v[152:155], a[152:155], a[88:91]
  s_add_u32 s97, s94, 163840
  ds_read_b64_tr_b16 v[94:95], v171 offset:6144
  v_mfma_f32_16x16x32_bf16 a[92:95], v[140:143], a[136:139], a[92:95]
  v_mfma_f32_16x16x32_bf16 a[92:95], v[156:159], a[152:155], a[92:95]
  s_waitcnt vmcnt(7)
  v_mfma_f32_16x16x32_bf16 a[96:99], v[128:131], a[140:143], a[96:99]
  buffer_load_dwordx4 a[188:191], v205, s[36:39], s98 offen sc1
  v_mfma_f32_16x16x32_bf16 a[96:99], v[144:147], a[156:159], a[96:99]
  v_mfma_f32_16x16x32_bf16 a[100:103], v[132:135], a[140:143], a[100:103]
  v_mfma_f32_16x16x32_bf16 a[100:103], v[148:151], a[156:159], a[100:103]
  v_mfma_f32_16x16x32_bf16 a[104:107], v[136:139], a[140:143], a[104:107]
  buffer_load_dwordx4 a[192:195], v190, s[36:39], s97 offen sc1
  v_mfma_f32_16x16x32_bf16 a[104:107], v[152:155], a[156:159], a[104:107]
  v_mfma_f32_16x16x32_bf16 a[108:111], v[140:143], a[140:143], a[108:111]
  v_mfma_f32_16x16x32_bf16 a[108:111], v[156:159], a[156:159], a[108:111]
  s_waitcnt vmcnt(7) lgkmcnt(0)
  v_mfma_f32_16x16x32_bf16 v[112:115], v[64:67], a[160:163], v[112:115]
  s_add_u32 s98, s94, 167936
  buffer_load_dwordx4 a[208:211], v190, s[36:39], s98 offen sc1
  v_mfma_f32_16x16x32_bf16 v[112:115], v[80:83], a[176:179], v[112:115]
  ds_read_b64_tr_b16 v[128:129], v168 offset:32768
  v_mfma_f32_16x16x32_bf16 v[116:119], v[68:71], a[160:163], v[116:119]
  ds_read_b64_tr_b16 v[130:131], v168 offset:34816
  v_mfma_f32_16x16x32_bf16 v[116:119], v[84:87], a[176:179], v[116:119]
  ds_read_b64_tr_b16 v[132:133], v169 offset:32768
  v_mfma_f32_16x16x32_bf16 v[120:123], v[72:75], a[160:163], v[120:123]
  buffer_load_dwordx4 a[196:199], v191, s[36:39], s97 offen sc1
  v_mfma_f32_16x16x32_bf16 v[120:123], v[88:91], a[176:179], v[120:123]
  ds_read_b64_tr_b16 v[134:135], v169 offset:34816
  v_mfma_f32_16x16x32_bf16 v[124:127], v[76:79], a[160:163], v[124:127]
  ds_read_b64_tr_b16 v[136:137], v170 offset:32768
  v_mfma_f32_16x16x32_bf16 v[124:127], v[92:95], a[176:179], v[124:127]
  s_waitcnt vmcnt(7)
  ds_read_b64_tr_b16 v[138:139], v170 offset:34816
  v_mfma_f32_16x16x32_bf16 a[64:67], v[64:67], a[164:167], a[64:67]
  buffer_load_dwordx4 a[212:215], v191, s[36:39], s98 offen sc1
  v_mfma_f32_16x16x32_bf16 a[64:67], v[80:83], a[180:183], a[64:67]
  ds_read_b64_tr_b16 v[140:141], v171 offset:32768
  v_mfma_f32_16x16x32_bf16 a[68:71], v[68:71], a[164:167], a[68:71]
  ds_read_b64_tr_b16 v[142:143], v171 offset:34816
  v_mfma_f32_16x16x32_bf16 a[68:71], v[84:87], a[180:183], a[68:71]
  ds_read_b64_tr_b16 v[144:145], v168 offset:36864
  v_mfma_f32_16x16x32_bf16 a[72:75], v[72:75], a[164:167], a[72:75]
  buffer_load_dwordx4 a[200:203], v204, s[36:39], s97 offen sc1
  v_mfma_f32_16x16x32_bf16 a[72:75], v[88:91], a[180:183], a[72:75]
  ds_read_b64_tr_b16 v[146:147], v168 offset:38912
  v_mfma_f32_16x16x32_bf16 a[76:79], v[76:79], a[164:167], a[76:79]
  ds_read_b64_tr_b16 v[148:149], v169 offset:36864
  v_mfma_f32_16x16x32_bf16 a[76:79], v[92:95], a[180:183], a[76:79]
  s_waitcnt vmcnt(7)
  ds_read_b64_tr_b16 v[150:151], v169 offset:38912
  v_mfma_f32_16x16x32_bf16 a[80:83], v[64:67], a[168:171], a[80:83]
  buffer_load_dwordx4 a[216:219], v204, s[36:39], s98 offen sc1
  v_mfma_f32_16x16x32_bf16 a[80:83], v[80:83], a[184:187], a[80:83]
  ds_read_b64_tr_b16 v[152:153], v170 offset:36864
  v_mfma_f32_16x16x32_bf16 a[84:87], v[68:71], a[168:171], a[84:87]
  ds_read_b64_tr_b16 v[154:155], v170 offset:38912
  v_mfma_f32_16x16x32_bf16 a[84:87], v[84:87], a[184:187], a[84:87]
  ds_read_b64_tr_b16 v[156:157], v171 offset:36864
  v_mfma_f32_16x16x32_bf16 a[88:91], v[72:75], a[168:171], a[88:91]
  buffer_load_dwordx4 a[204:207], v205, s[36:39], s97 offen sc1
  v_mfma_f32_16x16x32_bf16 a[88:91], v[88:91], a[184:187], a[88:91]
  s_add_u32 s97, s93, 229376
  ds_read_b64_tr_b16 v[158:159], v171 offset:38912
  v_mfma_f32_16x16x32_bf16 a[92:95], v[76:79], a[168:171], a[92:95]
  v_mfma_f32_16x16x32_bf16 a[92:95], v[92:95], a[184:187], a[92:95]
  s_waitcnt vmcnt(7)
  v_mfma_f32_16x16x32_bf16 a[96:99], v[64:67], a[172:175], a[96:99]
  buffer_load_dwordx4 a[220:223], v205, s[36:39], s98 offen sc1
  v_mfma_f32_16x16x32_bf16 a[96:99], v[80:83], a[188:191], a[96:99]
  ds_read_b64_tr_b16 v[0:1], v160 offset:32768
  ds_read_b64_tr_b16 v[2:3], v160 offset:34816
  v_mfma_f32_16x16x32_bf16 a[100:103], v[68:71], a[172:175], a[100:103]
  ds_read_b64_tr_b16 v[4:5], v160 offset:36864
  ds_read_b64_tr_b16 v[6:7], v160 offset:38912
  v_mfma_f32_16x16x32_bf16 a[100:103], v[84:87], a[188:191], a[100:103]
  ds_read_b64_tr_b16 v[8:9], v200 offset:0
  ds_read_b64_tr_b16 v[10:11], v200 offset:2048
  v_mfma_f32_16x16x32_bf16 a[104:107], v[72:75], a[172:175], a[104:107]
  buffer_load_dwordx4 a[236:239], v205, s[36:39], s97 offen sc1
  v_mfma_f32_16x16x32_bf16 a[104:107], v[88:91], a[188:191], a[104:107]
  ds_read_b64_tr_b16 v[12:13], v200 offset:4096
  ds_read_b64_tr_b16 v[14:15], v200 offset:6144
  v_mfma_f32_16x16x32_bf16 a[108:111], v[76:79], a[172:175], a[108:111]
  ds_read_b64_tr_b16 v[16:17], v161 offset:32768
  ds_read_b64_tr_b16 v[18:19], v161 offset:34816
  v_mfma_f32_16x16x32_bf16 a[108:111], v[92:95], a[188:191], a[108:111]
  s_waitcnt vmcnt(7) lgkmcnt(10)
  ds_read_b64_tr_b16 v[20:21], v161 offset:36864
  ds_read_b64_tr_b16 v[22:23], v161 offset:38912
  v_mfma_f32_16x16x32_bf16 v[112:115], v[128:131], a[192:195], v[112:115]
  s_add_u32 s98, s93, 233472
  buffer_load_dwordx4 a[252:255], v205, s[36:39], s98 offen sc1
  v_mfma_f32_16x16x32_bf16 v[112:115], v[144:147], a[208:211], v[112:115]
  s_add_u32 s99, s94, 229376
  ds_read_b64_tr_b16 v[24:25], v201 offset:0
  s_add_u32 s79, s94, 233472
  v_mfma_f32_16x16x32_bf16 v[116:119], v[132:135], a[192:195], v[116:119]
  ds_read_b64_tr_b16 v[26:27], v201 offset:2048
  v_mfma_f32_16x16x32_bf16 v[116:119], v[148:151], a[208:211], v[116:119]
  ds_read_b64_tr_b16 v[28:29], v201 offset:4096
  ds_read_b64_tr_b16 v[30:31], v201 offset:6144
  v_mfma_f32_16x16x32_bf16 v[120:123], v[136:139], a[192:195], v[120:123]
  buffer_load_dwordx4 a[12:15], v205, s[36:39], s99 offen sc1
  v_mfma_f32_16x16x32_bf16 v[120:123], v[152:155], a[208:211], v[120:123]
  ds_read_b64_tr_b16 v[32:33], v162 offset:32768
  ds_read_b64_tr_b16 v[34:35], v162 offset:34816
  v_mfma_f32_16x16x32_bf16 v[124:127], v[140:143], a[192:195], v[124:127]
  ds_read_b64_tr_b16 v[36:37], v162 offset:36864
  ds_read_b64_tr_b16 v[38:39], v162 offset:38912
  v_mfma_f32_16x16x32_bf16 v[124:127], v[156:159], a[208:211], v[124:127]
  s_waitcnt vmcnt(7)
  ds_read_b64_tr_b16 v[40:41], v202 offset:0
  ds_read_b64_tr_b16 v[42:43], v202 offset:2048
  v_mfma_f32_16x16x32_bf16 a[64:67], v[128:131], a[196:199], a[64:67]
  buffer_load_dwordx4 a[28:31], v205, s[36:39], s79 offen sc1
  v_mfma_f32_16x16x32_bf16 a[64:67], v[144:147], a[212:215], a[64:67]
  ds_read_b64_tr_b16 v[44:45], v202 offset:4096
  ds_read_b64_tr_b16 v[46:47], v202 offset:6144
  v_mfma_f32_16x16x32_bf16 a[68:71], v[132:135], a[196:199], a[68:71]
  ds_read_b64_tr_b16 v[48:49], v163 offset:32768
  ds_read_b64_tr_b16 v[50:51], v163 offset:34816
  v_mfma_f32_16x16x32_bf16 a[68:71], v[148:151], a[212:215], a[68:71]
  ds_read_b64_tr_b16 v[52:53], v163 offset:36864
  ds_read_b64_tr_b16 v[54:55], v163 offset:38912
  v_mfma_f32_16x16x32_bf16 a[72:75], v[136:139], a[196:199], a[72:75]
  buffer_load_dwordx4 a[232:235], v204, s[36:39], s97 offen sc1
  v_mfma_f32_16x16x32_bf16 a[72:75], v[152:155], a[212:215], a[72:75]
  ds_read_b64_tr_b16 v[56:57], v203 offset:0
  ds_read_b64_tr_b16 v[58:59], v203 offset:2048
  v_mfma_f32_16x16x32_bf16 a[76:79], v[140:143], a[196:199], a[76:79]
  ds_read_b64_tr_b16 v[60:61], v203 offset:4096
  ds_read_b64_tr_b16 v[62:63], v203 offset:6144
  v_mfma_f32_16x16x32_bf16 a[76:79], v[156:159], a[212:215], a[76:79]
  s_waitcnt vmcnt(7)
  v_mfma_f32_16x16x32_bf16 a[80:83], v[128:131], a[200:203], a[80:83]
  buffer_load_dwordx4 a[248:251], v204, s[36:39], s98 offen sc1
  v_mfma_f32_16x16x32_bf16 a[80:83], v[144:147], a[216:219], a[80:83]
  v_mfma_f32_16x16x32_bf16 a[84:87], v[132:135], a[200:203], a[84:87]
  v_mfma_f32_16x16x32_bf16 a[84:87], v[148:151], a[216:219], a[84:87]
  v_mfma_f32_16x16x32_bf16 a[88:91], v[136:139], a[200:203], a[88:91]
  buffer_load_dwordx4 a[8:11], v204, s[36:39], s99 offen sc1
  v_mfma_f32_16x16x32_bf16 a[88:91], v[152:155], a[216:219], a[88:91]
  v_mfma_f32_16x16x32_bf16 a[92:95], v[140:143], a[200:203], a[92:95]
  v_mfma_f32_16x16x32_bf16 a[92:95], v[156:159], a[216:219], a[92:95]
  s_waitcnt vmcnt(7)
  v_mfma_f32_16x16x32_bf16 a[96:99], v[128:131], a[204:207], a[96:99]
  buffer_load_dwordx4 a[24:27], v204, s[36:39], s79 offen sc1
  v_mfma_f32_16x16x32_bf16 a[96:99], v[144:147], a[220:223], a[96:99]
  v_mfma_f32_16x16x32_bf16 a[100:103], v[132:135], a[204:207], a[100:103]
  v_mfma_f32_16x16x32_bf16 a[100:103], v[148:151], a[220:223], a[100:103]
  v_mfma_f32_16x16x32_bf16 a[104:107], v[136:139], a[204:207], a[104:107]
  buffer_load_dwordx4 a[228:231], v191, s[36:39], s97 offen sc1
  v_mfma_f32_16x16x32_bf16 a[104:107], v[152:155], a[220:223], a[104:107]
  v_mfma_f32_16x16x32_bf16 a[108:111], v[140:143], a[204:207], a[108:111]
  v_mfma_f32_16x16x32_bf16 a[108:111], v[156:159], a[220:223], a[108:111]
  s_waitcnt vmcnt(5) lgkmcnt(15)
  v_mfma_f32_16x16x32_bf16 a[96:99], v[0:3], a[236:239], a[96:99]
  buffer_load_dwordx4 a[244:247], v191, s[36:39], s98 offen sc1
  v_mfma_f32_16x16x32_bf16 a[96:99], v[4:7], a[252:255], a[96:99]
  v_mfma_f32_16x16x32_bf16 a[96:99], v[8:11], a[12:15], a[96:99]
  v_mfma_f32_16x16x32_bf16 a[96:99], v[12:15], a[28:31], a[96:99]
  v_mfma_f32_16x16x32_bf16 a[100:103], v[16:19], a[236:239], a[100:103]
  buffer_load_dwordx4 a[4:7], v191, s[36:39], s99 offen sc1
  v_mfma_f32_16x16x32_bf16 a[100:103], v[20:23], a[252:255], a[100:103]
  v_mfma_f32_16x16x32_bf16 a[100:103], v[24:27], a[12:15], a[100:103]
  v_mfma_f32_16x16x32_bf16 a[100:103], v[28:31], a[28:31], a[100:103]
  s_waitcnt lgkmcnt(0)
  v_mfma_f32_16x16x32_bf16 a[104:107], v[32:35], a[236:239], a[104:107]
  buffer_load_dwordx4 a[20:23], v191, s[36:39], s79 offen sc1
  v_mfma_f32_16x16x32_bf16 a[104:107], v[36:39], a[252:255], a[104:107]
  v_mfma_f32_16x16x32_bf16 a[104:107], v[40:43], a[12:15], a[104:107]
  v_mfma_f32_16x16x32_bf16 a[104:107], v[44:47], a[28:31], a[104:107]
  ds_write_b128 v208, a[96:99] offset:0
  v_mfma_f32_16x16x32_bf16 a[108:111], v[48:51], a[236:239], a[108:111]
  buffer_load_dwordx4 a[224:227], v190, s[36:39], s97 offen sc1
  v_mfma_f32_16x16x32_bf16 a[108:111], v[52:55], a[252:255], a[108:111]
  v_mfma_f32_16x16x32_bf16 a[108:111], v[56:59], a[12:15], a[108:111]
  v_mfma_f32_16x16x32_bf16 a[108:111], v[60:63], a[28:31], a[108:111]
  s_waitcnt vmcnt(5)
  ds_write_b128 v208, a[100:103] offset:1024
  v_mfma_f32_16x16x32_bf16 a[80:83], v[0:3], a[232:235], a[80:83]
  buffer_load_dwordx4 a[240:243], v190, s[36:39], s98 offen sc1
  v_mfma_f32_16x16x32_bf16 a[80:83], v[4:7], a[248:251], a[80:83]
  v_mfma_f32_16x16x32_bf16 a[80:83], v[8:11], a[8:11], a[80:83]
  v_mfma_f32_16x16x32_bf16 a[80:83], v[12:15], a[24:27], a[80:83]
  ds_write_b128 v208, a[104:107] offset:2048
  v_mfma_f32_16x16x32_bf16 a[84:87], v[16:19], a[232:235], a[84:87]
  buffer_load_dwordx4 a[0:3], v190, s[36:39], s99 offen sc1
  v_mfma_f32_16x16x32_bf16 a[84:87], v[20:23], a[248:251], a[84:87]
  v_mfma_f32_16x16x32_bf16 a[84:87], v[24:27], a[8:11], a[84:87]
  v_mfma_f32_16x16x32_bf16 a[84:87], v[28:31], a[24:27], a[84:87]
  ds_write_b128 v208, a[108:111] offset:3072
  v_mfma_f32_16x16x32_bf16 a[88:91], v[32:35], a[232:235], a[88:91]
  buffer_load_dwordx4 a[16:19], v190, s[36:39], s79 offen sc1
  v_mfma_f32_16x16x32_bf16 a[88:91], v[36:39], a[248:251], a[88:91]
  v_mfma_f32_16x16x32_bf16 a[88:91], v[40:43], a[8:11], a[88:91]
  v_mfma_f32_16x16x32_bf16 a[88:91], v[44:47], a[24:27], a[88:91]
  ds_write_b128 v208, a[80:83] offset:36864
  v_mfma_f32_16x16x32_bf16 a[92:95], v[48:51], a[232:235], a[92:95]
  v_mfma_f32_16x16x32_bf16 a[92:95], v[52:55], a[248:251], a[92:95]
  v_mfma_f32_16x16x32_bf16 a[92:95], v[56:59], a[8:11], a[92:95]
  v_mfma_f32_16x16x32_bf16 a[92:95], v[60:63], a[24:27], a[92:95]
  s_waitcnt vmcnt(4)
  ds_write_b128 v208, a[84:87] offset:37888
  v_mfma_f32_16x16x32_bf16 a[64:67], v[0:3], a[228:231], a[64:67]
  v_mfma_f32_16x16x32_bf16 a[64:67], v[4:7], a[244:247], a[64:67]
  v_mfma_f32_16x16x32_bf16 a[64:67], v[8:11], a[4:7], a[64:67]
  v_mfma_f32_16x16x32_bf16 a[64:67], v[12:15], a[20:23], a[64:67]
  ds_write_b128 v208, a[88:91] offset:38912
  v_mfma_f32_16x16x32_bf16 a[68:71], v[16:19], a[228:231], a[68:71]
  v_mfma_f32_16x16x32_bf16 a[68:71], v[20:23], a[244:247], a[68:71]
  v_mfma_f32_16x16x32_bf16 a[68:71], v[24:27], a[4:7], a[68:71]
  v_mfma_f32_16x16x32_bf16 a[68:71], v[28:31], a[20:23], a[68:71]
  ds_write_b128 v208, a[92:95] offset:39936
  v_mfma_f32_16x16x32_bf16 a[72:75], v[32:35], a[228:231], a[72:75]
  v_mfma_f32_16x16x32_bf16 a[72:75], v[36:39], a[244:247], a[72:75]
  v_mfma_f32_16x16x32_bf16 a[72:75], v[40:43], a[4:7], a[72:75]
  v_mfma_f32_16x16x32_bf16 a[72:75], v[44:47], a[20:23], a[72:75]
  ds_write_b128 v208, a[64:67] offset:32768
  v_mfma_f32_16x16x32_bf16 a[76:79], v[48:51], a[228:231], a[76:79]
  v_mfma_f32_16x16x32_bf16 a[76:79], v[52:55], a[244:247], a[76:79]
  v_mfma_f32_16x16x32_bf16 a[76:79], v[56:59], a[4:7], a[76:79]
  v_mfma_f32_16x16x32_bf16 a[76:79], v[60:63], a[20:23], a[76:79]
  s_waitcnt vmcnt(0)
  ds_write_b128 v208, a[68:71] offset:33792
  v_mfma_f32_16x16x32_bf16 v[112:115], v[0:3], a[224:227], v[112:115]
  v_mfma_f32_16x16x32_bf16 v[112:115], v[4:7], a[240:243], v[112:115]
  v_mfma_f32_16x16x32_bf16 v[112:115], v[8:11], a[0:3], v[112:115]
  v_mfma_f32_16x16x32_bf16 v[112:115], v[12:15], a[16:19], v[112:115]
  ds_write_b128 v208, a[72:75] offset:34816
  v_mfma_f32_16x16x32_bf16 v[116:119], v[16:19], a[224:227], v[116:119]
  v_mfma_f32_16x16x32_bf16 v[116:119], v[20:23], a[240:243], v[116:119]
  v_mfma_f32_16x16x32_bf16 v[116:119], v[24:27], a[0:3], v[116:119]
  v_mfma_f32_16x16x32_bf16 v[116:119], v[28:31], a[16:19], v[116:119]
  ds_write_b128 v208, a[76:79] offset:35840
  v_mfma_f32_16x16x32_bf16 v[120:123], v[32:35], a[224:227], v[120:123]
  v_mfma_f32_16x16x32_bf16 v[120:123], v[36:39], a[240:243], v[120:123]
  v_mfma_f32_16x16x32_bf16 v[120:123], v[40:43], a[0:3], v[120:123]
  s_waitcnt lgkmcnt(0)
  s_barrier
  ds_read_b128 v[64:67], v209 offset:32768
  ds_read_b128 v[80:83], v210 offset:36864
  v_mfma_f32_16x16x32_bf16 v[120:123], v[44:47], a[16:19], v[120:123]
  ds_read_b128 v[96:99], v211 offset:0
  ds_read_b128 v[68:71], v209 offset:33792
  v_mfma_f32_16x16x32_bf16 v[124:127], v[48:51], a[224:227], v[124:127]
  ds_read_b128 v[84:87], v210 offset:37888
  ds_read_b128 v[100:103], v211 offset:1024
  v_mfma_f32_16x16x32_bf16 v[124:127], v[52:55], a[240:243], v[124:127]
  ds_read_b128 v[72:75], v209 offset:34816
  ds_read_b128 v[88:91], v210 offset:38912
  v_mfma_f32_16x16x32_bf16 v[124:127], v[56:59], a[0:3], v[124:127]
  ds_read_b128 v[104:107], v211 offset:2048
  ds_read_b128 v[76:79], v209 offset:35840
  v_mfma_f32_16x16x32_bf16 v[124:127], v[60:63], a[16:19], v[124:127]
  ds_read_b128 v[92:95], v210 offset:39936
  ds_read_b128 v[108:111], v211 offset:3072
  s_waitcnt lgkmcnt(11)
  v_pk_add_f32 v[112:113], v[112:113], v[64:65]
  v_pk_add_f32 v[114:115], v[114:115], v[66:67]
  s_waitcnt lgkmcnt(10)
  v_pk_add_f32 v[112:113], v[112:113], v[80:81]
  v_pk_add_f32 v[114:115], v[114:115], v[82:83]
  s_waitcnt lgkmcnt(9)
  v_pk_add_f32 v[112:113], v[112:113], v[96:97]
  v_pk_add_f32 v[114:115], v[114:115], v[98:99]
  v_cvt_pk_bf16_f32 v216, v112, v113
  v_cvt_pk_bf16_f32 v217, v114, v115
  s_waitcnt lgkmcnt(8)
  v_pk_add_f32 v[116:117], v[116:117], v[68:69]
  v_pk_add_f32 v[118:119], v[118:119], v[70:71]
  s_waitcnt lgkmcnt(7)
  v_pk_add_f32 v[116:117], v[116:117], v[84:85]
  v_pk_add_f32 v[118:119], v[118:119], v[86:87]
  s_waitcnt lgkmcnt(6)
  v_pk_add_f32 v[116:117], v[116:117], v[100:101]
  v_pk_add_f32 v[118:119], v[118:119], v[102:103]
  v_cvt_pk_bf16_f32 v218, v116, v117
  v_cvt_pk_bf16_f32 v219, v118, v119
  s_nop 0
  v_permlane16_swap_b32 v216, v218
  v_permlane16_swap_b32 v217, v219
  buffer_store_dwordx4 v[216:219], v212, s[48:51], 0 offen offset:0 sc1
  s_waitcnt lgkmcnt(5)
  v_pk_add_f32 v[120:121], v[120:121], v[72:73]
  v_pk_add_f32 v[122:123], v[122:123], v[74:75]
  s_waitcnt lgkmcnt(4)
  v_pk_add_f32 v[120:121], v[120:121], v[88:89]
  v_pk_add_f32 v[122:123], v[122:123], v[90:91]
  s_waitcnt lgkmcnt(3)
  v_pk_add_f32 v[120:121], v[120:121], v[104:105]
  v_pk_add_f32 v[122:123], v[122:123], v[106:107]
  v_cvt_pk_bf16_f32 v220, v120, v121
  v_cvt_pk_bf16_f32 v221, v122, v123
  s_waitcnt lgkmcnt(2)
  v_pk_add_f32 v[124:125], v[124:125], v[76:77]
  v_pk_add_f32 v[126:127], v[126:127], v[78:79]
  s_waitcnt lgkmcnt(1)
  v_pk_add_f32 v[124:125], v[124:125], v[92:93]
  v_pk_add_f32 v[126:127], v[126:127], v[94:95]
  s_waitcnt lgkmcnt(0)
  v_pk_add_f32 v[124:125], v[124:125], v[108:109]
  v_pk_add_f32 v[126:127], v[126:127], v[110:111]
  v_cvt_pk_bf16_f32 v222, v124, v125
  v_cvt_pk_bf16_f32 v223, v126, v127
  s_nop 0
  v_permlane16_swap_b32 v220, v222
  v_permlane16_swap_b32 v221, v223
  buffer_store_dwordx4 v[220:223], v212, s[48:51], 0 offen offset:64 sc1
  s_endpgm
L_slow5:
  s_mov_b32 s3, 0
L_slow5_l:
  buffer_load_dword v177, v226, s[36:39], s27 offen offset:0 sc1
  s_add_u32 s3, s3, 1
  s_waitcnt vmcnt(0)
  v_cmp_ne_u32 vcc, v177, v176
  s_cbranch_vccz L_ret5
  s_cmp_le_u32 s3, 262144
  s_cbranch_scc1 L_slow5_l
  s_branch L_ret5
L_slow6:
  s_mov_b32 s3, 0
L_slow6_l:
  s_add_u32 s3, s3, 1
  s_cmp_gt_u32 s3, 131072
  s_cbranch_scc1 L_ret6
  buffer_load_dword v176, off, s[52:55], 0 sc1
  s_waitcnt vmcnt(0)
  v_cmp_eq_u32 vcc, 0, v176
  s_cbranch_vccnz L_slow6_l
  s_branch L_ret6
L_slow7:
  s_mov_b32 s3, 0
L_slow7_l:
  buffer_load_dword v178, v180, s[36:39], s96 offen offset:1024 sc1
  s_add_u32 s3, s3, 1
  s_waitcnt vmcnt(0)
  v_cmp_ne_u32 vcc, v178, v176
  s_cbranch_vccz L_ret7
  s_cmp_le_u32 s3, 262144
  s_cbranch_scc1 L_slow7_l
  s_branch L_ret7
L_slow8:
  s_mov_b32 s3, 0
L_slow8_l:
  buffer_load_dword v179, v181, s[36:39], s96 offen offset:8 sc1
  s_add_u32 s3, s3, 1
  s_waitcnt vmcnt(0)
  v_cmp_ne_u32 vcc, v179, v176
  s_cbranch_vccz L_ret8
  s_cmp_le_u32 s3, 262144
  s_cbranch_scc1 L_slow8_l
  s_branch L_ret8
L_slow9:
  s_mov_b32 s3, 0
L_slow9_l:
  buffer_load_dword v178, v180, s[36:39], s96 offen offset:4 sc1
  s_add_u32 s3, s3, 1
  s_waitcnt vmcnt(0)
  v_cmp_ne_u32 vcc, v178, v176
  s_cbranch_vccz L_ret9
  s_cmp_le_u32 s3, 262144
  s_cbranch_scc1 L_slow9_l
  s_branch L_ret9
L_slow10:
  s_mov_b32 s3, 0
L_slow10_l:
  buffer_load_dword v179, v180, s[36:39], s96 offen offset:1028 sc1
  s_add_u32 s3, s3, 1
  s_waitcnt vmcnt(0)
  v_cmp_ne_u32 vcc, v179, v176
  s_cbranch_vccz L_ret10
  s_cmp_le_u32 s3, 262144
  s_cbranch_scc1 L_slow10_l
  s_branch L_ret10
L_end:
  s_endpgm
.section .rodata,"a"
.p2align 6
.amdhsa_kernel gated_mix__linear_kernel_hedgehog__glu_gated_geglu__prompt_kernel
  .amdhsa_next_free_vgpr 512
  .amdhsa_next_free_sgpr 102
  .amdhsa_accum_offset 256
  .amdhsa_group_segment_fixed_size 0
  .amdhsa_kernarg_size 96
  .amdhsa_user_sgpr_count 2
  .amdhsa_user_sgpr_kernarg_segment_ptr 1
  .amdhsa_system_sgpr_workgroup_id_x 1
.end_amdhsa_kernel
```
